```python
import torch

def _softmax(x, axis=-1):
    return torch.softmax(x, dim=axis)
def _gelu(x):
    return torch.nn.functional.gelu(x, approximate="tanh")
def _silu(x):
    return torch.nn.functional.silu(x)
def _sigmoid(x):
    return torch.sigmoid(x)
def _layernorm(x, axis=-1, eps=1e-5):
    m = x.mean(dim=axis, keepdim=True)
    v = x.var(dim=axis, keepdim=True, unbiased=False)
    return (x - m) / torch.sqrt(v + eps)
def _scatter_add(tgt, idx, src, axis=0):
    return tgt.clone().index_add_(axis, idx, src)
def _segment_sum(src, seg, n):
    out = torch.zeros((n,) + src.shape[1:], dtype=src.dtype)
    return out.index_add_(0, seg, src)
def _pad(x, pw):
    flat = tuple(v for pair in reversed(pw) for v in pair)
    return torch.nn.functional.pad(x, flat)

kernel_name = 'recurrent_scan__ssm_conv_s5__dense_activation_gelu__prompt'

def setup_inputs():

    _w = (lambda a: (lambda t: t.to(torch.bfloat16) if t.is_floating_point() else t)(torch.as_tensor(a)))
    def _A_setup():
        B, S, D = 1, 2048, 640
        P = D
        Lambda_re = -0.5 * (lambda _x: torch.exp(torch.as_tensor(_x)))((lambda *s: torch.randn(*s, dtype=torch.bfloat16) * 0.4)(P))
        Lambda_im = (lambda *s: torch.randn(*s, dtype=torch.bfloat16) * 0.4)(P) * 1.0
        B_re = (lambda *s: torch.randn(*s, dtype=torch.bfloat16) * 0.4)(P, D) * (D ** -0.5)
        B_im = (lambda *s: torch.randn(*s, dtype=torch.bfloat16) * 0.4)(P, D) * (D ** -0.5)
        C_re = (lambda *s: torch.randn(*s, dtype=torch.bfloat16) * 0.4)(D, P) * (P ** -0.5)
        C_im = (lambda *s: torch.randn(*s, dtype=torch.bfloat16) * 0.4)(D, P) * (P ** -0.5)
        log_dt = (lambda *s: torch.randn(*s, dtype=torch.bfloat16) * 0.4)(P) * 0.3 - 2.0
        Dskip = (lambda *s: torch.randn(*s, dtype=torch.bfloat16) * 0.2)(D)
        return {
            "x": _w((lambda *s: torch.randn(*s, dtype=torch.bfloat16) * 0.05)(B, S, D)),
            "Lambda_re": _w(Lambda_re),
            "Lambda_im": _w(Lambda_im),
            "B_re": _w(B_re),
            "B_im": _w(B_im),
            "C_re": _w(C_re),
            "C_im": _w(C_im),
            "log_dt": _w(log_dt),
            "Dskip": _w(Dskip),
        }
    _A_in = _A_setup()

    def _B_setup():
        B, S, D, F = 1, 2048, 640, 1728
        return {
            "x": _w((lambda *s: torch.randn(*s, dtype=torch.bfloat16) * 0.05)(B, S, D)),
            "w1": _w((lambda *s: torch.randn(*s, dtype=torch.bfloat16) * 0.8)(D, F) * (D ** -0.5)),
            "b1": _w((lambda *s: torch.randn(*s, dtype=torch.bfloat16) * 12.8)(F) * 0.01),
            "w2": _w((lambda *s: torch.randn(*s, dtype=torch.bfloat16) * 0.8)(F, D) * (F ** -0.5)),
            "b2": _w((lambda *s: torch.randn(*s, dtype=torch.bfloat16) * 12.8)(D) * 0.01),
        }
    _B_in = _B_setup()

    return {
        "A_x": _A_in["x"],
        "A_Lambda_re": _A_in["Lambda_re"],
        "A_Lambda_im": _A_in["Lambda_im"],
        "A_B_re": _A_in["B_re"],
        "A_B_im": _A_in["B_im"],
        "A_C_re": _A_in["C_re"],
        "A_C_im": _A_in["C_im"],
        "A_log_dt": _A_in["log_dt"],
        "A_Dskip": _A_in["Dskip"],
        "B_x": _B_in["x"],
        "B_w1": _B_in["w1"],
        "B_b1": _B_in["b1"],
        "B_w2": _B_in["w2"],
        "B_b2": _B_in["b2"],
    }

def reference(A_x, A_Lambda_re, A_Lambda_im, A_B_re, A_B_im, A_C_re, A_C_im, A_log_dt, A_Dskip, B_x, B_w1, B_b1, B_w2, B_b2):
    def _A_ref(x, Lambda_re, Lambda_im, B_re, B_im, C_re, C_im, log_dt, Dskip):
        Bsz, L, H = x.shape
        Lam = Lambda_re + 1j * Lambda_im
        Bmat = B_re + 1j * B_im
        Cmat = C_re + 1j * C_im
        dt = torch.exp(log_dt)
        Lam_bar = torch.exp(dt * Lam)
        B_bar = ((Lam_bar - 1.0) / Lam)[:, None] * Bmat
        Bu = torch.einsum("bld,pd->blp", x + 0j, B_bar)
        h = torch.zeros_like(Bu[:, 0, :])
        hs = []
        for t in range(L):
            h = Lam_bar[None, :] * h + Bu[:, t, :]
            hs.append(h)
        hseq = torch.stack(hs, 1)
        y = 2.0 * torch.einsum("blp,dp->bld", hseq, Cmat).real + x * Dskip[None, None, :]
        return y

    def _B_ref(x, w1, b1, w2, b2):
        h = torch.einsum("bsd,df->bsf", x, w1) + b1
        h = _gelu(h)
        return torch.einsum("bsf,fd->bsd", h, w2) + b2

    x = A_x
    xn = _layernorm(x, axis=-1)
    s = _A_ref(xn, A_Lambda_re, A_Lambda_im, A_B_re, A_B_im, A_C_re, A_C_im, A_log_dt, A_Dskip)
    g = _silu(_B_ref(xn, B_w1, B_b1, B_w2, B_b2))
    return x + s * g
```

```asm
; @launch grid=(256,1,1) block=(256,1,1) lds=163840
.amdgcn_target "amdgcn-amd-amdhsa--gfx950"
.text
.globl recurrent_scan__ssm_conv_s5__dense_activation_gelu__prompt_kernel
.p2align 8
.type recurrent_scan__ssm_conv_s5__dense_activation_gelu__prompt_kernel,@function
recurrent_scan__ssm_conv_s5__dense_activation_gelu__prompt_kernel:
L_base:
    s_getpc_b64 s[66:67]
L_pc:
    s_load_dwordx2 s[8:9], s[0:1], 128
    s_load_dwordx2 s[4:5], s[0:1], 0
    s_cmp_ge_u32 s2, 256
    s_cbranch_scc1 L_end
    s_lshr_b32 s69, s2, 3
    v_lshrrev_b32 v1, 6, v0
    v_and_b32 v0, 63, v0
    s_lshl_b32 s70, s69, 2
    v_add_u32 v11, s70, v1
    v_and_b32 v12, 3, v0
    v_lshl_add_u32 v11, v11, 2, v12
    v_lshlrev_b32 v11, 7, v11
    v_min_u32 v11, (L_end-L_pc), v11
    global_load_dword v253, v11, s[66:67]
    v_readfirstlane_b32 s52, v1
    s_and_b32 s70, s2, 6
    s_lshr_b32 s71, s2, 6
    s_add_u32 s70, s70, s71
    s_cmp_ge_u32 s71, 2
    s_cselect_b32 s71, 7, 0
    s_add_u32 s54, s70, s71
    s_cmp_eq_u32 s54, 16
    s_cselect_b32 s54, 8, s54
    s_cmp_ge_u32 s54, 9
    s_cbranch_scc1 L_pro_s5
    s_load_dwordx2 s[12:13], s[0:1], 112
    s_load_dwordx2 s[14:15], s[0:1], 64
    s_load_dwordx2 s[16:17], s[0:1], 104
    s_load_dwordx2 s[24:25], s[0:1], 80
    s_load_dwordx2 s[72:73], s[0:1], 88
    s_load_dwordx2 s[28:29], s[0:1], 96
    s_mov_b32 s26, 2211840
    s_mov_b32 s27, 0x20000
    s_mov_b32 s74, 3456
    s_mov_b32 s75, 0x20000
    s_mov_b32 s30, 2211840
    s_mov_b32 s31, 0x20000
    s_mov_b32 s10, 28311552
    s_mov_b32 s11, 0x20000
    s_mov_b32 s6, 2621440
    s_mov_b32 s7, 0x20000
    s_and_b32 s70, s2, 1
    s_lshl_b32 s70, s70, 3
    s_and_b32 s71, s69, 7
    s_add_u32 s53, s70, s71
    s_lshr_b32 s3, s53, 2
    s_sub_u32 s3, s53, s3
    s_sub_u32 s3, s3, 1
    s_and_b32 s70, s53, 3
    s_cselect_b32 s3, s3, 12
    s_lshl_b32 s59, s52, 10
    s_and_b32 s61, s52, 1
    s_lshr_b32 s62, s52, 1
    s_lshl_b32 s70, s53, 4
    s_add_u32 s70, s70, s54
    s_lshl_b32 s70, s70, 2
    s_add_u32 s70, s70, s52
    s_lshl_b32 s70, s70, 1
    v_lshrrev_b32 v254, 5, v0
    v_add_u32 v254, s70, v254
    v_mul_u32_u24 v12, 1280, v254
    v_and_b32 v13, 31, v0
    v_lshl_add_u32 v12, v13, 3, v12
    v_mov_b32 v255, 17268736
    v_lshrrev_b32 v11, 3, v0
    v_lshrrev_b32 v8, 4, v0
    v_lshlrev_b32 v8, 1, v8
    v_and_b32 v9, 7, v0
    v_xor_b32 v8, v8, v9
    v_lshlrev_b32 v8, 4, v8
    v_mul_u32_u24 v9, 3456, v11
    v_add_u32 v9, v9, v8
    s_mul_i32 s18, s3, 86
    s_lshr_b32 s18, s18, 8
    s_mul_i32 s19, s18, 3
    s_sub_u32 s19, s3, s19
    s_mul_i32 s20, s54, 3
    s_add_u32 s19, s19, s20
    s_mul_i32 s20, s18, 552960
    s_lshl_b32 s21, s19, 7
    s_add_u32 s20, s20, s21
    s_mul_i32 s21, s52, 27648
    s_add_u32 s20, s20, s21
    s_cmp_lt_u32 s3, 12
    s_cselect_b32 s20, s20, 1073741824
    s_waitcnt lgkmcnt(0)
    buffer_load_dword v255, v255, s[8:11], 0 offen sc1
    buffer_load_dwordx2 v[240:241], v12, s[4:7], 0 offen offset:0
    buffer_load_dwordx2 v[242:243], v12, s[4:7], 0 offen offset:256
    buffer_load_dwordx2 v[244:245], v12, s[4:7], 0 offen offset:512
    buffer_load_dwordx2 v[246:247], v12, s[4:7], 0 offen offset:768
    buffer_load_dwordx2 v[248:249], v12, s[4:7], 0 offen offset:1024
    s_add_u32 m0, s59, 0
    s_nop 0
    buffer_load_dwordx4 v9, s[24:27], s20 offen lds
    s_add_u32 m0, s59, 4096
    s_add_u32 s20, s20, 110592
    buffer_load_dwordx4 v9, s[24:27], s20 offen lds
    s_add_u32 m0, s59, 8192
    s_add_u32 s20, s20, 110592
    buffer_load_dwordx4 v9, s[24:27], s20 offen lds
    s_add_u32 m0, s59, 12288
    s_add_u32 s20, s20, 110592
    buffer_load_dwordx4 v9, s[24:27], s20 offen lds
    s_add_u32 m0, s59, 16384
    s_add_u32 s20, s20, 110592
    buffer_load_dwordx4 v9, s[24:27], s20 offen lds
    s_lshl_b32 s21, s54, 1
    s_add_u32 s21, s21, s62
    s_mul_i32 s21, s21, 192
    v_lshlrev_b32 v13, 1, v13
    buffer_load_ushort v236, v13, s[72:75], s21 offen offset:0
    buffer_load_ushort v237, v13, s[72:75], s21 offen offset:64
    buffer_load_ushort v238, v13, s[72:75], s21 offen offset:128
    s_branch L_ffn
L_pro_s5:
    s_load_dwordx2 s[12:13], s[0:1], 112
    s_load_dwordx2 s[14:15], s[0:1], 64
    s_load_dwordx2 s[16:17], s[0:1], 104
    s_load_dwordx2 s[24:25], s[0:1], 24
    s_load_dwordx2 s[28:29], s[0:1], 32
    s_load_dwordx2 s[40:41], s[0:1], 8
    s_load_dwordx2 s[44:45], s[0:1], 16
    s_load_dwordx2 s[48:49], s[0:1], 56
    s_load_dwordx2 s[32:33], s[0:1], 40
    s_load_dwordx2 s[36:37], s[0:1], 48
    s_mov_b32 s26, 819200
    s_mov_b32 s27, 0x20000
    s_mov_b32 s30, 819200
    s_mov_b32 s31, 0x20000
    s_mov_b32 s42, 1280
    s_mov_b32 s43, 0x20000
    s_mov_b32 s46, 1280
    s_mov_b32 s47, 0x20000
    s_mov_b32 s50, 1280
    s_mov_b32 s51, 0x20000
    s_mov_b32 s34, 819200
    s_mov_b32 s35, 0x20000
    s_mov_b32 s38, 819200
    s_mov_b32 s39, 0x20000
    s_mov_b32 s10, 28311552
    s_mov_b32 s11, 0x20000
    s_mov_b32 s6, 2621440
    s_mov_b32 s7, 0x20000
    s_and_b32 s70, s2, 1
    s_lshl_b32 s70, s70, 3
    s_and_b32 s71, s69, 7
    s_add_u32 s53, s70, s71
    s_lshr_b32 s3, s53, 2
    s_sub_u32 s3, s53, s3
    s_sub_u32 s3, s3, 1
    s_and_b32 s70, s53, 3
    s_cselect_b32 s3, s3, 12
    s_lshl_b32 s59, s52, 10
    s_and_b32 s61, s52, 1
    s_lshr_b32 s62, s52, 1
    s_lshl_b32 s70, s53, 4
    s_add_u32 s70, s70, s54
    s_lshl_b32 s70, s70, 2
    s_add_u32 s70, s70, s52
    s_lshl_b32 s70, s70, 1
    v_lshrrev_b32 v254, 5, v0
    v_add_u32 v254, s70, v254
    v_mul_u32_u24 v12, 1280, v254
    v_and_b32 v13, 31, v0
    v_lshl_add_u32 v12, v13, 3, v12
    v_mov_b32 v255, 17268736
    s_sub_u32 s77, s54, 9
    s_mul_i32 s68, s77, 96
    s_mul_i32 s60, s62, 48
    s_add_u32 s60, s60, s68
    s_lshl_b32 s70, s77, 4
    s_add_u32 s70, s70, s53
    s_mul_i32 s64, s70, 6554
    s_lshr_b32 s64, s64, 16
    s_mul_i32 s65, s64, 10
    s_sub_u32 s65, s70, s65
    v_and_b32 v7, 15, v0
    v_lshrrev_b32 v8, 4, v0
    v_lshlrev_b32 v9, 1, v7
    s_cmp_ge_u32 s3, 6
    s_cselect_b32 s69, 1, 0
    s_mul_i32 s70, s69, 6
    s_sub_u32 s70, s3, s70
    s_lshl_b32 s70, s70, 4
    s_add_u32 s70, s70, s68
    s_lshl_b32 s71, s52, 2
    s_add_u32 s70, s70, s71
    s_cmp_lt_u32 s3, 12
    s_cselect_b32 s70, s70, 1000
    v_add_u32 v10, s70, v8
    v_mul_u32_u24 v11, 1280, v10
    v_lshl_add_u32 v11, v7, 4, v11
    s_mov_b32 s74, 819200
    s_mov_b32 s75, 0x20000
    s_lshl_b32 s71, s64, 2
    s_add_u32 s71, s71, s52
    s_lshl_b32 s71, s71, 4
    v_add_u32 v9, s60, v0
    v_add_u32 v13, s71, v7
    v_cmp_eq_u32 vcc, 3, v8
    s_nop 1
    v_cndmask_b32 v9, v9, v13, vcc
    v_lshlrev_b32 v9, 1, v9
    s_waitcnt lgkmcnt(0)
    s_nop 0
    buffer_load_ushort v16, v9, s[40:43], 0 offen
    buffer_load_ushort v17, v9, s[44:47], 0 offen
    buffer_load_ushort v18, v9, s[48:51], 0 offen
    buffer_load_dword v255, v255, s[8:11], 0 offen sc1
    buffer_load_dwordx2 v[240:241], v12, s[4:7], 0 offen offset:0
    buffer_load_dwordx2 v[242:243], v12, s[4:7], 0 offen offset:256
    buffer_load_dwordx2 v[244:245], v12, s[4:7], 0 offen offset:512
    buffer_load_dwordx2 v[246:247], v12, s[4:7], 0 offen offset:768
    buffer_load_dwordx2 v[248:249], v12, s[4:7], 0 offen offset:1024
    s_cmp_ge_u32 s3, 6
    s_cselect_b32 s72, s28, s24
    s_cselect_b32 s73, s29, s25
    buffer_load_dwordx4 v[32:35], v11, s[72:75], 0 offen offset:0
    buffer_load_dwordx4 v[36:39], v11, s[72:75], 0 offen offset:256
    buffer_load_dwordx4 v[40:43], v11, s[72:75], 0 offen offset:512
    buffer_load_dwordx4 v[44:47], v11, s[72:75], 0 offen offset:768
    buffer_load_dwordx4 v[48:51], v11, s[72:75], 0 offen offset:1024
    v_min_u32 v13, 9, v7
    v_lshlrev_b32 v13, 7, v13
    global_load_dword v28, v13, s[14:15]
    global_load_dword v29, v13, s[16:17]
    s_branch L_s5
L_ffn:
    v_mul_u32_u24 v10, 1280, v11
    v_add_u32 v10, v10, v8
    s_mov_b32 s56, 40960
    s_mov_b32 s57, 81920
    s_mov_b32 s58, 122880
    s_lshl_b32 s70, s61, 2
    v_lshrrev_b32 v12, 4, v0
    v_add_u32 v12, s70, v12
    v_and_b32 v1, 7, v0
    v_xor_b32 v1, v1, v12
    v_lshlrev_b32 v1, 4, v1
    s_lshl_b32 s70, s53, 4
    s_add_u32 s70, s70, s52
    s_lshl_b32 s70, s70, 3
    v_add_u32 v12, s70, v11
    v_mul_u32_u24 v12, 1280, v12
    v_add_u32 v1, v1, v12
    s_lshl_b32 s70, s52, 3
    v_add_u32 v12, s70, v11
    v_mul_u32_u24 v12, 3456, v12
    v_bfe_u32 v13, v0, 4, 1
    v_lshlrev_b32 v13, 2, v13
    v_and_b32 v2, 7, v0
    v_xor_b32 v2, v2, v13
    v_lshl_add_u32 v2, v2, 4, v12
    s_mul_i32 s60, s54, 384
    v_bfe_u32 v12, v0, 1, 3
    v_lshrrev_b32 v3, 5, v0
    v_xor_b32 v12, v12, v3
    v_and_b32 v3, 31, v0
    v_lshlrev_b32 v3, 7, v3
    v_lshl_add_u32 v3, v12, 4, v3
    s_lshl_b32 s70, s61, 13
    s_add_u32 s70, s70, 40960
    v_add_u32 v3, s70, v3
    v_xor_b32 v4, 32, v3
    v_xor_b32 v5, 64, v3
    v_xor_b32 v6, 96, v3
    v_lshrrev_b32 v11, 5, v0
    v_bfe_u32 v12, v0, 2, 2
    v_lshl_add_u32 v11, v11, 3, v12
    v_lshlrev_b32 v11, 7, v11
    v_bfe_u32 v12, v0, 3, 1
    v_lshl_add_u32 v11, v12, 6, v11
    v_bfe_u32 v12, v0, 4, 1
    v_lshl_add_u32 v11, v12, 5, v11
    v_and_b32 v12, 3, v0
    v_lshl_add_u32 v11, v12, 3, v11
    s_mul_i32 s70, s62, 3
    s_add_u32 s70, s70, 0
    s_add_u32 m0, s59, 40960
    s_nop 0
    buffer_load_dwordx4 v1, s[4:7], 0 offen offset:0 lds
    s_and_b32 s71, s70, 1
    s_lshl_b32 s71, s71, 6
    s_lshr_b32 s70, s70, 1
    s_lshl_b32 s70, s70, 13
    s_add_u32 s70, s70, 57344
    v_xor_b32 v7, s71, v11
    v_add_u32 v7, s70, v7
    s_mul_i32 s70, s62, 3
    s_add_u32 s70, s70, 1
    s_and_b32 s71, s70, 1
    s_lshl_b32 s71, s71, 6
    s_lshr_b32 s70, s70, 1
    s_lshl_b32 s70, s70, 13
    s_add_u32 s70, s70, 57344
    v_xor_b32 v8, s71, v11
    v_add_u32 v8, s70, v8
    s_mul_i32 s70, s62, 3
    s_add_u32 s70, s70, 2
    s_and_b32 s71, s70, 1
    s_lshl_b32 s71, s71, 6
    s_lshr_b32 s70, s70, 1
    s_lshl_b32 s70, s70, 13
    s_add_u32 s70, s70, 57344
    v_xor_b32 v9, s71, v11
    s_add_u32 m0, s59, 57344
    s_nop 0
    buffer_load_dwordx4 v2, s[24:27], s60 offen offset:0 lds
    v_add_u32 v9, s70, v9
    v_lshrrev_b32 v216, 5, v0
    v_lshlrev_b32 v216, 4, v216
    v_bfe_u32 v12, v0, 2, 3
    v_add_u32 v216, v216, v12
    v_lshrrev_b32 v12, 1, v12
    v_lshlrev_b32 v12, 5, v12
    v_lshl_add_u32 v216, v216, 7, v12
    v_and_b32 v12, 3, v0
    v_lshl_add_u32 v216, v12, 3, v216
    s_lshl_b32 s70, s52, 5
    v_xor_b32 v217, s70, v216
    s_lshl_b32 s70, s52, 12
    v_add_u32 v216, s70, v216
    v_mov_b32 v160, 0x3f803f80
    v_mov_b32 v161, 0x3f803f80
    v_mov_b32 v162, 0x3f803f80
    v_mov_b32 v163, 0x3f803f80
    v_lshlrev_b32 v14, 4, v0
    v_add_u32 v15, 4096, v14
    s_lshl_b32 s77, s19, 6
    s_lshl_b32 s21, s52, 4
    s_add_u32 s77, s77, s21
    s_lshl_b32 s77, s77, 5
    s_add_u32 m0, s59, 65408
    s_nop 0
    buffer_load_dwordx4 v2, s[24:27], s60 offen offset:128 lds
    s_lshl_b32 s21, s18, 3
    s_add_u32 s77, s77, s21
    s_add_u32 s77, s77, 16842752
    s_cmp_lt_u32 s3, 12
    s_cselect_b32 s77, s77, 1073741824
    v_lshlrev_b32 v218, 5, v0
    s_lshl_b32 s18, s54, 4
    s_add_u32 s18, s18, s53
    s_mul_i32 s72, s18, 4682
    s_lshr_b32 s72, s72, 16
    s_mul_i32 s19, s72, 14
    s_sub_u32 s19, s18, s19
    s_lshl_b32 s20, s19, 2
    s_add_u32 s20, s20, s52
    s_mul_i32 s21, s20, 3641
    s_lshr_b32 s21, s21, 16
    s_mul_i32 s70, s21, 18
    s_sub_u32 s70, s20, s70
    s_mul_i32 s70, s70, 3
    s_add_u32 s70, s70, s21
    s_mul_i32 s64, s70, 40960
    s_lshl_b32 s70, s72, 7
    s_add_u32 s64, s64, s70
    s_and_b32 s65, s20, 7
    s_add_u32 m0, s59, 45056
    s_nop 0
    buffer_load_dwordx4 v1, s[4:7], s56 offen offset:0 lds
    s_mul_i32 s65, s65, 12
    s_lshr_b32 s70, s20, 3
    s_add_u32 s65, s65, s70
    s_mul_i32 s65, s65, 5120
    s_lshl_b32 s21, s72, 12
    s_add_u32 s65, s65, s21
    s_add_u32 s65, s65, 12582912
    s_cmp_lt_u32 s20, 54
    s_cselect_b32 s21, s18, 200
    s_cmp_lt_u32 s21, 140
    s_cselect_b32 s65, s65, 1073741824
    s_cselect_b32 s64, s64, 1073741824
    s_lshl_b32 s73, s52, 12
    s_and_b32 s21, s20, 7
    s_lshl_b32 s21, s21, 3
    s_add_u32 s21, s21, s70
    s_lshl_b32 s70, s72, 6
    s_add_u32 s21, s21, s70
    s_lshl_b32 s21, s21, 2
    s_add_u32 s21, s21, 17563648
    v_lshlrev_b32 v231, 12, v0
    s_cmp_lt_u32 s18, 140
    s_cselect_b32 s51, s21, 1073741824
    s_lshl_b32 s70, s72, 2
    s_add_u32 m0, s59, 73472
    s_nop 0
    buffer_load_dwordx4 v2, s[24:27], s60 offen offset:256 lds
    s_add_u32 s60, s60, 110592
    s_add_u32 s70, s70, 0
    s_mul_i32 s70, s70, 52
    s_lshr_b32 s70, s70, 8
    s_mul_i32 s70, s70, 486400
    v_add_u32 v232, s70, v14
    s_lshl_b32 s70, s72, 2
    s_add_u32 s70, s70, 1
    s_mul_i32 s70, s70, 52
    s_lshr_b32 s70, s70, 8
    s_mul_i32 s70, s70, 486400
    v_add_u32 v233, s70, v14
    s_lshl_b32 s70, s72, 2
    s_add_u32 s70, s70, 2
    s_mul_i32 s70, s70, 52
    s_lshr_b32 s70, s70, 8
    s_mul_i32 s70, s70, 486400
    v_add_u32 v234, s70, v14
    s_lshl_b32 s70, s72, 2
    s_add_u32 s70, s70, 3
    s_mul_i32 s70, s70, 52
    s_lshr_b32 s70, s70, 8
    s_mul_i32 s70, s70, 486400
    v_add_u32 v235, s70, v14
    s_and_b32 s18, s2, 6
    s_add_u32 m0, s59, 49152
    s_nop 0
    buffer_load_dwordx4 v1, s[4:7], s57 offen offset:0 lds
    s_lshl_b32 s18, s18, 1
    s_lshr_b32 s19, s2, 2
    s_and_b32 s19, s19, 2
    s_lshr_b32 s20, s2, 6
    s_xor_b32 s19, s19, s20
    s_add_u32 s18, s18, s19
    s_lshl_b32 s18, s18, 1
    s_and_b32 s20, s2, 1
    s_add_u32 s18, s18, s20
    s_xor_b32 s19, s18, 1
    s_lshr_b32 s50, s18, 1
    s_lshl_b32 s50, s50, 12
    s_add_u32 s50, s50, 17563648
    s_lshl_b32 s20, s20, 2
    s_add_u32 s20, s20, s52
    s_cmp_ge_u32 s20, 6
    s_cselect_b32 s3, 1073741824, 0
    s_lshl_b32 s49, s20, 5
    s_add_u32 s49, s49, s50
    s_lshl_b32 s21, s19, 3
    s_add_u32 s21, s21, s20
    s_mul_i32 s40, s21, 49152
    s_lshl_b32 s42, s21, 6
    s_add_u32 s42, s42, 17317888
    s_add_u32 m0, s59, 61440
    s_nop 0
    buffer_load_dwordx4 v2, s[24:27], s60 offen offset:0 lds
    s_lshl_b32 s21, s18, 3
    s_add_u32 s21, s21, s20
    s_mul_i32 s41, s21, 49152
    s_lshl_b32 s43, s21, 6
    s_add_u32 s43, s43, 17317888
    s_bfe_u32 s21, s2, 0x30003
    s_mul_i32 s47, s21, 160
    s_lshl_b32 s63, s21, 3
    s_add_u32 s63, s63, s20
    s_mul_i32 s63, s63, 61440
    s_add_u32 s63, s63, 12582912
    s_mul_i32 s20, s21, 5
    s_lshr_b32 s20, s20, 2
    s_lshl_b32 s20, s20, 6
    s_add_u32 s50, s50, s20
    s_lshl_b32 s20, s20, 2
    s_add_u32 s49, s49, s20
    s_lshl_b32 s20, s52, 5
    s_add_u32 s50, s50, s20
    s_add_u32 s50, s50, 3072
    s_lshl_b32 s21, s21, 2
    s_add_u32 s21, s21, s52
    s_lshl_b32 s20, s19, 5
    s_add_u32 s20, s20, s21
    s_add_u32 m0, s59, 69504
    s_nop 0
    buffer_load_dwordx4 v2, s[24:27], s60 offen offset:128 lds
    s_mul_i32 s44, s20, 6272
    s_add_u32 s44, s44, 17825792
    s_lshl_b32 s20, s18, 5
    s_add_u32 s20, s20, s21
    s_mul_i32 s45, s20, 6272
    s_add_u32 s45, s45, 17825792
    s_lshl_b32 s20, s18, 2
    s_add_u32 s20, s20, s52
    s_mul_i32 s46, s20, 20480
    s_add_u32 s46, s46, s47
    s_lshl_b32 s48, s20, 7
    s_add_u32 s48, s48, 16777216
    s_buffer_load_dword s66, s[8:11], s42 glc
    s_lshl_b32 s67, s54, 1
    s_add_u32 s67, s67, s62
    s_lshl_b32 s68, s53, 1
    s_add_u32 s68, s68, s61
    s_lshl_b32 s68, s68, 3
    s_add_u32 s18, s67, 0
    s_and_b32 s69, s18, 7
    s_add_u32 s69, s69, s68
    s_lshr_b32 s18, s18, 3
    s_lshl_b32 s21, s69, 4
    s_add_u32 s21, s21, s18
    s_add_u32 m0, s59, 53248
    s_nop 0
    buffer_load_dwordx4 v1, s[4:7], s58 offen offset:0 lds
    s_lshl_b32 s21, s21, 2
    s_add_u32 s21, s21, 17317888
    s_mul_i32 s69, s69, 12
    s_add_u32 s18, s18, s69
    s_lshl_b32 s18, s18, 12
    s_add_u32 s19, s67, 18
    s_and_b32 s69, s19, 7
    s_add_u32 s69, s69, s68
    s_lshr_b32 s19, s19, 3
    s_lshl_b32 s22, s69, 4
    s_add_u32 s22, s22, s19
    s_lshl_b32 s22, s22, 2
    s_add_u32 s22, s22, 17317888
    s_mul_i32 s69, s69, 12
    s_add_u32 s19, s19, s69
    s_lshl_b32 s19, s19, 12
    s_add_u32 s20, s67, 36
    s_and_b32 s69, s20, 7
    s_add_u32 s69, s69, s68
    s_lshr_b32 s20, s20, 3
    s_lshl_b32 s23, s69, 4
    s_add_u32 s23, s23, s20
    s_lshl_b32 s23, s23, 2
    s_add_u32 s23, s23, 17317888
    s_add_u32 m0, s59, 77568
    s_nop 0
    buffer_load_dwordx4 v2, s[24:27], s60 offen offset:256 lds
    s_add_u32 s60, s60, 110592
    s_mul_i32 s69, s69, 12
    s_add_u32 s20, s20, s69
    s_lshl_b32 s20, s20, 12
    s_lshl_b32 s74, s68, 6
    s_add_u32 s74, s74, 16777216
    s_mul_i32 s75, s67, 3072
    s_add_u32 s75, s75, 16842752
    v_and_b32 v12, 31, v0
    v_lshlrev_b32 v219, 3, v12
    v_lshrrev_b32 v220, 5, v0
    v_lshlrev_b32 v220, 4, v220
    v_lshl_add_u32 v220, v12, 5, v220
    v_bfe_u32 v11, v0, 4, 1
    v_lshlrev_b32 v11, 10, v11
    v_lshrrev_b32 v12, 5, v0
    v_lshl_add_u32 v11, v12, 8, v11
    v_and_b32 v12, 15, v0
    v_lshl_add_u32 v11, v12, 4, v11
    v_mov_b32 v190, 0
    v_mov_b32 v191, 0
    v_mov_b32 v194, 0
    v_mov_b32 v195, 0
    v_mov_b32 v198, 0
    v_mov_b32 v199, 0
    v_mov_b32 v202, 0
    v_mov_b32 v203, 0
    v_mov_b32 v206, 0
    v_mov_b32 v207, 0
    s_mov_b32 s36, -1
    s_mov_b32 s37, 0
    s_mov_b32 s38, 0x07060302
    s_mov_b32 s39, 0x05040302
    s_mov_b32 s76, 0x01000100
    s_waitcnt vmcnt(23)
    v_readfirstlane_b32 s55, v255
    s_nop 0
    s_mul_i32 s55, s55, 0x9e3779b1
    s_add_u32 s55, s55, 0x7f4a7c15
    v_mov_b32 v13, s55
    v_mov_b32 v250, 0
    v_mov_b32 v251, 0
    s_waitcnt vmcnt(22)
    v_dot2c_f32_bf16 v250, 0x3f803f80, v240
    v_dot2c_f32_bf16 v251, v240, v240
    v_dot2c_f32_bf16 v250, 0x3f803f80, v241
    v_dot2c_f32_bf16 v251, v241, v241
    s_waitcnt vmcnt(21)
    v_dot2c_f32_bf16 v250, 0x3f803f80, v242
    v_dot2c_f32_bf16 v251, v242, v242
    v_dot2c_f32_bf16 v250, 0x3f803f80, v243
    v_dot2c_f32_bf16 v251, v243, v243
    s_waitcnt vmcnt(20)
    v_dot2c_f32_bf16 v250, 0x3f803f80, v244
    v_dot2c_f32_bf16 v251, v244, v244
    s_add_u32 m0, s59, 81792
    s_nop 0
    buffer_load_dwordx4 v1, s[4:7], 0 offen offset:128 lds
    v_dot2c_f32_bf16 v250, 0x3f803f80, v245
    v_dot2c_f32_bf16 v251, v245, v245
    s_waitcnt vmcnt(20)
    v_dot2c_f32_bf16 v250, 0x3f803f80, v246
    v_dot2c_f32_bf16 v251, v246, v246
    v_dot2c_f32_bf16 v250, 0x3f803f80, v247
    v_dot2c_f32_bf16 v251, v247, v247
    s_waitcnt vmcnt(19)
    v_dot2c_f32_bf16 v250, 0x3f803f80, v248
    v_dot2c_f32_bf16 v251, v248, v248
    v_dot2c_f32_bf16 v250, 0x3f803f80, v249
    v_dot2c_f32_bf16 v251, v249, v249
    s_nop 1
    v_add_f32_dpp v250, v250, v250 row_ror:8 row_mask:0xf bank_mask:0xf
    v_add_f32_dpp v251, v251, v251 row_ror:8 row_mask:0xf bank_mask:0xf
    s_add_u32 m0, s59, 98304
    s_nop 0
    buffer_load_dwordx4 v2, s[24:27], s60 offen offset:0 lds
    v_add_f32_dpp v250, v250, v250 row_ror:4 row_mask:0xf bank_mask:0xf
    v_add_f32_dpp v251, v251, v251 row_ror:4 row_mask:0xf bank_mask:0xf
    s_nop 0
    v_add_f32_dpp v250, v250, v250 row_ror:2 row_mask:0xf bank_mask:0xf
    v_add_f32_dpp v251, v251, v251 row_ror:2 row_mask:0xf bank_mask:0xf
    s_nop 0
    v_add_f32_dpp v250, v250, v250 row_ror:1 row_mask:0xf bank_mask:0xf
    v_add_f32_dpp v251, v251, v251 row_ror:1 row_mask:0xf bank_mask:0xf
    v_mov_b32 v252, v250
    v_mov_b32 v253, v251
    s_nop 0
    v_permlane16_swap_b32 v250, v252
    v_permlane16_swap_b32 v251, v253
    s_add_u32 m0, s59, 106368
    s_nop 0
    buffer_load_dwordx4 v2, s[24:27], s60 offen offset:128 lds
    v_add_f32 v250, v250, v252
    v_add_f32 v251, v251, v253
    v_mul_f32 v250, 0x3acccccd, v250
    v_mul_f32 v251, 0x3acccccd, v251
    v_fma_f32 v251, -v250, v250, v251
    v_max_f32 v251, 0, v251
    v_cvt_pk_bf16_f32 v251, v251, v251
    v_and_b32 v251, 0xffff0000, v251
    v_add_f32 v251, 0x3727c5ac, v251
    v_cvt_pk_bf16_f32 v251, v251, v251
    v_and_b32 v251, 0xffff0000, v251
    v_sqrt_f32 v251, v251
    s_add_u32 m0, s59, 85888
    s_nop 0
    buffer_load_dwordx4 v1, s[4:7], s56 offen offset:128 lds
    v_mov_b32 v253, s55
    v_lshlrev_b32 v254, 3, v254
    v_cvt_pk_bf16_f32 v252, -v250, v251
    s_mov_b32 s70, 16777216
    s_mov_b32 exec_lo, 1
    s_mov_b32 exec_hi, 1
    buffer_store_dwordx2 v[252:253], v254, s[8:11], s70 offen sc1
    s_mov_b64 exec, -1
    s_waitcnt vmcnt(18) lgkmcnt(0)
    s_barrier
    ds_read_b64_tr_b16 v[168:169], v217 offset:0
    s_add_u32 m0, s59, 114432
    s_nop 0
    s_nop 0
    buffer_load_dwordx4 v2, s[24:27], s60 offen offset:256 lds
    s_add_u32 s60, s60, 110592
    ds_read_b64_tr_b16 v[170:171], v217 offset:1024
    ds_read_b64_tr_b16 v[172:173], v217 offset:4096
    ds_read_b64_tr_b16 v[174:175], v217 offset:5120
    ds_read_b64_tr_b16 v[176:177], v217 offset:8192
    ds_read_b64_tr_b16 v[178:179], v217 offset:9216
    ds_read_b64_tr_b16 v[180:181], v217 offset:12288
    ds_read_b64_tr_b16 v[182:183], v217 offset:13312
    ds_read_b64_tr_b16 v[184:185], v217 offset:16384
    ds_read_b64_tr_b16 v[186:187], v217 offset:17408
    s_waitcnt lgkmcnt(8)
    v_mfma_f32_16x16x32_bf16 v[164:167], v[160:163], v[168:171], 0
    s_waitcnt lgkmcnt(6)
    v_mfma_f32_16x16x32_bf16 v[164:167], v[160:163], v[172:175], v[164:167]
    s_waitcnt lgkmcnt(4)
    v_mfma_f32_16x16x32_bf16 v[164:167], v[160:163], v[176:179], v[164:167]
    s_add_u32 m0, s59, 89984
    s_nop 0
    buffer_load_dwordx4 v1, s[4:7], s57 offen offset:128 lds
    s_waitcnt lgkmcnt(2)
    v_mfma_f32_16x16x32_bf16 v[164:167], v[160:163], v[180:183], v[164:167]
    s_waitcnt lgkmcnt(0)
    v_mfma_f32_16x16x32_bf16 v[164:167], v[160:163], v[184:187], v[164:167]
    s_nop 7
    v_mov_b32 v165, v13
    s_mov_b64 exec, 0xffff
    buffer_store_dwordx2 v[164:165], v218, s[8:11], s77 offen sc1
    s_mov_b64 exec, -1
    s_add_u32 m0, s59, 102400
    s_nop 0
    buffer_load_dwordx4 v2, s[24:27], s60 offen offset:0 lds
    s_add_u32 m0, s59, 110464
    s_nop 0
    buffer_load_dwordx4 v2, s[24:27], s60 offen offset:128 lds
    s_add_u32 m0, s59, 94080
    s_nop 0
    buffer_load_dwordx4 v1, s[4:7], s58 offen offset:128 lds
    s_add_u32 m0, s59, 118528
    s_nop 0
    buffer_load_dwordx4 v2, s[24:27], s60 offen offset:256 lds
    s_add_u32 s60, s60, 110592
    s_waitcnt vmcnt(12)
    s_barrier
    s_nop 0
    ds_read_b128 v[112:115], v3 offset:0
    ds_read_b64_tr_b16 v[120:121], v7 offset:0
    ds_read_b64_tr_b16 v[122:123], v7 offset:512
    ds_read_b128 v[116:119], v3 offset:4096
    ds_read_b64_tr_b16 v[124:125], v8 offset:0
    ds_read_b64_tr_b16 v[126:127], v8 offset:512
    ds_read_b64_tr_b16 v[128:129], v9 offset:0
    ds_read_b64_tr_b16 v[130:131], v9 offset:512
    v_add_u32 v3, 40960, v3
    s_waitcnt lgkmcnt(5)
    s_nop 0
    v_mfma_f32_32x32x16_bf16 v[16:31], v[120:123], v[112:115], 0
    s_add_u32 m0, s73, 20480
    ds_read_b128 v[132:135], v4 offset:0
    ds_read_b64_tr_b16 v[140:141], v7 offset:2048
    buffer_load_dwordx4 v10, s[28:31], s64 offen lds
    s_add_u32 s64, s64, 10240
    s_waitcnt lgkmcnt(6)
    v_mfma_f32_32x32x16_bf16 v[32:47], v[120:123], v[116:119], 0
    s_waitcnt lgkmcnt(2)
    ds_read_b64_tr_b16 v[142:143], v7 offset:2560
    ds_read_b128 v[136:139], v4 offset:4096
    s_add_u32 m0, s73, 21504
    v_mfma_f32_32x32x16_bf16 v[48:63], v[124:127], v[112:115], 0
    ds_read_b64_tr_b16 v[144:145], v8 offset:2048
    ds_read_b64_tr_b16 v[146:147], v8 offset:2560
    buffer_load_dwordx4 v10, s[28:31], s64 offen lds
    s_add_u32 s64, s64, 10240
    v_mfma_f32_32x32x16_bf16 v[64:79], v[124:127], v[116:119], 0
    s_add_u32 m0, s73, 22528
    ds_read_b64_tr_b16 v[148:149], v9 offset:2048
    ds_read_b64_tr_b16 v[150:151], v9 offset:2560
    v_mfma_f32_32x32x16_bf16 v[80:95], v[128:131], v[112:115], 0
    buffer_load_dwordx4 v10, s[28:31], s64 offen lds
    v_add_u32 v4, 40960, v4
    s_add_u32 s64, s64, 10240
    v_mfma_f32_32x32x16_bf16 v[96:111], v[128:131], v[116:119], 0
    s_waitcnt lgkmcnt(4)
    s_add_u32 m0, s73, 23552
    v_mfma_f32_32x32x16_bf16 v[16:31], v[140:143], v[132:135], v[16:31]
    ds_read_b128 v[112:115], v5 offset:0
    ds_read_b64_tr_b16 v[120:121], v7 offset:4096
    buffer_load_dwordx4 v10, s[28:31], s64 offen lds
    s_add_u32 s64, s64, 10240
    v_mfma_f32_32x32x16_bf16 v[32:47], v[140:143], v[136:139], v[32:47]
    s_waitcnt lgkmcnt(2)
    ds_read_b64_tr_b16 v[122:123], v7 offset:4608
    ds_read_b128 v[116:119], v5 offset:4096
    s_add_u32 m0, s59, 122624
    v_mfma_f32_32x32x16_bf16 v[48:63], v[144:147], v[132:135], v[48:63]
    ds_read_b64_tr_b16 v[124:125], v8 offset:4096
    ds_read_b64_tr_b16 v[126:127], v8 offset:4608
    buffer_load_dwordx4 v1, s[4:7], 0 offen offset:256 lds
    v_mfma_f32_32x32x16_bf16 v[64:79], v[144:147], v[136:139], v[64:79]
    s_add_u32 m0, s59, 139264
    ds_read_b64_tr_b16 v[128:129], v9 offset:4096
    ds_read_b64_tr_b16 v[130:131], v9 offset:4608
    v_mfma_f32_32x32x16_bf16 v[80:95], v[148:151], v[132:135], v[80:95]
    buffer_load_dwordx4 v2, s[24:27], s60 offen offset:0 lds
    v_add_u32 v5, 40960, v5
    v_mfma_f32_32x32x16_bf16 v[96:111], v[148:151], v[136:139], v[96:111]
    s_waitcnt lgkmcnt(4)
    v_mfma_f32_32x32x16_bf16 v[16:31], v[120:123], v[112:115], v[16:31]
    s_add_u32 m0, s59, 147328
    ds_read_b128 v[132:135], v6 offset:0
    ds_read_b64_tr_b16 v[140:141], v7 offset:6144
    v_mfma_f32_32x32x16_bf16 v[32:47], v[120:123], v[116:119], v[32:47]
    s_waitcnt lgkmcnt(2)
    ds_read_b64_tr_b16 v[142:143], v7 offset:6656
    ds_read_b128 v[136:139], v6 offset:4096
    buffer_load_dwordx4 v2, s[24:27], s60 offen offset:128 lds
    v_mfma_f32_32x32x16_bf16 v[48:63], v[124:127], v[112:115], v[48:63]
    s_add_u32 m0, s59, 126720
    ds_read_b64_tr_b16 v[144:145], v8 offset:6144
    ds_read_b64_tr_b16 v[146:147], v8 offset:6656
    v_mfma_f32_32x32x16_bf16 v[64:79], v[124:127], v[116:119], v[64:79]
    ds_read_b64_tr_b16 v[148:149], v9 offset:6144
    ds_read_b64_tr_b16 v[150:151], v9 offset:6656
    buffer_load_dwordx4 v1, s[4:7], s56 offen offset:256 lds
    v_add_u32 v6, 40960, v6
    v_mfma_f32_32x32x16_bf16 v[80:95], v[128:131], v[112:115], v[80:95]
    s_add_u32 m0, s59, 155392
    v_add_u32 v7, 40960, v7
    v_add_u32 v8, 40960, v8
    v_add_u32 v9, 40960, v9
    v_mfma_f32_32x32x16_bf16 v[96:111], v[128:131], v[116:119], v[96:111]
    s_waitcnt lgkmcnt(4)
    buffer_load_dwordx4 v2, s[24:27], s60 offen offset:256 lds
    s_add_u32 s60, s60, 110592
    v_mfma_f32_32x32x16_bf16 v[16:31], v[140:143], v[132:135], v[16:31]
    s_add_u32 m0, s59, 130816
    v_mfma_f32_32x32x16_bf16 v[32:47], v[140:143], v[136:139], v[32:47]
    s_waitcnt vmcnt(9) lgkmcnt(0)
    s_barrier
    ds_read_b128 v[112:115], v3 offset:0
    ds_read_b64_tr_b16 v[120:121], v7 offset:0
    buffer_load_dwordx4 v1, s[4:7], s57 offen offset:256 lds
    v_mfma_f32_32x32x16_bf16 v[48:63], v[144:147], v[132:135], v[48:63]
    s_add_u32 m0, s59, 143360
    ds_read_b64_tr_b16 v[122:123], v7 offset:512
    ds_read_b128 v[116:119], v3 offset:4096
    v_mfma_f32_32x32x16_bf16 v[64:79], v[144:147], v[136:139], v[64:79]
    ds_read_b64_tr_b16 v[124:125], v8 offset:0
    ds_read_b64_tr_b16 v[126:127], v8 offset:512
    buffer_load_dwordx4 v2, s[24:27], s60 offen offset:0 lds
    v_mfma_f32_32x32x16_bf16 v[80:95], v[148:151], v[132:135], v[80:95]
    s_add_u32 m0, s59, 151424
    ds_read_b64_tr_b16 v[128:129], v9 offset:0
    ds_read_b64_tr_b16 v[130:131], v9 offset:512
    v_mfma_f32_32x32x16_bf16 v[96:111], v[148:151], v[136:139], v[96:111]
    s_waitcnt lgkmcnt(4)
    buffer_load_dwordx4 v2, s[24:27], s60 offen offset:128 lds
    v_add_u32 v3, 40960, v3
    v_mfma_f32_32x32x16_bf16 v[16:31], v[120:123], v[112:115], v[16:31]
    s_add_u32 m0, s59, 134912
    ds_read_b128 v[132:135], v4 offset:0
    ds_read_b64_tr_b16 v[140:141], v7 offset:2048
    v_mfma_f32_32x32x16_bf16 v[32:47], v[120:123], v[116:119], v[32:47]
    s_waitcnt lgkmcnt(2)
    ds_read_b64_tr_b16 v[142:143], v7 offset:2560
    ds_read_b128 v[136:139], v4 offset:4096
    v_mfma_f32_32x32x16_bf16 v[48:63], v[124:127], v[112:115], v[48:63]
    ds_read_b64_tr_b16 v[144:145], v8 offset:2048
    ds_read_b64_tr_b16 v[146:147], v8 offset:2560
    buffer_load_dwordx4 v1, s[4:7], s58 offen offset:256 lds
    v_mfma_f32_32x32x16_bf16 v[64:79], v[124:127], v[116:119], v[64:79]
    s_add_u32 m0, s59, 159488
    ds_read_b64_tr_b16 v[148:149], v9 offset:2048
    ds_read_b64_tr_b16 v[150:151], v9 offset:2560
    v_mfma_f32_32x32x16_bf16 v[80:95], v[128:131], v[112:115], v[80:95]
    buffer_load_dwordx4 v2, s[24:27], s60 offen offset:256 lds
    v_add_u32 v4, 40960, v4
    s_add_u32 s60, s60, 110592
    v_mfma_f32_32x32x16_bf16 v[96:111], v[128:131], v[116:119], v[96:111]
    s_waitcnt lgkmcnt(4)
    s_add_u32 m0, s59, 40576
    v_mfma_f32_32x32x16_bf16 v[16:31], v[140:143], v[132:135], v[16:31]
    ds_read_b128 v[112:115], v5 offset:0
    ds_read_b64_tr_b16 v[120:121], v7 offset:4096
    buffer_load_dwordx4 v1, s[4:7], 0 offen offset:384 lds
    v_mfma_f32_32x32x16_bf16 v[32:47], v[140:143], v[136:139], v[32:47]
    s_waitcnt lgkmcnt(2)
    ds_read_b64_tr_b16 v[122:123], v7 offset:4608
    ds_read_b128 v[116:119], v5 offset:4096
    s_add_u32 m0, s59, 57344
    v_mfma_f32_32x32x16_bf16 v[48:63], v[144:147], v[132:135], v[48:63]
    ds_read_b64_tr_b16 v[124:125], v8 offset:4096
    ds_read_b64_tr_b16 v[126:127], v8 offset:4608
    buffer_load_dwordx4 v2, s[24:27], s60 offen offset:0 lds
    v_mfma_f32_32x32x16_bf16 v[64:79], v[144:147], v[136:139], v[64:79]
    s_add_u32 m0, s59, 65408
    ds_read_b64_tr_b16 v[128:129], v9 offset:4096
    ds_read_b64_tr_b16 v[130:131], v9 offset:4608
    v_mfma_f32_32x32x16_bf16 v[80:95], v[148:151], v[132:135], v[80:95]
    buffer_load_dwordx4 v2, s[24:27], s60 offen offset:128 lds
    v_add_u32 v5, 40960, v5
    v_mfma_f32_32x32x16_bf16 v[96:111], v[148:151], v[136:139], v[96:111]
    s_waitcnt lgkmcnt(4)
    v_mfma_f32_32x32x16_bf16 v[16:31], v[120:123], v[112:115], v[16:31]
    s_add_u32 m0, s59, 44672
    ds_read_b128 v[132:135], v6 offset:0
    ds_read_b64_tr_b16 v[140:141], v7 offset:6144
    v_mfma_f32_32x32x16_bf16 v[32:47], v[120:123], v[116:119], v[32:47]
    s_waitcnt lgkmcnt(2)
    s_nop 0
    ds_read_b64_tr_b16 v[142:143], v7 offset:6656
    ds_read_b128 v[136:139], v6 offset:4096
    buffer_load_dwordx4 v1, s[4:7], s56 offen offset:384 lds
    v_mfma_f32_32x32x16_bf16 v[48:63], v[124:127], v[112:115], v[48:63]
    s_add_u32 m0, s59, 73472
    ds_read_b64_tr_b16 v[144:145], v8 offset:6144
    ds_read_b64_tr_b16 v[146:147], v8 offset:6656
    v_mfma_f32_32x32x16_bf16 v[64:79], v[124:127], v[116:119], v[64:79]
    ds_read_b64_tr_b16 v[148:149], v9 offset:6144
    ds_read_b64_tr_b16 v[150:151], v9 offset:6656
    buffer_load_dwordx4 v2, s[24:27], s60 offen offset:256 lds
    v_add_u32 v6, 40960, v6
    s_add_u32 s60, s60, 110592
    v_mfma_f32_32x32x16_bf16 v[80:95], v[128:131], v[112:115], v[80:95]
    s_add_u32 m0, s59, 48768
    v_add_u32 v7, 40960, v7
    v_add_u32 v8, 40960, v8
    v_add_u32 v9, 40960, v9
    v_mfma_f32_32x32x16_bf16 v[96:111], v[128:131], v[116:119], v[96:111]
    s_waitcnt lgkmcnt(4)
    buffer_load_dwordx4 v1, s[4:7], s57 offen offset:384 lds
    v_mfma_f32_32x32x16_bf16 v[16:31], v[140:143], v[132:135], v[16:31]
    s_add_u32 m0, s59, 61440
    v_mfma_f32_32x32x16_bf16 v[32:47], v[140:143], v[136:139], v[32:47]
    s_waitcnt vmcnt(6) lgkmcnt(0)
    s_barrier
    s_nop 0
    ds_read_b128 v[112:115], v3 offset:0
    ds_read_b64_tr_b16 v[120:121], v7 offset:0
    buffer_load_dwordx4 v2, s[24:27], s60 offen offset:0 lds
    v_mfma_f32_32x32x16_bf16 v[48:63], v[144:147], v[132:135], v[48:63]
    s_add_u32 m0, s59, 69504
    ds_read_b64_tr_b16 v[122:123], v7 offset:512
    ds_read_b128 v[116:119], v3 offset:4096
    v_xor_b32_e64 v12, 0, v216
    v_mfma_f32_32x32x16_bf16 v[64:79], v[144:147], v[136:139], v[64:79]
    ds_read_b64_tr_b16 v[124:125], v8 offset:0
    ds_read_b64_tr_b16 v[126:127], v8 offset:512
    buffer_load_dwordx4 v2, s[24:27], s60 offen offset:128 lds
    ds_read_b64_tr_b16 v[152:153], v12 offset:20480
    ds_read_b64_tr_b16 v[154:155], v12 offset:21504
    v_xor_b32_e64 v12, 32, v216
    v_mfma_f32_32x32x16_bf16 v[80:95], v[148:151], v[132:135], v[80:95]
    s_add_u32 m0, s59, 52864
    ds_read_b64_tr_b16 v[128:129], v9 offset:0
    ds_read_b64_tr_b16 v[130:131], v9 offset:512
    ds_read_b64_tr_b16 v[156:157], v12 offset:20480
    ds_read_b64_tr_b16 v[158:159], v12 offset:21504
    v_xor_b32 v12, 64, v216
    v_mfma_f32_32x32x16_bf16 v[96:111], v[148:151], v[136:139], v[96:111]
    s_waitcnt lgkmcnt(8)
    buffer_load_dwordx4 v1, s[4:7], s58 offen offset:384 lds
    ds_read_b64_tr_b16 v[160:161], v12 offset:20480
    ds_read_b64_tr_b16 v[162:163], v12 offset:21504
    v_subrev_u32 v3, 81920, v3
    v_xor_b32 v12, 96, v216
    v_mfma_f32_32x32x16_bf16 v[16:31], v[120:123], v[112:115], v[16:31]
    s_add_u32 m0, s59, 77568
    ds_read_b128 v[132:135], v4 offset:0
    ds_read_b64_tr_b16 v[140:141], v7 offset:2048
    ds_read_b64_tr_b16 v[164:165], v12 offset:20480
    ds_read_b64_tr_b16 v[166:167], v12 offset:21504
    v_mfma_f32_32x32x16_bf16 v[32:47], v[120:123], v[116:119], v[32:47]
    s_waitcnt lgkmcnt(8)
    s_nop 0
    ds_read_b64_tr_b16 v[142:143], v7 offset:2560
    ds_read_b128 v[136:139], v4 offset:4096
    buffer_store_dwordx4 v[152:155], v232, s[8:11], s65 offen offset:0 sc1
    v_mfma_f32_32x32x16_bf16 v[48:63], v[124:127], v[112:115], v[48:63]
    ds_read_b64_tr_b16 v[144:145], v8 offset:2048
    ds_read_b64_tr_b16 v[146:147], v8 offset:2560
    buffer_load_dwordx4 v2, s[24:27], s60 offen offset:256 lds
    s_add_u32 s60, s60, 110592
    v_mfma_f32_32x32x16_bf16 v[64:79], v[124:127], v[116:119], v[64:79]
    s_add_u32 m0, s59, 81408
    ds_read_b64_tr_b16 v[148:149], v9 offset:2048
    ds_read_b64_tr_b16 v[150:151], v9 offset:2560
    v_mfma_f32_32x32x16_bf16 v[80:95], v[128:131], v[112:115], v[80:95]
    buffer_load_dwordx4 v1, s[4:7], 0 offen offset:512 lds
    s_waitcnt lgkmcnt(12)
    buffer_store_dwordx4 v[156:159], v233, s[8:11], s65 offen offset:1024 sc1
    v_subrev_u32 v4, 81920, v4
    v_mfma_f32_32x32x16_bf16 v[96:111], v[128:131], v[116:119], v[96:111]
    s_waitcnt lgkmcnt(4)
    s_add_u32 m0, s59, 98304
    v_mfma_f32_32x32x16_bf16 v[16:31], v[140:143], v[132:135], v[16:31]
    ds_read_b128 v[112:115], v5 offset:0
    ds_read_b64_tr_b16 v[120:121], v7 offset:4096
    buffer_load_dwordx4 v2, s[24:27], s60 offen offset:0 lds
    v_mfma_f32_32x32x16_bf16 v[32:47], v[140:143], v[136:139], v[32:47]
    s_waitcnt lgkmcnt(2)
    s_nop 0
    ds_read_b64_tr_b16 v[122:123], v7 offset:4608
    ds_read_b128 v[116:119], v5 offset:4096
    buffer_store_dwordx4 v[160:163], v234, s[8:11], s65 offen offset:2048 sc1
    s_add_u32 m0, s59, 106368
    v_mfma_f32_32x32x16_bf16 v[48:63], v[144:147], v[132:135], v[48:63]
    ds_read_b64_tr_b16 v[124:125], v8 offset:4096
    ds_read_b64_tr_b16 v[126:127], v8 offset:4608
    buffer_load_dwordx4 v2, s[24:27], s60 offen offset:128 lds
    v_mfma_f32_32x32x16_bf16 v[64:79], v[144:147], v[136:139], v[64:79]
    s_add_u32 m0, s59, 85504
    ds_read_b64_tr_b16 v[128:129], v9 offset:4096
    ds_read_b64_tr_b16 v[130:131], v9 offset:4608
    v_mfma_f32_32x32x16_bf16 v[80:95], v[148:151], v[132:135], v[80:95]
    buffer_load_dwordx4 v1, s[4:7], s56 offen offset:512 lds
    buffer_store_dwordx4 v[164:167], v235, s[8:11], s65 offen offset:3072 sc1
    v_subrev_u32 v5, 81920, v5
    v_mfma_f32_32x32x16_bf16 v[96:111], v[148:151], v[136:139], v[96:111]
    s_waitcnt lgkmcnt(4)
    v_mfma_f32_32x32x16_bf16 v[16:31], v[120:123], v[112:115], v[16:31]
    s_add_u32 m0, s59, 114432
    ds_read_b128 v[132:135], v6 offset:0
    ds_read_b64_tr_b16 v[140:141], v7 offset:6144
    v_mfma_f32_32x32x16_bf16 v[32:47], v[120:123], v[116:119], v[32:47]
    s_waitcnt lgkmcnt(2)
    ds_read_b64_tr_b16 v[142:143], v7 offset:6656
    ds_read_b128 v[136:139], v6 offset:4096
    buffer_load_dwordx4 v2, s[24:27], s60 offen offset:256 lds
    s_add_u32 s60, s60, 110592
    v_mfma_f32_32x32x16_bf16 v[48:63], v[124:127], v[112:115], v[48:63]
    s_add_u32 m0, s59, 89600
    ds_read_b64_tr_b16 v[144:145], v8 offset:6144
    ds_read_b64_tr_b16 v[146:147], v8 offset:6656
    v_mfma_f32_32x32x16_bf16 v[64:79], v[124:127], v[116:119], v[64:79]
    ds_read_b64_tr_b16 v[148:149], v9 offset:6144
    ds_read_b64_tr_b16 v[150:151], v9 offset:6656
    buffer_load_dwordx4 v1, s[4:7], s57 offen offset:512 lds
    v_subrev_u32 v6, 81920, v6
    v_mfma_f32_32x32x16_bf16 v[80:95], v[128:131], v[112:115], v[80:95]
    s_add_u32 m0, s59, 102400
    v_subrev_u32 v7, 81920, v7
    v_subrev_u32 v8, 81920, v8
    v_subrev_u32 v9, 81920, v9
    v_mfma_f32_32x32x16_bf16 v[96:111], v[128:131], v[116:119], v[96:111]
    s_waitcnt lgkmcnt(4)
    buffer_load_dwordx4 v2, s[24:27], s60 offen offset:0 lds
    v_mfma_f32_32x32x16_bf16 v[16:31], v[140:143], v[132:135], v[16:31]
    s_add_u32 m0, s59, 110464
    v_mfma_f32_32x32x16_bf16 v[32:47], v[140:143], v[136:139], v[32:47]
    s_waitcnt vmcnt(10) lgkmcnt(0)
    s_barrier
    ds_read_b128 v[112:115], v3 offset:0
    ds_read_b64_tr_b16 v[120:121], v7 offset:0
    buffer_load_dwordx4 v2, s[24:27], s60 offen offset:128 lds
    v_mfma_f32_32x32x16_bf16 v[48:63], v[144:147], v[132:135], v[48:63]
    s_add_u32 m0, s59, 93696
    ds_read_b64_tr_b16 v[122:123], v7 offset:512
    ds_read_b128 v[116:119], v3 offset:4096
    v_mfma_f32_32x32x16_bf16 v[64:79], v[144:147], v[136:139], v[64:79]
    ds_read_b64_tr_b16 v[124:125], v8 offset:0
    ds_read_b64_tr_b16 v[126:127], v8 offset:512
    buffer_load_dwordx4 v1, s[4:7], s58 offen offset:512 lds
    v_mfma_f32_32x32x16_bf16 v[80:95], v[148:151], v[132:135], v[80:95]
    s_add_u32 m0, s59, 118528
    ds_read_b64_tr_b16 v[128:129], v9 offset:0
    ds_read_b64_tr_b16 v[130:131], v9 offset:512
    v_mfma_f32_32x32x16_bf16 v[96:111], v[148:151], v[136:139], v[96:111]
    s_waitcnt lgkmcnt(4)
    buffer_load_dwordx4 v2, s[24:27], s60 offen offset:256 lds
    v_add_u32 v3, 40960, v3
    s_add_u32 s60, s60, 110592
    v_mfma_f32_32x32x16_bf16 v[16:31], v[120:123], v[112:115], v[16:31]
    s_add_u32 m0, s59, 122240
    ds_read_b128 v[132:135], v4 offset:0
    ds_read_b64_tr_b16 v[140:141], v7 offset:2048
    v_mfma_f32_32x32x16_bf16 v[32:47], v[120:123], v[116:119], v[32:47]
    s_waitcnt lgkmcnt(2)
    ds_read_b64_tr_b16 v[142:143], v7 offset:2560
    ds_read_b128 v[136:139], v4 offset:4096
    v_mfma_f32_32x32x16_bf16 v[48:63], v[124:127], v[112:115], v[48:63]
    ds_read_b64_tr_b16 v[144:145], v8 offset:2048
    ds_read_b64_tr_b16 v[146:147], v8 offset:2560
    buffer_load_dwordx4 v1, s[4:7], 0 offen offset:640 lds
    v_mfma_f32_32x32x16_bf16 v[64:79], v[124:127], v[116:119], v[64:79]
    s_add_u32 m0, s59, 139264
    ds_read_b64_tr_b16 v[148:149], v9 offset:2048
    ds_read_b64_tr_b16 v[150:151], v9 offset:2560
    v_mfma_f32_32x32x16_bf16 v[80:95], v[128:131], v[112:115], v[80:95]
    buffer_load_dwordx4 v2, s[24:27], s60 offen offset:0 lds
    v_add_u32 v4, 40960, v4
    v_mfma_f32_32x32x16_bf16 v[96:111], v[128:131], v[116:119], v[96:111]
    s_waitcnt lgkmcnt(4)
    s_add_u32 m0, s59, 147328
    v_mfma_f32_32x32x16_bf16 v[16:31], v[140:143], v[132:135], v[16:31]
    ds_read_b128 v[112:115], v5 offset:0
    ds_read_b64_tr_b16 v[120:121], v7 offset:4096
    buffer_load_dwordx4 v2, s[24:27], s60 offen offset:128 lds
    v_mfma_f32_32x32x16_bf16 v[32:47], v[140:143], v[136:139], v[32:47]
    s_waitcnt lgkmcnt(2)
    ds_read_b64_tr_b16 v[122:123], v7 offset:4608
    ds_read_b128 v[116:119], v5 offset:4096
    s_add_u32 m0, s59, 126336
    v_mfma_f32_32x32x16_bf16 v[48:63], v[144:147], v[132:135], v[48:63]
    ds_read_b64_tr_b16 v[124:125], v8 offset:4096
    ds_read_b64_tr_b16 v[126:127], v8 offset:4608
    buffer_load_dwordx4 v1, s[4:7], s56 offen offset:640 lds
    v_mfma_f32_32x32x16_bf16 v[64:79], v[144:147], v[136:139], v[64:79]
    s_add_u32 m0, s59, 155392
    ds_read_b64_tr_b16 v[128:129], v9 offset:4096
    ds_read_b64_tr_b16 v[130:131], v9 offset:4608
    v_mfma_f32_32x32x16_bf16 v[80:95], v[148:151], v[132:135], v[80:95]
    s_waitcnt vmcnt(10)
    buffer_load_dwordx4 v2, s[24:27], s60 offen offset:256 lds
    s_mov_b64 exec, 0xffff
    buffer_store_dword v13, v231, s[8:11], s51 offen sc1
    s_mov_b64 exec, -1
    v_add_u32 v5, 40960, v5
    s_add_u32 s60, s60, 110592
    v_mfma_f32_32x32x16_bf16 v[96:111], v[148:151], v[136:139], v[96:111]
    s_waitcnt lgkmcnt(4)
    v_mfma_f32_32x32x16_bf16 v[16:31], v[120:123], v[112:115], v[16:31]
    s_add_u32 m0, s59, 130432
    ds_read_b128 v[132:135], v6 offset:0
    ds_read_b64_tr_b16 v[140:141], v7 offset:6144
    v_mfma_f32_32x32x16_bf16 v[32:47], v[120:123], v[116:119], v[32:47]
    s_waitcnt lgkmcnt(2)
    s_nop 0
    ds_read_b64_tr_b16 v[142:143], v7 offset:6656
    ds_read_b128 v[136:139], v6 offset:4096
    buffer_load_dwordx4 v1, s[4:7], s57 offen offset:640 lds
    v_mfma_f32_32x32x16_bf16 v[48:63], v[124:127], v[112:115], v[48:63]
    s_add_u32 m0, s59, 143360
    ds_read_b64_tr_b16 v[144:145], v8 offset:6144
    ds_read_b64_tr_b16 v[146:147], v8 offset:6656
    v_mfma_f32_32x32x16_bf16 v[64:79], v[124:127], v[116:119], v[64:79]
    ds_read_b64_tr_b16 v[148:149], v9 offset:6144
    ds_read_b64_tr_b16 v[150:151], v9 offset:6656
    buffer_load_dwordx4 v2, s[24:27], s60 offen offset:0 lds
    v_add_u32 v6, 40960, v6
    v_mfma_f32_32x32x16_bf16 v[80:95], v[128:131], v[112:115], v[80:95]
    s_add_u32 m0, s59, 151424
    v_add_u32 v7, 40960, v7
    v_add_u32 v8, 40960, v8
    v_add_u32 v9, 40960, v9
    v_mfma_f32_32x32x16_bf16 v[96:111], v[128:131], v[116:119], v[96:111]
    s_waitcnt lgkmcnt(4)
    buffer_load_dwordx4 v2, s[24:27], s60 offen offset:128 lds
    v_mfma_f32_32x32x16_bf16 v[16:31], v[140:143], v[132:135], v[16:31]
    s_add_u32 m0, s59, 134528
    v_mfma_f32_32x32x16_bf16 v[32:47], v[140:143], v[136:139], v[32:47]
    s_waitcnt vmcnt(9) lgkmcnt(0)
    s_barrier
    s_nop 0
    ds_read_b128 v[112:115], v3 offset:0
    ds_read_b64_tr_b16 v[120:121], v7 offset:0
    buffer_load_dwordx4 v1, s[4:7], s58 offen offset:640 lds
    v_mfma_f32_32x32x16_bf16 v[48:63], v[144:147], v[132:135], v[48:63]
    s_add_u32 m0, s59, 159488
    ds_read_b64_tr_b16 v[122:123], v7 offset:512
    ds_read_b128 v[116:119], v3 offset:4096
    v_mfma_f32_32x32x16_bf16 v[64:79], v[144:147], v[136:139], v[64:79]
    ds_read_b64_tr_b16 v[124:125], v8 offset:0
    ds_read_b64_tr_b16 v[126:127], v8 offset:512
    buffer_load_dwordx4 v2, s[24:27], s60 offen offset:256 lds
    s_add_u32 s60, s60, 110592
    v_mfma_f32_32x32x16_bf16 v[80:95], v[148:151], v[132:135], v[80:95]
    s_add_u32 m0, s59, 40192
    ds_read_b64_tr_b16 v[128:129], v9 offset:0
    ds_read_b64_tr_b16 v[130:131], v9 offset:512
    v_mfma_f32_32x32x16_bf16 v[96:111], v[148:151], v[136:139], v[96:111]
    s_waitcnt lgkmcnt(4)
    v_add_u32 v3, 40960, v3
    v_mfma_f32_32x32x16_bf16 v[16:31], v[120:123], v[112:115], v[16:31]
    ds_read_b128 v[132:135], v4 offset:0
    ds_read_b64_tr_b16 v[140:141], v7 offset:2048
    buffer_load_dwordx4 v1, s[4:7], 0 offen offset:768 lds
    buffer_load_dwordx2 v[168:169], v219, s[8:11], s74 offen offset:0 sc1
    v_mfma_f32_32x32x16_bf16 v[32:47], v[120:123], v[116:119], v[32:47]
    s_waitcnt lgkmcnt(2)
    ds_read_b64_tr_b16 v[142:143], v7 offset:2560
    ds_read_b128 v[136:139], v4 offset:4096
    s_add_u32 m0, s59, 57344
    v_mfma_f32_32x32x16_bf16 v[48:63], v[124:127], v[112:115], v[48:63]
    ds_read_b64_tr_b16 v[144:145], v8 offset:2048
    ds_read_b64_tr_b16 v[146:147], v8 offset:2560
    buffer_load_dwordx4 v2, s[24:27], s60 offen offset:0 lds
    v_mfma_f32_32x32x16_bf16 v[64:79], v[124:127], v[116:119], v[64:79]
    s_add_u32 m0, s59, 65408
    ds_read_b64_tr_b16 v[148:149], v9 offset:2048
    ds_read_b64_tr_b16 v[150:151], v9 offset:2560
    v_mfma_f32_32x32x16_bf16 v[80:95], v[128:131], v[112:115], v[80:95]
    buffer_load_dwordx4 v2, s[24:27], s60 offen offset:128 lds
    buffer_load_dwordx2 v[170:171], v219, s[8:11], s74 offen offset:256 sc1
    v_add_u32 v4, 40960, v4
    v_mfma_f32_32x32x16_bf16 v[96:111], v[128:131], v[116:119], v[96:111]
    s_waitcnt lgkmcnt(4)
    s_add_u32 m0, s59, 44288
    v_mfma_f32_32x32x16_bf16 v[16:31], v[140:143], v[132:135], v[16:31]
    ds_read_b128 v[112:115], v5 offset:0
    ds_read_b64_tr_b16 v[120:121], v7 offset:4096
    buffer_load_dwordx4 v1, s[4:7], s56 offen offset:768 lds
    v_mfma_f32_32x32x16_bf16 v[32:47], v[140:143], v[136:139], v[32:47]
    s_waitcnt lgkmcnt(2)
    ds_read_b64_tr_b16 v[122:123], v7 offset:4608
    ds_read_b128 v[116:119], v5 offset:4096
    s_add_u32 m0, s59, 73472
    v_mfma_f32_32x32x16_bf16 v[48:63], v[144:147], v[132:135], v[48:63]
    ds_read_b64_tr_b16 v[124:125], v8 offset:4096
    ds_read_b64_tr_b16 v[126:127], v8 offset:4608
    buffer_load_dwordx4 v2, s[24:27], s60 offen offset:256 lds
    buffer_load_dwordx4 v[172:175], v220, s[8:11], s75 offen offset:0 sc1
    s_add_u32 s60, s60, 110592
    v_mfma_f32_32x32x16_bf16 v[64:79], v[144:147], v[136:139], v[64:79]
    s_add_u32 m0, s59, 48384
    ds_read_b64_tr_b16 v[128:129], v9 offset:4096
    ds_read_b64_tr_b16 v[130:131], v9 offset:4608
    v_mfma_f32_32x32x16_bf16 v[80:95], v[148:151], v[132:135], v[80:95]
    buffer_load_dwordx4 v1, s[4:7], s57 offen offset:768 lds
    v_add_u32 v5, 40960, v5
    v_mfma_f32_32x32x16_bf16 v[96:111], v[148:151], v[136:139], v[96:111]
    s_waitcnt lgkmcnt(4)
    v_mfma_f32_32x32x16_bf16 v[16:31], v[120:123], v[112:115], v[16:31]
    s_add_u32 m0, s59, 61440
    ds_read_b128 v[132:135], v6 offset:0
    ds_read_b64_tr_b16 v[140:141], v7 offset:6144
    buffer_load_dwordx4 v[176:179], v220, s[8:11], s75 offen offset:1024 sc1
    v_mfma_f32_32x32x16_bf16 v[32:47], v[120:123], v[116:119], v[32:47]
    s_waitcnt lgkmcnt(2)
    ds_read_b64_tr_b16 v[142:143], v7 offset:6656
    ds_read_b128 v[136:139], v6 offset:4096
    buffer_load_dwordx4 v2, s[24:27], s60 offen offset:0 lds
    v_mfma_f32_32x32x16_bf16 v[48:63], v[124:127], v[112:115], v[48:63]
    s_add_u32 m0, s59, 69504
    ds_read_b64_tr_b16 v[144:145], v8 offset:6144
    ds_read_b64_tr_b16 v[146:147], v8 offset:6656
    v_mfma_f32_32x32x16_bf16 v[64:79], v[124:127], v[116:119], v[64:79]
    ds_read_b64_tr_b16 v[148:149], v9 offset:6144
    ds_read_b64_tr_b16 v[150:151], v9 offset:6656
    buffer_load_dwordx4 v2, s[24:27], s60 offen offset:128 lds
    v_add_u32 v6, 40960, v6
    v_mfma_f32_32x32x16_bf16 v[80:95], v[128:131], v[112:115], v[80:95]
    s_add_u32 m0, s59, 52480
    buffer_load_dwordx4 v[180:183], v220, s[8:11], s75 offen offset:2048 sc1
    v_add_u32 v7, 40960, v7
    v_add_u32 v8, 40960, v8
    v_add_u32 v9, 40960, v9
    v_mfma_f32_32x32x16_bf16 v[96:111], v[128:131], v[116:119], v[96:111]
    s_waitcnt lgkmcnt(4)
    buffer_load_dwordx4 v1, s[4:7], s58 offen offset:768 lds
    v_mfma_f32_32x32x16_bf16 v[16:31], v[140:143], v[132:135], v[16:31]
    s_add_u32 m0, s59, 77568
    v_mfma_f32_32x32x16_bf16 v[32:47], v[140:143], v[136:139], v[32:47]
    s_waitcnt vmcnt(14) lgkmcnt(0)
    s_barrier
    s_nop 0
    ds_read_b128 v[112:115], v3 offset:0
    ds_read_b64_tr_b16 v[120:121], v7 offset:0
    buffer_load_dwordx4 v2, s[24:27], s60 offen offset:256 lds
    s_add_u32 s60, s60, 110592
    v_mfma_f32_32x32x16_bf16 v[48:63], v[144:147], v[132:135], v[48:63]
    s_add_u32 m0, s59, 81024
    ds_read_b64_tr_b16 v[122:123], v7 offset:512
    ds_read_b128 v[116:119], v3 offset:4096
    v_mfma_f32_32x32x16_bf16 v[64:79], v[144:147], v[136:139], v[64:79]
    ds_read_b64_tr_b16 v[124:125], v8 offset:0
    ds_read_b64_tr_b16 v[126:127], v8 offset:512
    buffer_load_dwordx4 v1, s[4:7], 0 offen offset:896 lds
    v_mfma_f32_32x32x16_bf16 v[80:95], v[148:151], v[132:135], v[80:95]
    s_add_u32 m0, s59, 98304
    ds_read_b64_tr_b16 v[128:129], v9 offset:0
    ds_read_b64_tr_b16 v[130:131], v9 offset:512
    v_mfma_f32_32x32x16_bf16 v[96:111], v[148:151], v[136:139], v[96:111]
    s_waitcnt lgkmcnt(4)
    v_subrev_u32 v3, 81920, v3
    v_mfma_f32_32x32x16_bf16 v[16:31], v[120:123], v[112:115], v[16:31]
    ds_read_b128 v[132:135], v4 offset:0
    ds_read_b64_tr_b16 v[140:141], v7 offset:2048
    buffer_load_dwordx4 v2, s[24:27], s60 offen offset:0 lds
    v_mfma_f32_32x32x16_bf16 v[32:47], v[120:123], v[116:119], v[32:47]
    s_waitcnt lgkmcnt(2)
    ds_read_b64_tr_b16 v[142:143], v7 offset:2560
    ds_read_b128 v[136:139], v4 offset:4096
    s_add_u32 m0, s59, 106368
    v_mfma_f32_32x32x16_bf16 v[48:63], v[124:127], v[112:115], v[48:63]
    ds_read_b64_tr_b16 v[144:145], v8 offset:2048
    ds_read_b64_tr_b16 v[146:147], v8 offset:2560
    buffer_load_dwordx4 v2, s[24:27], s60 offen offset:128 lds
    v_mfma_f32_32x32x16_bf16 v[64:79], v[124:127], v[116:119], v[64:79]
    s_add_u32 m0, s59, 85120
    ds_read_b64_tr_b16 v[148:149], v9 offset:2048
    ds_read_b64_tr_b16 v[150:151], v9 offset:2560
    v_mfma_f32_32x32x16_bf16 v[80:95], v[128:131], v[112:115], v[80:95]
    buffer_load_dwordx4 v1, s[4:7], s56 offen offset:896 lds
    v_subrev_u32 v4, 81920, v4
    v_mfma_f32_32x32x16_bf16 v[96:111], v[128:131], v[116:119], v[96:111]
    s_waitcnt lgkmcnt(4)
    s_add_u32 m0, s59, 114432
    v_mfma_f32_32x32x16_bf16 v[16:31], v[140:143], v[132:135], v[16:31]
    ds_read_b128 v[112:115], v5 offset:0
    ds_read_b64_tr_b16 v[120:121], v7 offset:4096
    buffer_load_dwordx4 v2, s[24:27], s60 offen offset:256 lds
    s_add_u32 s60, s60, 110592
    v_mfma_f32_32x32x16_bf16 v[32:47], v[140:143], v[136:139], v[32:47]
    s_waitcnt lgkmcnt(2)
    ds_read_b64_tr_b16 v[122:123], v7 offset:4608
    ds_read_b128 v[116:119], v5 offset:4096
    s_add_u32 m0, s59, 89216
    v_mfma_f32_32x32x16_bf16 v[48:63], v[144:147], v[132:135], v[48:63]
    ds_read_b64_tr_b16 v[124:125], v8 offset:4096
    ds_read_b64_tr_b16 v[126:127], v8 offset:4608
    buffer_load_dwordx4 v1, s[4:7], s57 offen offset:896 lds
    v_mfma_f32_32x32x16_bf16 v[64:79], v[144:147], v[136:139], v[64:79]
    s_add_u32 m0, s59, 102400
    ds_read_b64_tr_b16 v[128:129], v9 offset:4096
    ds_read_b64_tr_b16 v[130:131], v9 offset:4608
    v_mfma_f32_32x32x16_bf16 v[80:95], v[148:151], v[132:135], v[80:95]
    buffer_load_dwordx4 v2, s[24:27], s60 offen offset:0 lds
    v_subrev_u32 v5, 81920, v5
    v_mfma_f32_32x32x16_bf16 v[96:111], v[148:151], v[136:139], v[96:111]
    s_waitcnt lgkmcnt(4)
    v_mfma_f32_32x32x16_bf16 v[16:31], v[120:123], v[112:115], v[16:31]
    s_add_u32 m0, s59, 110464
    ds_read_b128 v[132:135], v6 offset:0
    ds_read_b64_tr_b16 v[140:141], v7 offset:6144
    v_mfma_f32_32x32x16_bf16 v[32:47], v[120:123], v[116:119], v[32:47]
    s_waitcnt lgkmcnt(2)
    ds_read_b64_tr_b16 v[142:143], v7 offset:6656
    ds_read_b128 v[136:139], v6 offset:4096
    buffer_load_dwordx4 v2, s[24:27], s60 offen offset:128 lds
    v_mfma_f32_32x32x16_bf16 v[48:63], v[124:127], v[112:115], v[48:63]
    s_add_u32 m0, s59, 93312
    ds_read_b64_tr_b16 v[144:145], v8 offset:6144
    ds_read_b64_tr_b16 v[146:147], v8 offset:6656
    v_mfma_f32_32x32x16_bf16 v[64:79], v[124:127], v[116:119], v[64:79]
    ds_read_b64_tr_b16 v[148:149], v9 offset:6144
    ds_read_b64_tr_b16 v[150:151], v9 offset:6656
    buffer_load_dwordx4 v1, s[4:7], s58 offen offset:896 lds
    v_subrev_u32 v6, 81920, v6
    v_mfma_f32_32x32x16_bf16 v[80:95], v[128:131], v[112:115], v[80:95]
    s_add_u32 m0, s59, 118528
    v_subrev_u32 v7, 81920, v7
    v_subrev_u32 v8, 81920, v8
    v_subrev_u32 v9, 81920, v9
    v_mfma_f32_32x32x16_bf16 v[96:111], v[128:131], v[116:119], v[96:111]
    s_waitcnt lgkmcnt(4)
    buffer_load_dwordx4 v2, s[24:27], s60 offen offset:256 lds
    s_add_u32 s60, s60, 110592
    v_mfma_f32_32x32x16_bf16 v[16:31], v[140:143], v[132:135], v[16:31]
    s_add_u32 m0, s59, 121856
    s_waitcnt vmcnt(23)
    v_xor_b32 v12, s55, v169
    s_waitcnt vmcnt(20)
    v_bitop3_b32 v12, v12, v171, s55 bitop3:0xf6
    s_waitcnt vmcnt(17)
    v_bitop3_b32 v12, v12, v173, s55 bitop3:0xf6
    v_bitop3_b32 v12, v12, v175, s55 bitop3:0xf6
    v_mfma_f32_32x32x16_bf16 v[32:47], v[140:143], v[136:139], v[32:47]
    s_waitcnt vmcnt(10) lgkmcnt(0)
    s_barrier
    s_nop 0
    ds_read_b128 v[112:115], v3 offset:0
    ds_read_b64_tr_b16 v[120:121], v7 offset:0
    buffer_load_dwordx4 v1, s[4:7], 0 offen offset:1024 lds
    v_mfma_f32_32x32x16_bf16 v[48:63], v[144:147], v[132:135], v[48:63]
    s_add_u32 m0, s59, 139264
    ds_read_b64_tr_b16 v[122:123], v7 offset:512
    ds_read_b128 v[116:119], v3 offset:4096
    v_bitop3_b32 v12, v12, v177, s55 bitop3:0xf6
    v_bitop3_b32 v12, v12, v179, s55 bitop3:0xf6
    v_mfma_f32_32x32x16_bf16 v[64:79], v[144:147], v[136:139], v[64:79]
    ds_read_b64_tr_b16 v[124:125], v8 offset:0
    ds_read_b64_tr_b16 v[126:127], v8 offset:512
    buffer_load_dwordx4 v2, s[24:27], s60 offen offset:0 lds
    v_bitop3_b32 v12, v12, v181, s55 bitop3:0xf6
    v_mfma_f32_32x32x16_bf16 v[80:95], v[148:151], v[132:135], v[80:95]
    s_add_u32 m0, s59, 147328
    ds_read_b64_tr_b16 v[128:129], v9 offset:0
    ds_read_b64_tr_b16 v[130:131], v9 offset:512
    v_bitop3_b32 v12, v12, v183, s55 bitop3:0xf6
    v_mfma_f32_32x32x16_bf16 v[96:111], v[148:151], v[136:139], v[96:111]
    s_waitcnt lgkmcnt(4)
    v_add_u32 v3, 40960, v3
    v_cmp_ne_u32 vcc, 0, v12
    s_nop 3
    s_cbranch_vccnz L_spin_ext
L_ret_ext:
    v_cndmask_b32 v189, 0, v168, s[36:37]
    v_mfma_f32_32x32x16_bf16 v[16:31], v[120:123], v[112:115], v[16:31]
    ds_read_b128 v[132:135], v4 offset:0
    ds_read_b64_tr_b16 v[140:141], v7 offset:2048
    buffer_load_dwordx4 v2, s[24:27], s60 offen offset:128 lds
    v_perm_b32 v188, v189, v189, s76
    v_mfma_f32_32x32x16_bf16 v[32:47], v[120:123], v[116:119], v[32:47]
    s_waitcnt lgkmcnt(2)
    s_nop 0
    ds_read_b64_tr_b16 v[142:143], v7 offset:2560
    ds_read_b128 v[136:139], v4 offset:4096
    v_cndmask_b32 v193, 0, v170, s[36:37]
    s_add_u32 m0, s59, 125952
    v_mfma_f32_32x32x16_bf16 v[48:63], v[124:127], v[112:115], v[48:63]
    ds_read_b64_tr_b16 v[144:145], v8 offset:2048
    ds_read_b64_tr_b16 v[146:147], v8 offset:2560
    buffer_load_dwordx4 v1, s[4:7], s56 offen offset:1024 lds
    v_perm_b32 v192, v193, v193, s76
    v_mfma_f32_32x32x16_bf16 v[64:79], v[124:127], v[116:119], v[64:79]
    s_add_u32 m0, s59, 155392
    ds_read_b64_tr_b16 v[148:149], v9 offset:2048
    ds_read_b64_tr_b16 v[150:151], v9 offset:2560
    v_add_f32 v172, v172, v174
    v_add_f32 v176, v176, v178
    v_mfma_f32_32x32x16_bf16 v[80:95], v[128:131], v[112:115], v[80:95]
    buffer_load_dwordx4 v2, s[24:27], s60 offen offset:256 lds
    v_add_u32 v4, 40960, v4
    v_add_f32 v180, v180, v182
    s_add_u32 s60, s60, 110592
    v_mfma_f32_32x32x16_bf16 v[96:111], v[128:131], v[116:119], v[96:111]
    s_waitcnt lgkmcnt(4)
    v_mov_b32 v173, v172
    v_mov_b32 v177, v176
    v_mov_b32 v181, v180
    s_add_u32 m0, s59, 130048
    v_mfma_f32_32x32x16_bf16 v[16:31], v[140:143], v[132:135], v[16:31]
    ds_read_b128 v[112:115], v5 offset:0
    ds_read_b64_tr_b16 v[120:121], v7 offset:4096
    buffer_load_dwordx4 v1, s[4:7], s57 offen offset:1024 lds
    v_mfma_f32_32x32x16_bf16 v[32:47], v[140:143], v[136:139], v[32:47]
    s_waitcnt lgkmcnt(2)
    ds_read_b64_tr_b16 v[122:123], v7 offset:4608
    ds_read_b128 v[116:119], v5 offset:4096
    s_add_u32 m0, s59, 143360
    v_mfma_f32_32x32x16_bf16 v[48:63], v[144:147], v[132:135], v[48:63]
    ds_read_b64_tr_b16 v[124:125], v8 offset:4096
    ds_read_b64_tr_b16 v[126:127], v8 offset:4608
    buffer_load_dwordx4 v2, s[24:27], s60 offen offset:0 lds
    v_mfma_f32_32x32x16_bf16 v[64:79], v[144:147], v[136:139], v[64:79]
    s_add_u32 m0, s59, 151424
    ds_read_b64_tr_b16 v[128:129], v9 offset:4096
    ds_read_b64_tr_b16 v[130:131], v9 offset:4608
    v_permlane32_swap_b32 v172, v173
    v_mfma_f32_32x32x16_bf16 v[80:95], v[148:151], v[132:135], v[80:95]
    buffer_load_dwordx4 v2, s[24:27], s60 offen offset:128 lds
    v_add_u32 v5, 40960, v5
    v_add_f32 v172, v172, v173
    v_and_b32 v173, 0xffff0000, v172
    v_mfma_f32_32x32x16_bf16 v[96:111], v[148:151], v[136:139], v[96:111]
    s_waitcnt lgkmcnt(4)
    v_sub_f32 v173, v172, v173
    v_perm_b32 v196, v173, v172, s38
    v_and_b32 v172, 0xffff0000, v173
    v_sub_f32 v173, v173, v172
    v_mfma_f32_32x32x16_bf16 v[16:31], v[120:123], v[112:115], v[16:31]
    s_add_u32 m0, s59, 134144
    ds_read_b128 v[132:135], v6 offset:0
    ds_read_b64_tr_b16 v[140:141], v7 offset:6144
    v_perm_b32 v197, v236, v173, s39
    v_mfma_f32_32x32x16_bf16 v[32:47], v[120:123], v[116:119], v[32:47]
    s_waitcnt lgkmcnt(2)
    ds_read_b64_tr_b16 v[142:143], v7 offset:6656
    ds_read_b128 v[136:139], v6 offset:4096
    buffer_load_dwordx4 v1, s[4:7], s58 offen offset:1024 lds
    v_mfma_f32_32x32x16_bf16 v[48:63], v[124:127], v[112:115], v[48:63]
    s_add_u32 m0, s59, 159488
    ds_read_b64_tr_b16 v[144:145], v8 offset:6144
    ds_read_b64_tr_b16 v[146:147], v8 offset:6656
    v_permlane32_swap_b32 v176, v177
    s_nop 0
    v_mfma_f32_32x32x16_bf16 v[64:79], v[124:127], v[116:119], v[64:79]
    ds_read_b64_tr_b16 v[148:149], v9 offset:6144
    ds_read_b64_tr_b16 v[150:151], v9 offset:6656
    buffer_load_dwordx4 v2, s[24:27], s60 offen offset:256 lds
    v_add_u32 v6, 40960, v6
    s_add_u32 s60, s60, 110592
    v_mfma_f32_32x32x16_bf16 v[80:95], v[128:131], v[112:115], v[80:95]
    v_add_u32 v7, 40960, v7
    v_add_u32 v8, 40960, v8
    v_add_u32 v9, 40960, v9
    v_add_f32 v176, v176, v177
    v_mfma_f32_32x32x16_bf16 v[96:111], v[128:131], v[116:119], v[96:111]
    s_waitcnt lgkmcnt(4)
    v_and_b32 v217, 7, v0
    v_min_u32 v217, 6, v217
    v_and_b32 v218, 8, v0
    v_lshl_or_b32 v217, v218, 3, v217
    v_lshlrev_b32 v217, 2, v217
    v_mfma_f32_32x32x16_bf16 v[16:31], v[140:143], v[132:135], v[16:31]
    s_add_u32 m0, s59, 39808
    buffer_load_dword v217, v217, s[8:11], s49 offen sc1
    v_and_b32 v177, 0xffff0000, v176
    v_sub_f32 v177, v176, v177
    v_perm_b32 v200, v177, v176, s38
    v_mfma_f32_32x32x16_bf16 v[32:47], v[140:143], v[136:139], v[32:47]
    s_waitcnt vmcnt(11) lgkmcnt(0)
    s_barrier
    s_nop 0
    ds_read_b128 v[112:115], v3 offset:0
    ds_read_b64_tr_b16 v[120:121], v7 offset:0
    buffer_load_dwordx4 v1, s[4:7], 0 offen offset:1152 lds
    v_mfma_f32_32x32x16_bf16 v[48:63], v[144:147], v[132:135], v[48:63]
    s_add_u32 m0, s59, 57344
    ds_read_b64_tr_b16 v[122:123], v7 offset:512
    ds_read_b128 v[116:119], v3 offset:4096
    v_and_b32 v176, 0xffff0000, v177
    v_sub_f32_e64 v177, v177, v176
    v_mfma_f32_32x32x16_bf16 v[64:79], v[144:147], v[136:139], v[64:79]
    ds_read_b64_tr_b16 v[124:125], v8 offset:0
    ds_read_b64_tr_b16 v[126:127], v8 offset:512
    buffer_load_dwordx4 v2, s[24:27], s60 offen offset:0 lds
    v_perm_b32 v201, v237, v177, s39
    v_mfma_f32_32x32x16_bf16 v[80:95], v[148:151], v[132:135], v[80:95]
    s_add_u32 m0, s59, 65408
    ds_read_b64_tr_b16 v[128:129], v9 offset:0
    ds_read_b64_tr_b16 v[130:131], v9 offset:512
    v_permlane32_swap_b32 v180, v181
    v_mfma_f32_32x32x16_bf16 v[96:111], v[148:151], v[136:139], v[96:111]
    s_waitcnt lgkmcnt(4)
    buffer_load_dwordx4 v2, s[24:27], s60 offen offset:128 lds
    v_add_u32 v3, 40960, v3
    v_add_f32 v180, v180, v181
    v_and_b32 v181, 0xffff0000, v180
    v_mfma_f32_32x32x16_bf16 v[16:31], v[120:123], v[112:115], v[16:31]
    s_add_u32 m0, s59, 43904
    ds_read_b128 v[132:135], v4 offset:0
    ds_read_b64_tr_b16 v[140:141], v7 offset:2048
    v_sub_f32 v181, v180, v181
    v_perm_b32 v204, v181, v180, s38
    v_mfma_f32_32x32x16_bf16 v[32:47], v[120:123], v[116:119], v[32:47]
    s_waitcnt lgkmcnt(2)
    s_nop 0
    ds_read_b64_tr_b16 v[142:143], v7 offset:2560
    ds_read_b128 v[136:139], v4 offset:4096
    buffer_load_dwordx4 v1, s[4:7], s56 offen offset:1152 lds
    v_and_b32 v180, 0xffff0000, v181
    v_mfma_f32_32x32x16_bf16 v[48:63], v[124:127], v[112:115], v[48:63]
    s_add_u32 m0, s59, 73472
    ds_read_b64_tr_b16 v[144:145], v8 offset:2048
    ds_read_b64_tr_b16 v[146:147], v8 offset:2560
    v_sub_f32 v181, v181, v180
    v_perm_b32 v205, v238, v181, s39
    v_mfma_f32_32x32x16_bf16 v[64:79], v[124:127], v[116:119], v[64:79]
    ds_read_b64_tr_b16 v[148:149], v9 offset:2048
    ds_read_b64_tr_b16 v[150:151], v9 offset:2560
    buffer_load_dwordx4 v2, s[24:27], s60 offen offset:256 lds
    s_add_u32 s60, s60, 110592
    v_mfma_f32_32x32x16_bf16 v[80:95], v[128:131], v[112:115], v[80:95]
    s_add_u32 m0, s59, 48000
    v_add_u32 v4, 40960, v4
    v_and_b32 v212, 0xffff0000, v168
    v_and_b32 v213, 0xffff0000, v170
    v_mfma_f32_32x32x16_bf16 v[96:111], v[128:131], v[116:119], v[96:111]
    s_waitcnt lgkmcnt(4)
    buffer_load_dwordx4 v1, s[4:7], s57 offen offset:1152 lds
    v_rcp_f32 v169, v212
    v_mfma_f32_32x32x16_bf16 v[16:31], v[140:143], v[132:135], v[16:31]
    s_add_u32 m0, s59, 61440
    ds_read_b128 v[112:115], v5 offset:0
    ds_read_b64_tr_b16 v[120:121], v7 offset:4096
    v_rcp_f32 v171, v213
    v_mfma_f32_32x32x16_bf16 v[32:47], v[140:143], v[136:139], v[32:47]
    s_waitcnt lgkmcnt(2)
    ds_read_b64_tr_b16 v[122:123], v7 offset:4608
    ds_read_b128 v[116:119], v5 offset:4096
    v_mul_f32 v208, 0xc0135761, v169
    v_mul_f32 v12, v169, v169
    v_mfma_f32_32x32x16_bf16 v[48:63], v[144:147], v[132:135], v[48:63]
    ds_read_b64_tr_b16 v[124:125], v8 offset:4096
    ds_read_b64_tr_b16 v[126:127], v8 offset:4608
    buffer_load_dwordx4 v2, s[24:27], s60 offen offset:0 lds
    v_mul_f32_e64 v12, v12, v169
    v_mfma_f32_32x32x16_bf16 v[64:79], v[144:147], v[136:139], v[64:79]
    s_add_u32 m0, s59, 69504
    ds_read_b64_tr_b16 v[128:129], v9 offset:4096
    ds_read_b64_tr_b16 v[130:131], v9 offset:4608
    v_mul_f32 v210, 0xbdd2d3e8, v12
    v_mul_f32 v209, 0xc0135761, v171
    v_mfma_f32_32x32x16_bf16 v[80:95], v[148:151], v[132:135], v[80:95]
    buffer_load_dwordx4 v2, s[24:27], s60 offen offset:128 lds
    v_add_u32 v5, 40960, v5
    v_mul_f32 v12, v171, v171
    v_mul_f32 v12, v12, v171
    v_mfma_f32_32x32x16_bf16 v[96:111], v[148:151], v[136:139], v[96:111]
    s_waitcnt lgkmcnt(4)
    v_mul_f32 v211, 0xbdd2d3e8, v12
    s_add_u32 m0, s59, 52096
    v_mfma_f32_32x32x16_bf16 v[16:31], v[120:123], v[112:115], v[16:31]
    s_waitcnt vmcnt(8)
    ds_read_b128 v[132:135], v6 offset:0
    ds_read_b64_tr_b16 v[140:141], v7 offset:6144
    buffer_load_dwordx4 v1, s[4:7], s58 offen offset:1152 lds
    v_cmp_ne_u32 vcc, s55, v217
    v_mfma_f32_32x32x16_bf16 v[32:47], v[120:123], v[116:119], v[32:47]
    s_waitcnt lgkmcnt(2)
    ds_read_b64_tr_b16 v[142:143], v7 offset:6656
    ds_read_b128 v[136:139], v6 offset:4096
    s_add_u32 m0, s59, 77568
    v_mfma_f32_32x32x16_bf16 v[48:63], v[124:127], v[112:115], v[48:63]
    ds_read_b64_tr_b16 v[144:145], v8 offset:6144
    ds_read_b64_tr_b16 v[146:147], v8 offset:6656
    buffer_load_dwordx4 v2, s[24:27], s60 offen offset:256 lds
    s_add_u32 s60, s60, 110592
    s_cbranch_vccnz L_spin_pf_ff
L_ret_pf_ff:
    v_mfma_f32_32x32x16_bf16 v[64:79], v[124:127], v[116:119], v[64:79]
    ds_read_b64_tr_b16 v[148:149], v9 offset:6144
    ds_read_b64_tr_b16 v[150:151], v9 offset:6656
    buffer_load_dwordx4 a[0:3], v14, s[8:11], s63 offen offset:0 sc1
    v_add_u32 v6, 40960, v6
    v_mfma_f32_32x32x16_bf16 v[80:95], v[128:131], v[112:115], v[80:95]
    v_add_u32 v7, 40960, v7
    v_add_u32 v8, 40960, v8
    v_add_u32 v9, 40960, v9
    v_mfma_f32_32x32x16_bf16 v[96:111], v[128:131], v[116:119], v[96:111]
    s_waitcnt lgkmcnt(4)
    buffer_load_dwordx4 a[4:7], v14, s[8:11], s63 offen offset:1024 sc1
    v_mfma_f32_32x32x16_bf16 v[16:31], v[140:143], v[132:135], v[16:31]
    v_mfma_f32_32x32x16_bf16 v[32:47], v[140:143], v[136:139], v[32:47]
    s_waitcnt lgkmcnt(0)
    s_barrier
    ds_read_b128 v[112:115], v3 offset:0
    ds_read_b64_tr_b16 v[120:121], v7 offset:0
    buffer_load_dwordx4 a[8:11], v14, s[8:11], s63 offen offset:2048 sc1
    v_mfma_f32_32x32x16_bf16 v[48:63], v[144:147], v[132:135], v[48:63]
    ds_read_b64_tr_b16 v[122:123], v7 offset:512
    ds_read_b128 v[116:119], v3 offset:4096
    v_mfma_f32_32x32x16_bf16 v[64:79], v[144:147], v[136:139], v[64:79]
    ds_read_b64_tr_b16 v[124:125], v8 offset:0
    ds_read_b64_tr_b16 v[126:127], v8 offset:512
    buffer_load_dwordx4 a[12:15], v14, s[8:11], s63 offen offset:3072 sc1
    v_mfma_f32_32x32x16_bf16 v[80:95], v[148:151], v[132:135], v[80:95]
    ds_read_b64_tr_b16 v[128:129], v9 offset:0
    ds_read_b64_tr_b16 v[130:131], v9 offset:512
    v_mfma_f32_32x32x16_bf16 v[96:111], v[148:151], v[136:139], v[96:111]
    s_waitcnt lgkmcnt(4)
    buffer_load_dwordx4 a[16:19], v15, s[8:11], s63 offen sc1
    v_subrev_u32 v3, 81920, v3
    v_mfma_f32_32x32x16_bf16 v[16:31], v[120:123], v[112:115], v[16:31]
    ds_read_b128 v[132:135], v4 offset:0
    ds_read_b64_tr_b16 v[140:141], v7 offset:2048
    v_mfma_f32_32x32x16_bf16 v[32:47], v[120:123], v[116:119], v[32:47]
    s_waitcnt lgkmcnt(2)
    ds_read_b64_tr_b16 v[142:143], v7 offset:2560
    ds_read_b128 v[136:139], v4 offset:4096
    s_add_u32 s63, s63, 5120
    buffer_load_dwordx4 a[20:23], v14, s[8:11], s63 offen offset:0 sc1
    v_mfma_f32_32x32x16_bf16 v[48:63], v[124:127], v[112:115], v[48:63]
    ds_read_b64_tr_b16 v[144:145], v8 offset:2048
    ds_read_b64_tr_b16 v[146:147], v8 offset:2560
    v_mfma_f32_32x32x16_bf16 v[64:79], v[124:127], v[116:119], v[64:79]
    ds_read_b64_tr_b16 v[148:149], v9 offset:2048
    ds_read_b64_tr_b16 v[150:151], v9 offset:2560
    buffer_load_dwordx4 a[24:27], v14, s[8:11], s63 offen offset:1024 sc1
    v_mfma_f32_32x32x16_bf16 v[80:95], v[128:131], v[112:115], v[80:95]
    v_subrev_u32 v4, 81920, v4
    v_mfma_f32_32x32x16_bf16 v[96:111], v[128:131], v[116:119], v[96:111]
    s_waitcnt lgkmcnt(4)
    buffer_load_dwordx4 a[28:31], v14, s[8:11], s63 offen offset:2048 sc1
    v_mfma_f32_32x32x16_bf16 v[16:31], v[140:143], v[132:135], v[16:31]
    ds_read_b128 v[112:115], v5 offset:0
    ds_read_b64_tr_b16 v[120:121], v7 offset:4096
    v_mfma_f32_32x32x16_bf16 v[32:47], v[140:143], v[136:139], v[32:47]
    s_waitcnt lgkmcnt(2)
    ds_read_b64_tr_b16 v[122:123], v7 offset:4608
    ds_read_b128 v[116:119], v5 offset:4096
    buffer_load_dwordx4 a[32:35], v14, s[8:11], s63 offen offset:3072 sc1
    v_mfma_f32_32x32x16_bf16 v[48:63], v[144:147], v[132:135], v[48:63]
    ds_read_b64_tr_b16 v[124:125], v8 offset:4096
    ds_read_b64_tr_b16 v[126:127], v8 offset:4608
    v_mfma_f32_32x32x16_bf16 v[64:79], v[144:147], v[136:139], v[64:79]
    ds_read_b64_tr_b16 v[128:129], v9 offset:4096
    ds_read_b64_tr_b16 v[130:131], v9 offset:4608
    buffer_load_dwordx4 a[36:39], v15, s[8:11], s63 offen sc1
    v_mfma_f32_32x32x16_bf16 v[80:95], v[148:151], v[132:135], v[80:95]
    v_subrev_u32 v5, 81920, v5
    v_mfma_f32_32x32x16_bf16 v[96:111], v[148:151], v[136:139], v[96:111]
    s_waitcnt lgkmcnt(4)
    s_add_u32 s63, s63, 5120
    buffer_load_dwordx4 a[40:43], v14, s[8:11], s63 offen offset:0 sc1
    v_mfma_f32_32x32x16_bf16 v[16:31], v[120:123], v[112:115], v[16:31]
    ds_read_b128 v[132:135], v6 offset:0
    ds_read_b64_tr_b16 v[140:141], v7 offset:6144
    v_mfma_f32_32x32x16_bf16 v[32:47], v[120:123], v[116:119], v[32:47]
    s_waitcnt lgkmcnt(2)
    ds_read_b64_tr_b16 v[142:143], v7 offset:6656
    ds_read_b128 v[136:139], v6 offset:4096
    buffer_load_dwordx4 a[44:47], v14, s[8:11], s63 offen offset:1024 sc1
    v_mfma_f32_32x32x16_bf16 v[48:63], v[124:127], v[112:115], v[48:63]
    ds_read_b64_tr_b16 v[144:145], v8 offset:6144
    ds_read_b64_tr_b16 v[146:147], v8 offset:6656
    v_mfma_f32_32x32x16_bf16 v[64:79], v[124:127], v[116:119], v[64:79]
    ds_read_b64_tr_b16 v[148:149], v9 offset:6144
    ds_read_b64_tr_b16 v[150:151], v9 offset:6656
    buffer_load_dwordx4 a[48:51], v14, s[8:11], s63 offen offset:2048 sc1
    v_subrev_u32 v6, 81920, v6
    v_mfma_f32_32x32x16_bf16 v[80:95], v[128:131], v[112:115], v[80:95]
    v_subrev_u32 v7, 81920, v7
    v_subrev_u32 v8, 81920, v8
    v_subrev_u32 v9, 81920, v9
    v_mfma_f32_32x32x16_bf16 v[96:111], v[128:131], v[116:119], v[96:111]
    s_waitcnt lgkmcnt(4)
    buffer_load_dwordx4 a[52:55], v14, s[8:11], s63 offen offset:3072 sc1
    v_mfma_f32_32x32x16_bf16 v[16:31], v[140:143], v[132:135], v[16:31]
    v_mfma_f32_32x32x16_bf16 v[32:47], v[140:143], v[136:139], v[32:47]
    s_waitcnt vmcnt(14) lgkmcnt(0)
    s_barrier
    ds_read_b128 v[112:115], v3 offset:0
    ds_read_b64_tr_b16 v[120:121], v7 offset:0
    buffer_load_dwordx4 a[56:59], v15, s[8:11], s63 offen sc1
    v_mfma_f32_32x32x16_bf16 v[48:63], v[144:147], v[132:135], v[48:63]
    ds_read_b64_tr_b16 v[122:123], v7 offset:512
    ds_read_b128 v[116:119], v3 offset:4096
    v_mfma_f32_32x32x16_bf16 v[64:79], v[144:147], v[136:139], v[64:79]
    ds_read_b64_tr_b16 v[124:125], v8 offset:0
    ds_read_b64_tr_b16 v[126:127], v8 offset:512
    s_add_u32 s63, s63, 5120
    buffer_load_dwordx4 a[60:63], v14, s[8:11], s63 offen offset:0 sc1
    v_mfma_f32_32x32x16_bf16 v[80:95], v[148:151], v[132:135], v[80:95]
    ds_read_b64_tr_b16 v[128:129], v9 offset:0
    ds_read_b64_tr_b16 v[130:131], v9 offset:512
    v_mfma_f32_32x32x16_bf16 v[96:111], v[148:151], v[136:139], v[96:111]
    s_waitcnt lgkmcnt(4)
    buffer_load_dwordx4 a[64:67], v14, s[8:11], s63 offen offset:1024 sc1
    v_mfma_f32_32x32x16_bf16 v[16:31], v[120:123], v[112:115], v[16:31]
    ds_read_b128 v[132:135], v4 offset:0
    ds_read_b64_tr_b16 v[140:141], v7 offset:2048
    v_mfma_f32_32x32x16_bf16 v[32:47], v[120:123], v[116:119], v[32:47]
    s_waitcnt lgkmcnt(2)
    ds_read_b64_tr_b16 v[142:143], v7 offset:2560
    ds_read_b128 v[136:139], v4 offset:4096
    buffer_load_dwordx4 a[68:71], v14, s[8:11], s63 offen offset:2048 sc1
    v_mfma_f32_32x32x16_bf16 v[48:63], v[124:127], v[112:115], v[48:63]
    ds_read_b64_tr_b16 v[144:145], v8 offset:2048
    ds_read_b64_tr_b16 v[146:147], v8 offset:2560
    v_mfma_f32_32x32x16_bf16 v[64:79], v[124:127], v[116:119], v[64:79]
    ds_read_b64_tr_b16 v[148:149], v9 offset:2048
    ds_read_b64_tr_b16 v[150:151], v9 offset:2560
    buffer_load_dwordx4 a[72:75], v14, s[8:11], s63 offen offset:3072 sc1
    v_mfma_f32_32x32x16_bf16 v[80:95], v[128:131], v[112:115], v[80:95]
    v_mfma_f32_32x32x16_bf16 v[96:111], v[128:131], v[116:119], v[96:111]
    s_waitcnt lgkmcnt(4)
    buffer_load_dwordx4 a[76:79], v15, s[8:11], s63 offen sc1
    v_mfma_f32_32x32x16_bf16 v[16:31], v[140:143], v[132:135], v[16:31]
    ds_read_b128 v[112:115], v5 offset:0
    ds_read_b64_tr_b16 v[120:121], v7 offset:4096
    v_mfma_f32_32x32x16_bf16 v[32:47], v[140:143], v[136:139], v[32:47]
    s_waitcnt lgkmcnt(2)
    ds_read_b64_tr_b16 v[122:123], v7 offset:4608
    ds_read_b128 v[116:119], v5 offset:4096
    s_add_u32 s63, s63, 5120
    buffer_load_dwordx4 a[80:83], v14, s[8:11], s63 offen offset:0 sc1
    v_mfma_f32_32x32x16_bf16 v[48:63], v[144:147], v[132:135], v[48:63]
    ds_read_b64_tr_b16 v[124:125], v8 offset:4096
    ds_read_b64_tr_b16 v[126:127], v8 offset:4608
    v_mfma_f32_32x32x16_bf16 v[64:79], v[144:147], v[136:139], v[64:79]
    ds_read_b64_tr_b16 v[128:129], v9 offset:4096
    ds_read_b64_tr_b16 v[130:131], v9 offset:4608
    buffer_load_dwordx4 a[84:87], v14, s[8:11], s63 offen offset:1024 sc1
    v_mfma_f32_32x32x16_bf16 v[80:95], v[148:151], v[132:135], v[80:95]
    v_mfma_f32_32x32x16_bf16 v[96:111], v[148:151], v[136:139], v[96:111]
    s_waitcnt lgkmcnt(4)
    buffer_load_dwordx4 a[88:91], v14, s[8:11], s63 offen offset:2048 sc1
    v_mfma_f32_32x32x16_bf16 v[16:31], v[120:123], v[112:115], v[16:31]
    ds_read_b128 v[132:135], v6 offset:0
    ds_read_b64_tr_b16 v[140:141], v7 offset:6144
    v_mfma_f32_32x32x16_bf16 v[32:47], v[120:123], v[116:119], v[32:47]
    s_waitcnt lgkmcnt(2)
    ds_read_b64_tr_b16 v[142:143], v7 offset:6656
    ds_read_b128 v[136:139], v6 offset:4096
    buffer_load_dwordx4 a[92:95], v14, s[8:11], s63 offen offset:3072 sc1
    v_mfma_f32_32x32x16_bf16 v[48:63], v[124:127], v[112:115], v[48:63]
    ds_read_b64_tr_b16 v[144:145], v8 offset:6144
    ds_read_b64_tr_b16 v[146:147], v8 offset:6656
    v_mfma_f32_32x32x16_bf16 v[64:79], v[124:127], v[116:119], v[64:79]
    ds_read_b64_tr_b16 v[148:149], v9 offset:6144
    ds_read_b64_tr_b16 v[150:151], v9 offset:6656
    buffer_load_dwordx4 a[96:99], v15, s[8:11], s63 offen sc1
    v_mfma_f32_32x32x16_bf16 v[80:95], v[128:131], v[112:115], v[80:95]
    v_mfma_f32_32x32x16_bf16 v[96:111], v[128:131], v[116:119], v[96:111]
    s_waitcnt lgkmcnt(4)
    s_add_u32 s63, s63, 5120
    buffer_load_dwordx4 a[100:103], v14, s[8:11], s63 offen offset:0 sc1
    v_mfma_f32_32x32x16_bf16 v[16:31], v[140:143], v[132:135], v[16:31]
    v_add_u32_e64 v1, s59, v14
    v_add_u32 v2, 1024, v1
    v_and_b32 v2, 0xfff, v2
    v_add_u32 v3, 2048, v1
    v_and_b32 v3, 0xfff, v3
    v_add_u32 v4, 3072, v1
    v_mfma_f32_32x32x16_bf16 v[32:47], v[140:143], v[136:139], v[32:47]
    s_waitcnt lgkmcnt(0)
    buffer_load_dwordx4 a[104:107], v14, s[8:11], s63 offen offset:1024 sc1
    v_and_b32 v4, 0xfff, v4
    v_mfma_f32_32x32x16_bf16 v[48:63], v[144:147], v[132:135], v[48:63]
    v_mfma_f32_32x32x16_bf16 v[64:79], v[144:147], v[136:139], v[64:79]
    buffer_load_dwordx4 a[108:111], v14, s[8:11], s63 offen offset:2048 sc1
    v_mfma_f32_32x32x16_bf16 v[80:95], v[148:151], v[132:135], v[80:95]
    v_mfma_f32_32x32x16_bf16 v[96:111], v[148:151], v[136:139], v[96:111]
    buffer_load_dwordx4 a[112:115], v14, s[8:11], s63 offen offset:3072 sc1
    v_mfma_f32_32x32x16_bf16 v[16:31], v[196:199], v[188:191], v[16:31]
    v_mfma_f32_32x32x16_bf16 v[32:47], v[196:199], v[192:195], v[32:47]
    v_mfma_f32_32x32x16_bf16 v[48:63], v[200:203], v[188:191], v[48:63]
    v_mfma_f32_32x32x16_bf16 v[64:79], v[200:203], v[192:195], v[64:79]
    v_mfma_f32_32x32x16_bf16 v[80:95], v[204:207], v[188:191], v[80:95]
    v_mfma_f32_32x32x16_bf16 v[96:111], v[204:207], v[192:195], v[96:111]
    s_mul_i32 s70, s52, 3072
    s_add_u32 s70, s70, 122880
    v_add_u32 v223, 0, v0
    v_mul_u32_u24 v222, 6554, v223
    v_lshrrev_b32 v222, 16, v222
    v_mul_u32_u24 v222, 1120, v222
    s_add_u32 m0, s70, 0
    v_lshl_add_u32 v222, v223, 4, v222
    buffer_load_dwordx4 v222, s[4:7], s46 offen lds
    v_add_u32 v223, 64, v0
    v_mul_u32_u24 v222, 6554, v223
    v_lshrrev_b32 v222, 16, v222
    v_mul_u32_u24 v222, 1120, v222
    s_add_u32 m0, s70, 1024
    v_lshl_add_u32 v222, v223, 4, v222
    buffer_load_dwordx4 v222, s[4:7], s46 offen lds
    v_add_u32 v223, 128, v0
    v_mul_u32_u24 v222, 6554, v223
    v_lshrrev_b32 v222, 16, v222
    v_mul_u32_u24 v222, 1120, v222
    s_add_u32 m0, s70, 2048
    v_lshl_add_u32 v222, v223, 4, v222
    s_mov_b32 exec_hi, 0
    buffer_load_dwordx4 v222, s[4:7], s46 offen lds
    s_mov_b32 exec_hi, -1
    v_add_u32 v222, s47, v14
    s_add_u32 m0, s70, 2560
    s_mov_b64 exec, 0x3ff
    global_load_lds_dwordx4 v222, s[14:15]
    s_mov_b64 exec, -1
    s_add_u32 m0, s70, 2720
    s_mov_b64 exec, 0x3ff
    global_load_lds_dwordx4 v222, s[16:17]
    s_mov_b64 exec, -1
    s_add_u32 m0, s70, 2880
    s_mov_b64 exec, 0xff
    buffer_load_dwordx4 v14, s[8:11], s48 offen sc1 lds
    s_mov_b64 exec, -1
    v_min_u32 v221, 4, v0
    v_lshlrev_b32_e64 v221, 2, v221
    buffer_load_dword v221, v221, s[8:11], s50 offen sc1
    v_pk_mul_f32 v[112:113], v[16:17], v[16:17]
    v_pk_mul_f32 v[114:115], v[18:19], v[18:19]
    v_pk_mul_f32 v[116:117], v[20:21], v[20:21]
    v_pk_mul_f32 v[118:119], v[22:23], v[22:23]
    v_pk_fma_f32 v[112:113], v[112:113], v[210:211], v[208:209] op_sel:[0,0,0] op_sel_hi:[1,0,0]
    v_pk_fma_f32 v[114:115], v[114:115], v[210:211], v[208:209] op_sel:[0,0,0] op_sel_hi:[1,0,0]
    v_pk_fma_f32 v[116:117], v[116:117], v[210:211], v[208:209] op_sel:[0,0,0] op_sel_hi:[1,0,0]
    v_pk_fma_f32 v[118:119], v[118:119], v[210:211], v[208:209] op_sel:[0,0,0] op_sel_hi:[1,0,0]
    v_pk_mul_f32 v[112:113], v[112:113], v[16:17]
    v_pk_mul_f32 v[114:115], v[114:115], v[18:19]
    v_pk_mul_f32 v[116:117], v[116:117], v[20:21]
    v_pk_mul_f32 v[118:119], v[118:119], v[22:23]
    v_exp_f32 v112, v112
    v_exp_f32 v113, v113
    v_exp_f32 v114, v114
    v_exp_f32 v115, v115
    v_exp_f32 v116, v116
    v_exp_f32 v117, v117
    v_exp_f32 v118, v118
    v_exp_f32 v119, v119
    v_pk_fma_f32 v[112:113], v[112:113], v[212:213], v[212:213] op_sel:[0,0,0] op_sel_hi:[1,0,0]
    v_pk_fma_f32 v[114:115], v[114:115], v[212:213], v[212:213] op_sel:[0,0,0] op_sel_hi:[1,0,0]
    v_pk_fma_f32 v[116:117], v[116:117], v[212:213], v[212:213] op_sel:[0,0,0] op_sel_hi:[1,0,0]
    v_pk_fma_f32 v[118:119], v[118:119], v[212:213], v[212:213] op_sel:[0,0,0] op_sel_hi:[1,0,0]
    v_rcp_f32 v112, v112
    v_rcp_f32 v113, v113
    v_rcp_f32 v114, v114
    v_rcp_f32 v115, v115
    v_rcp_f32 v116, v116
    v_rcp_f32 v117, v117
    v_rcp_f32 v118, v118
    buffer_load_dwordx4 a[116:119], v15, s[8:11], s63 offen sc1
    v_rcp_f32 v119, v119
    v_pk_mul_f32 v[112:113], v[112:113], v[16:17]
    v_pk_mul_f32 v[114:115], v[114:115], v[18:19]
    v_pk_mul_f32 v[116:117], v[116:117], v[20:21]
    v_pk_mul_f32 v[118:119], v[118:119], v[22:23]
    v_cvt_pk_bf16_f32 v128, v112, v113
    v_cvt_pk_bf16_f32 v129, v114, v115
    v_cvt_pk_bf16_f32 v130, v116, v117
    v_cvt_pk_bf16_f32 v131, v118, v119
    buffer_store_dwordx4 v[128:131], v11, s[8:11], s18 offen offset:0 sc1
    v_pk_mul_f32 v[112:113], v[24:25], v[24:25]
    v_pk_mul_f32 v[114:115], v[26:27], v[26:27]
    v_pk_mul_f32 v[116:117], v[28:29], v[28:29]
    v_pk_mul_f32 v[118:119], v[30:31], v[30:31]
    v_pk_fma_f32 v[112:113], v[112:113], v[210:211], v[208:209] op_sel:[0,0,0] op_sel_hi:[1,0,0]
    v_pk_fma_f32 v[114:115], v[114:115], v[210:211], v[208:209] op_sel:[0,0,0] op_sel_hi:[1,0,0]
    v_pk_fma_f32 v[116:117], v[116:117], v[210:211], v[208:209] op_sel:[0,0,0] op_sel_hi:[1,0,0]
    v_pk_fma_f32 v[118:119], v[118:119], v[210:211], v[208:209] op_sel:[0,0,0] op_sel_hi:[1,0,0]
    v_pk_mul_f32 v[112:113], v[112:113], v[24:25]
    v_pk_mul_f32 v[114:115], v[114:115], v[26:27]
    v_pk_mul_f32 v[116:117], v[116:117], v[28:29]
    v_pk_mul_f32 v[118:119], v[118:119], v[30:31]
    v_exp_f32 v112, v112
    v_exp_f32 v113, v113
    v_exp_f32 v114, v114
    v_exp_f32 v115, v115
    v_exp_f32 v116, v116
    v_exp_f32 v117, v117
    v_exp_f32 v118, v118
    v_exp_f32 v119, v119
    v_pk_fma_f32 v[112:113], v[112:113], v[212:213], v[212:213] op_sel:[0,0,0] op_sel_hi:[1,0,0]
    v_pk_fma_f32 v[114:115], v[114:115], v[212:213], v[212:213] op_sel:[0,0,0] op_sel_hi:[1,0,0]
    v_pk_fma_f32 v[116:117], v[116:117], v[212:213], v[212:213] op_sel:[0,0,0] op_sel_hi:[1,0,0]
    v_pk_fma_f32 v[118:119], v[118:119], v[212:213], v[212:213] op_sel:[0,0,0] op_sel_hi:[1,0,0]
    v_rcp_f32 v112, v112
    s_add_u32 s63, s63, 5120
    s_or_b32 s66, s63, s3
    buffer_load_dwordx4 a[120:123], v14, s[8:11], s66 offen offset:0 sc1
    v_rcp_f32 v113, v113
    v_rcp_f32 v114, v114
    v_rcp_f32 v115, v115
    v_rcp_f32 v116, v116
    v_rcp_f32 v117, v117
    v_rcp_f32 v118, v118
    v_rcp_f32_e64 v119, v119
    v_pk_mul_f32 v[112:113], v[112:113], v[24:25]
    v_pk_mul_f32 v[114:115], v[114:115], v[26:27]
    v_pk_mul_f32 v[116:117], v[116:117], v[28:29]
    v_pk_mul_f32 v[118:119], v[118:119], v[30:31]
    v_cvt_pk_bf16_f32 v132, v112, v113
    v_cvt_pk_bf16_f32 v133, v114, v115
    v_cvt_pk_bf16_f32 v134, v116, v117
    v_cvt_pk_bf16_f32 v135, v118, v119
    buffer_store_dwordx4 v[132:135], v11, s[8:11], s18 offen offset:512 sc1
    v_pk_mul_f32 v[112:113], v[32:33], v[32:33]
    v_pk_mul_f32 v[114:115], v[34:35], v[34:35]
    v_pk_mul_f32 v[116:117], v[36:37], v[36:37]
    v_pk_mul_f32 v[118:119], v[38:39], v[38:39]
    v_pk_fma_f32 v[112:113], v[112:113], v[210:211], v[208:209] op_sel:[0,1,1] op_sel_hi:[1,1,1]
    v_pk_fma_f32 v[114:115], v[114:115], v[210:211], v[208:209] op_sel:[0,1,1] op_sel_hi:[1,1,1]
    v_pk_fma_f32 v[116:117], v[116:117], v[210:211], v[208:209] op_sel:[0,1,1] op_sel_hi:[1,1,1]
    v_pk_fma_f32 v[118:119], v[118:119], v[210:211], v[208:209] op_sel:[0,1,1] op_sel_hi:[1,1,1]
    v_pk_mul_f32 v[112:113], v[112:113], v[32:33]
    v_pk_mul_f32 v[114:115], v[114:115], v[34:35]
    v_pk_mul_f32 v[116:117], v[116:117], v[36:37]
    v_pk_mul_f32 v[118:119], v[118:119], v[38:39]
    v_exp_f32 v112, v112
    v_exp_f32 v113, v113
    v_exp_f32 v114, v114
    v_exp_f32 v115, v115
    v_exp_f32 v116, v116
    buffer_load_dwordx4 a[124:127], v14, s[8:11], s66 offen offset:1024 sc1
    v_exp_f32 v117, v117
    v_exp_f32 v118, v118
    v_exp_f32 v119, v119
    v_pk_fma_f32 v[112:113], v[112:113], v[212:213], v[212:213] op_sel:[0,1,1] op_sel_hi:[1,1,1]
    v_pk_fma_f32 v[114:115], v[114:115], v[212:213], v[212:213] op_sel:[0,1,1] op_sel_hi:[1,1,1]
    v_pk_fma_f32 v[116:117], v[116:117], v[212:213], v[212:213] op_sel:[0,1,1] op_sel_hi:[1,1,1]
    v_pk_fma_f32 v[118:119], v[118:119], v[212:213], v[212:213] op_sel:[0,1,1] op_sel_hi:[1,1,1]
    v_rcp_f32 v112, v112
    v_rcp_f32 v113, v113
    v_rcp_f32 v114, v114
    v_rcp_f32 v115, v115
    v_rcp_f32 v116, v116
    v_rcp_f32 v117, v117
    v_rcp_f32 v118, v118
    v_rcp_f32 v119, v119
    v_pk_mul_f32 v[112:113], v[112:113], v[32:33]
    v_pk_mul_f32 v[114:115], v[114:115], v[34:35]
    v_pk_mul_f32 v[116:117], v[116:117], v[36:37]
    v_pk_mul_f32 v[118:119], v[118:119], v[38:39]
    v_cvt_pk_bf16_f32 v136, v112, v113
    v_cvt_pk_bf16_f32 v137, v114, v115
    v_cvt_pk_bf16_f32 v138, v116, v117
    v_cvt_pk_bf16_f32 v139, v118, v119
    buffer_store_dwordx4 v[136:139], v11, s[8:11], s18 offen offset:2048 sc1
    v_pk_mul_f32 v[112:113], v[40:41], v[40:41]
    v_pk_mul_f32 v[114:115], v[42:43], v[42:43]
    v_pk_mul_f32 v[116:117], v[44:45], v[44:45]
    v_pk_mul_f32 v[118:119], v[46:47], v[46:47]
    v_pk_fma_f32 v[112:113], v[112:113], v[210:211], v[208:209] op_sel:[0,1,1] op_sel_hi:[1,1,1]
    v_pk_fma_f32 v[114:115], v[114:115], v[210:211], v[208:209] op_sel:[0,1,1] op_sel_hi:[1,1,1]
    v_pk_fma_f32 v[116:117], v[116:117], v[210:211], v[208:209] op_sel:[0,1,1] op_sel_hi:[1,1,1]
    v_pk_fma_f32 v[118:119], v[118:119], v[210:211], v[208:209] op_sel:[0,1,1] op_sel_hi:[1,1,1]
    v_pk_mul_f32 v[112:113], v[112:113], v[40:41]
    buffer_load_dwordx4 a[128:131], v14, s[8:11], s66 offen offset:2048 sc1
    v_pk_mul_f32 v[114:115], v[114:115], v[42:43]
    v_pk_mul_f32 v[116:117], v[116:117], v[44:45]
    v_pk_mul_f32 v[118:119], v[118:119], v[46:47]
    v_exp_f32 v112, v112
    v_exp_f32 v113, v113
    v_exp_f32 v114, v114
    v_exp_f32 v115, v115
    v_exp_f32 v116, v116
    v_exp_f32 v117, v117
    v_exp_f32 v118, v118
    v_exp_f32 v119, v119
    v_pk_fma_f32 v[112:113], v[112:113], v[212:213], v[212:213] op_sel:[0,1,1] op_sel_hi:[1,1,1]
    v_pk_fma_f32 v[114:115], v[114:115], v[212:213], v[212:213] op_sel:[0,1,1] op_sel_hi:[1,1,1]
    v_pk_fma_f32 v[116:117], v[116:117], v[212:213], v[212:213] op_sel:[0,1,1] op_sel_hi:[1,1,1]
    v_pk_fma_f32 v[118:119], v[118:119], v[212:213], v[212:213] op_sel:[0,1,1] op_sel_hi:[1,1,1]
    v_rcp_f32 v112, v112
    v_rcp_f32 v113, v113
    v_rcp_f32 v114, v114
    v_rcp_f32 v115, v115
    v_rcp_f32 v116, v116
    v_rcp_f32 v117, v117
    v_rcp_f32 v118, v118
    v_rcp_f32 v119, v119
    v_pk_mul_f32 v[112:113], v[112:113], v[40:41]
    v_pk_mul_f32 v[114:115], v[114:115], v[42:43]
    v_pk_mul_f32 v[116:117], v[116:117], v[44:45]
    v_pk_mul_f32 v[118:119], v[118:119], v[46:47]
    v_cvt_pk_bf16_f32 v140, v112, v113
    v_cvt_pk_bf16_f32 v141, v114, v115
    buffer_load_dwordx4 a[132:135], v14, s[8:11], s66 offen offset:3072 sc1
    v_cvt_pk_bf16_f32 v142, v116, v117
    v_cvt_pk_bf16_f32 v143, v118, v119
    buffer_store_dwordx4 v[140:143], v11, s[8:11], s18 offen offset:2560 sc1
    v_pk_mul_f32 v[112:113], v[48:49], v[48:49]
    s_waitcnt vmcnt(9)
    v_cmp_ne_u32 vcc, s55, v221
    v_pk_mul_f32 v[114:115], v[50:51], v[50:51]
    v_pk_mul_f32 v[116:117], v[52:53], v[52:53]
    v_pk_mul_f32 v[118:119], v[54:55], v[54:55]
    v_pk_fma_f32 v[112:113], v[112:113], v[210:211], v[208:209] op_sel:[0,0,0] op_sel_hi:[1,0,0]
    s_cbranch_vccnz L_spin_pf_fy
L_ret_pf_fy:
    s_barrier
    v_pk_fma_f32 v[114:115], v[114:115], v[210:211], v[208:209] op_sel:[0,0,0] op_sel_hi:[1,0,0]
    v_pk_fma_f32 v[116:117], v[116:117], v[210:211], v[208:209] op_sel:[0,0,0] op_sel_hi:[1,0,0]
    v_pk_fma_f32 v[118:119], v[118:119], v[210:211], v[208:209] op_sel:[0,0,0] op_sel_hi:[1,0,0]
    v_pk_mul_f32 v[112:113], v[112:113], v[48:49]
    v_pk_mul_f32 v[114:115], v[114:115], v[50:51]
    v_pk_mul_f32 v[116:117], v[116:117], v[52:53]
    v_pk_mul_f32 v[118:119], v[118:119], v[54:55]
    v_exp_f32 v112, v112
    v_exp_f32 v113, v113
    v_exp_f32 v114, v114
    v_exp_f32 v115, v115
    v_exp_f32 v116, v116
    v_exp_f32 v117, v117
    v_exp_f32 v118, v118
    v_exp_f32 v119, v119
    v_pk_fma_f32 v[112:113], v[112:113], v[212:213], v[212:213] op_sel:[0,0,0] op_sel_hi:[1,0,0]
    v_pk_fma_f32 v[114:115], v[114:115], v[212:213], v[212:213] op_sel:[0,0,0] op_sel_hi:[1,0,0]
    v_pk_fma_f32 v[116:117], v[116:117], v[212:213], v[212:213] op_sel:[0,0,0] op_sel_hi:[1,0,0]
    v_pk_fma_f32 v[118:119], v[118:119], v[212:213], v[212:213] op_sel:[0,0,0] op_sel_hi:[1,0,0]
    v_rcp_f32 v112, v112
    v_rcp_f32 v113, v113
    v_rcp_f32 v114, v114
    v_rcp_f32 v115, v115
    v_rcp_f32 v116, v116
    v_rcp_f32 v117, v117
    v_rcp_f32 v118, v118
    buffer_load_dwordx4 a[136:139], v15, s[8:11], s66 offen sc1
    v_rcp_f32 v119, v119
    v_pk_mul_f32 v[112:113], v[112:113], v[48:49]
    v_pk_mul_f32 v[114:115], v[114:115], v[50:51]
    v_pk_mul_f32 v[116:117], v[116:117], v[52:53]
    v_pk_mul_f32 v[118:119], v[118:119], v[54:55]
    v_cvt_pk_bf16_f32 v128, v112, v113
    v_cvt_pk_bf16_f32 v129, v114, v115
    v_cvt_pk_bf16_f32 v130, v116, v117
    v_cvt_pk_bf16_f32 v131, v118, v119
    buffer_store_dwordx4 v[128:131], v11, s[8:11], s19 offen offset:0 sc1
    v_pk_mul_f32 v[112:113], v[56:57], v[56:57]
    v_pk_mul_f32 v[114:115], v[58:59], v[58:59]
    v_pk_mul_f32 v[116:117], v[60:61], v[60:61]
    v_pk_mul_f32 v[118:119], v[62:63], v[62:63]
    v_pk_fma_f32 v[112:113], v[112:113], v[210:211], v[208:209] op_sel:[0,0,0] op_sel_hi:[1,0,0]
    v_pk_fma_f32 v[114:115], v[114:115], v[210:211], v[208:209] op_sel:[0,0,0] op_sel_hi:[1,0,0]
    v_pk_fma_f32 v[116:117], v[116:117], v[210:211], v[208:209] op_sel:[0,0,0] op_sel_hi:[1,0,0]
    v_pk_fma_f32 v[118:119], v[118:119], v[210:211], v[208:209] op_sel:[0,0,0] op_sel_hi:[1,0,0]
    v_pk_mul_f32 v[112:113], v[112:113], v[56:57]
    v_pk_mul_f32 v[114:115], v[114:115], v[58:59]
    v_pk_mul_f32 v[116:117], v[116:117], v[60:61]
    v_pk_mul_f32 v[118:119], v[118:119], v[62:63]
    v_exp_f32 v112, v112
    v_exp_f32 v113, v113
    v_exp_f32 v114, v114
    v_exp_f32 v115, v115
    v_exp_f32 v116, v116
    v_exp_f32 v117, v117
    v_exp_f32 v118, v118
    v_exp_f32 v119, v119
    v_pk_fma_f32 v[112:113], v[112:113], v[212:213], v[212:213] op_sel:[0,0,0] op_sel_hi:[1,0,0]
    v_pk_fma_f32 v[114:115], v[114:115], v[212:213], v[212:213] op_sel:[0,0,0] op_sel_hi:[1,0,0]
    v_pk_fma_f32 v[116:117], v[116:117], v[212:213], v[212:213] op_sel:[0,0,0] op_sel_hi:[1,0,0]
    v_pk_fma_f32 v[118:119], v[118:119], v[212:213], v[212:213] op_sel:[0,0,0] op_sel_hi:[1,0,0]
    v_rcp_f32 v112, v112
    s_add_u32 s63, s63, 5120
    buffer_load_dwordx4 a[140:143], v14, s[8:11], s63 offen offset:0 sc1
    v_rcp_f32 v113, v113
    v_rcp_f32 v114, v114
    v_rcp_f32 v115, v115
    v_rcp_f32 v116, v116
    v_rcp_f32 v117, v117
    v_rcp_f32 v118, v118
    v_rcp_f32 v119, v119
    v_pk_mul_f32 v[112:113], v[112:113], v[56:57]
    v_pk_mul_f32 v[114:115], v[114:115], v[58:59]
    v_pk_mul_f32 v[116:117], v[116:117], v[60:61]
    v_pk_mul_f32 v[118:119], v[118:119], v[62:63]
    v_cvt_pk_bf16_f32 v132, v112, v113
    v_cvt_pk_bf16_f32 v133, v114, v115
    v_cvt_pk_bf16_f32 v134, v116, v117
    v_cvt_pk_bf16_f32 v135, v118, v119
    buffer_store_dwordx4 v[132:135], v11, s[8:11], s19 offen offset:512 sc1
    v_pk_mul_f32 v[112:113], v[64:65], v[64:65]
    v_pk_mul_f32 v[114:115], v[66:67], v[66:67]
    v_pk_mul_f32 v[116:117], v[68:69], v[68:69]
    v_pk_mul_f32 v[118:119], v[70:71], v[70:71]
    v_pk_fma_f32 v[112:113], v[112:113], v[210:211], v[208:209] op_sel:[0,1,1] op_sel_hi:[1,1,1]
    v_pk_fma_f32 v[114:115], v[114:115], v[210:211], v[208:209] op_sel:[0,1,1] op_sel_hi:[1,1,1]
    v_pk_fma_f32 v[116:117], v[116:117], v[210:211], v[208:209] op_sel:[0,1,1] op_sel_hi:[1,1,1]
    v_pk_fma_f32 v[118:119], v[118:119], v[210:211], v[208:209] op_sel:[0,1,1] op_sel_hi:[1,1,1]
    v_pk_mul_f32 v[112:113], v[112:113], v[64:65]
    v_pk_mul_f32 v[114:115], v[114:115], v[66:67]
    v_pk_mul_f32 v[116:117], v[116:117], v[68:69]
    v_pk_mul_f32 v[118:119], v[118:119], v[70:71]
    v_exp_f32 v112, v112
    v_exp_f32 v113, v113
    v_exp_f32 v114, v114
    v_exp_f32 v115, v115
    v_exp_f32 v116, v116
    buffer_load_dwordx4 a[144:147], v14, s[8:11], s63 offen offset:1024 sc1
    v_exp_f32 v117, v117
    v_exp_f32 v118, v118
    v_exp_f32 v119, v119
    v_pk_fma_f32 v[112:113], v[112:113], v[212:213], v[212:213] op_sel:[0,1,1] op_sel_hi:[1,1,1]
    v_pk_fma_f32 v[114:115], v[114:115], v[212:213], v[212:213] op_sel:[0,1,1] op_sel_hi:[1,1,1]
    v_pk_fma_f32 v[116:117], v[116:117], v[212:213], v[212:213] op_sel:[0,1,1] op_sel_hi:[1,1,1]
    v_pk_fma_f32 v[118:119], v[118:119], v[212:213], v[212:213] op_sel:[0,1,1] op_sel_hi:[1,1,1]
    v_rcp_f32 v112, v112
    v_rcp_f32 v113, v113
    v_rcp_f32 v114, v114
    v_rcp_f32 v115, v115
    v_rcp_f32 v116, v116
    v_rcp_f32 v117, v117
    v_rcp_f32 v118, v118
    v_rcp_f32 v119, v119
    v_pk_mul_f32 v[112:113], v[112:113], v[64:65]
    v_pk_mul_f32 v[114:115], v[114:115], v[66:67]
    v_pk_mul_f32 v[116:117], v[116:117], v[68:69]
    v_pk_mul_f32 v[118:119], v[118:119], v[70:71]
    v_cvt_pk_bf16_f32 v136, v112, v113
    v_cvt_pk_bf16_f32 v137, v114, v115
    v_cvt_pk_bf16_f32 v138, v116, v117
    v_cvt_pk_bf16_f32 v139, v118, v119
    buffer_store_dwordx4 v[136:139], v11, s[8:11], s19 offen offset:2048 sc1
    s_waitcnt vmcnt(6)
    s_mov_b64 exec, 1
    buffer_store_dword v13, v14, s[8:11], s21 offen sc1
    s_mov_b64 exec, -1
    s_nop 0
    v_pk_mul_f32 v[112:113], v[72:73], v[72:73]
    v_pk_mul_f32 v[114:115], v[74:75], v[74:75]
    v_pk_mul_f32 v[116:117], v[76:77], v[76:77]
    v_pk_mul_f32 v[118:119], v[78:79], v[78:79]
    v_pk_fma_f32 v[112:113], v[112:113], v[210:211], v[208:209] op_sel:[0,1,1] op_sel_hi:[1,1,1]
    v_pk_fma_f32 v[114:115], v[114:115], v[210:211], v[208:209] op_sel:[0,1,1] op_sel_hi:[1,1,1]
    v_pk_fma_f32 v[116:117], v[116:117], v[210:211], v[208:209] op_sel:[0,1,1] op_sel_hi:[1,1,1]
    buffer_load_dwordx4 a[148:151], v14, s[8:11], s63 offen offset:2048 sc1
    v_pk_fma_f32 v[118:119], v[118:119], v[210:211], v[208:209] op_sel:[0,1,1] op_sel_hi:[1,1,1]
    v_pk_mul_f32 v[112:113], v[112:113], v[72:73]
    v_pk_mul_f32 v[114:115], v[114:115], v[74:75]
    v_pk_mul_f32 v[116:117], v[116:117], v[76:77]
    v_pk_mul_f32 v[118:119], v[118:119], v[78:79]
    v_exp_f32 v112, v112
    v_exp_f32 v113, v113
    v_exp_f32 v114, v114
    v_exp_f32 v115, v115
    v_exp_f32 v116, v116
    v_exp_f32 v117, v117
    v_exp_f32 v118, v118
    v_exp_f32 v119, v119
    v_pk_fma_f32 v[112:113], v[112:113], v[212:213], v[212:213] op_sel:[0,1,1] op_sel_hi:[1,1,1]
    v_pk_fma_f32 v[114:115], v[114:115], v[212:213], v[212:213] op_sel:[0,1,1] op_sel_hi:[1,1,1]
    v_pk_fma_f32 v[116:117], v[116:117], v[212:213], v[212:213] op_sel:[0,1,1] op_sel_hi:[1,1,1]
    v_pk_fma_f32 v[118:119], v[118:119], v[212:213], v[212:213] op_sel:[0,1,1] op_sel_hi:[1,1,1]
    v_rcp_f32 v112, v112
    v_rcp_f32 v113, v113
    v_rcp_f32 v114, v114
    v_rcp_f32 v115, v115
    v_rcp_f32 v116, v116
    v_rcp_f32 v117, v117
    v_rcp_f32 v118, v118
    v_rcp_f32 v119, v119
    v_pk_mul_f32 v[112:113], v[112:113], v[72:73]
    v_pk_mul_f32 v[114:115], v[114:115], v[74:75]
    v_pk_mul_f32 v[116:117], v[116:117], v[76:77]
    v_pk_mul_f32 v[118:119], v[118:119], v[78:79]
    buffer_load_dwordx4 a[152:155], v14, s[8:11], s63 offen offset:3072 sc1
    v_cvt_pk_bf16_f32 v140, v112, v113
    v_cvt_pk_bf16_f32 v141, v114, v115
    v_cvt_pk_bf16_f32 v142, v116, v117
    v_cvt_pk_bf16_f32 v143, v118, v119
    buffer_store_dwordx4 v[140:143], v11, s[8:11], s19 offen offset:2560 sc1
    v_pk_mul_f32 v[112:113], v[80:81], v[80:81]
    v_pk_mul_f32 v[114:115], v[82:83], v[82:83]
    v_pk_mul_f32 v[116:117], v[84:85], v[84:85]
    v_pk_mul_f32 v[118:119], v[86:87], v[86:87]
    v_pk_fma_f32 v[112:113], v[112:113], v[210:211], v[208:209] op_sel:[0,0,0] op_sel_hi:[1,0,0]
    v_pk_fma_f32 v[114:115], v[114:115], v[210:211], v[208:209] op_sel:[0,0,0] op_sel_hi:[1,0,0]
    v_pk_fma_f32 v[116:117], v[116:117], v[210:211], v[208:209] op_sel:[0,0,0] op_sel_hi:[1,0,0]
    v_pk_fma_f32 v[118:119], v[118:119], v[210:211], v[208:209] op_sel:[0,0,0] op_sel_hi:[1,0,0]
    v_pk_mul_f32 v[112:113], v[112:113], v[80:81]
    v_pk_mul_f32 v[114:115], v[114:115], v[82:83]
    v_pk_mul_f32 v[116:117], v[116:117], v[84:85]
    v_pk_mul_f32 v[118:119], v[118:119], v[86:87]
    v_exp_f32 v112, v112
    v_exp_f32 v113, v113
    v_exp_f32 v114, v114
    v_exp_f32 v115, v115
    v_exp_f32 v116, v116
    v_exp_f32 v117, v117
    v_exp_f32 v118, v118
    v_exp_f32 v119, v119
    v_pk_fma_f32 v[112:113], v[112:113], v[212:213], v[212:213] op_sel:[0,0,0] op_sel_hi:[1,0,0]
    v_pk_fma_f32 v[114:115], v[114:115], v[212:213], v[212:213] op_sel:[0,0,0] op_sel_hi:[1,0,0]
    v_pk_fma_f32 v[116:117], v[116:117], v[212:213], v[212:213] op_sel:[0,0,0] op_sel_hi:[1,0,0]
    v_pk_fma_f32 v[118:119], v[118:119], v[212:213], v[212:213] op_sel:[0,0,0] op_sel_hi:[1,0,0]
    v_rcp_f32 v112, v112
    v_rcp_f32 v113, v113
    v_rcp_f32 v114, v114
    v_rcp_f32 v115, v115
    buffer_load_dwordx4 a[156:159], v15, s[8:11], s63 offen sc1
    v_rcp_f32 v116, v116
    v_rcp_f32 v117, v117
    v_rcp_f32 v118, v118
    v_rcp_f32 v119, v119
    v_pk_mul_f32 v[112:113], v[112:113], v[80:81]
    v_pk_mul_f32 v[114:115], v[114:115], v[82:83]
    v_pk_mul_f32 v[116:117], v[116:117], v[84:85]
    v_pk_mul_f32 v[118:119], v[118:119], v[86:87]
    v_cvt_pk_bf16_f32 v128, v112, v113
    v_cvt_pk_bf16_f32 v129, v114, v115
    v_cvt_pk_bf16_f32 v130, v116, v117
    v_cvt_pk_bf16_f32 v131, v118, v119
    buffer_store_dwordx4 v[128:131], v11, s[8:11], s20 offen offset:0 sc1
    v_pk_mul_f32 v[112:113], v[88:89], v[88:89]
    v_pk_mul_f32 v[114:115], v[90:91], v[90:91]
    v_pk_mul_f32 v[116:117], v[92:93], v[92:93]
    v_pk_mul_f32 v[118:119], v[94:95], v[94:95]
    v_pk_fma_f32 v[112:113], v[112:113], v[210:211], v[208:209] op_sel:[0,0,0] op_sel_hi:[1,0,0]
    v_pk_fma_f32 v[114:115], v[114:115], v[210:211], v[208:209] op_sel:[0,0,0] op_sel_hi:[1,0,0]
    v_pk_fma_f32 v[116:117], v[116:117], v[210:211], v[208:209] op_sel:[0,0,0] op_sel_hi:[1,0,0]
    v_pk_fma_f32 v[118:119], v[118:119], v[210:211], v[208:209] op_sel:[0,0,0] op_sel_hi:[1,0,0]
    v_pk_mul_f32 v[112:113], v[112:113], v[88:89]
    v_pk_mul_f32 v[114:115], v[114:115], v[90:91]
    v_pk_mul_f32 v[116:117], v[116:117], v[92:93]
    v_pk_mul_f32 v[118:119], v[118:119], v[94:95]
    v_exp_f32 v112, v112
    v_exp_f32 v113, v113
    v_exp_f32 v114, v114
    v_exp_f32 v115, v115
    v_exp_f32 v116, v116
    v_exp_f32 v117, v117
    v_exp_f32 v118, v118
    v_exp_f32 v119, v119
    s_add_u32 s63, s63, 5120
    buffer_load_dwordx4 a[160:163], v14, s[8:11], s63 offen offset:0 sc1
    v_pk_fma_f32 v[112:113], v[112:113], v[212:213], v[212:213] op_sel:[0,0,0] op_sel_hi:[1,0,0]
    v_pk_fma_f32 v[114:115], v[114:115], v[212:213], v[212:213] op_sel:[0,0,0] op_sel_hi:[1,0,0]
    v_pk_fma_f32 v[116:117], v[116:117], v[212:213], v[212:213] op_sel:[0,0,0] op_sel_hi:[1,0,0]
    v_pk_fma_f32 v[118:119], v[118:119], v[212:213], v[212:213] op_sel:[0,0,0] op_sel_hi:[1,0,0]
    v_rcp_f32 v112, v112
    v_rcp_f32 v113, v113
    v_rcp_f32 v114, v114
    v_rcp_f32 v115, v115
    v_rcp_f32 v116, v116
    v_rcp_f32 v117, v117
    v_rcp_f32 v118, v118
    v_rcp_f32 v119, v119
    v_pk_mul_f32 v[112:113], v[112:113], v[88:89]
    v_pk_mul_f32 v[114:115], v[114:115], v[90:91]
    v_pk_mul_f32 v[116:117], v[116:117], v[92:93]
    v_pk_mul_f32 v[118:119], v[118:119], v[94:95]
    v_cvt_pk_bf16_f32 v132, v112, v113
    v_cvt_pk_bf16_f32 v133, v114, v115
    v_cvt_pk_bf16_f32 v134, v116, v117
    v_cvt_pk_bf16_f32 v135, v118, v119
    buffer_store_dwordx4 v[132:135], v11, s[8:11], s20 offen offset:512 sc1
    s_buffer_load_dwordx8 s[24:31], s[8:11], s42 offset:0 glc
    v_pk_mul_f32 v[112:113], v[96:97], v[96:97]
    v_pk_mul_f32 v[114:115], v[98:99], v[98:99]
    v_pk_mul_f32 v[116:117], v[100:101], v[100:101]
    v_pk_mul_f32 v[118:119], v[102:103], v[102:103]
    v_pk_fma_f32 v[112:113], v[112:113], v[210:211], v[208:209] op_sel:[0,1,1] op_sel_hi:[1,1,1]
    v_pk_fma_f32 v[114:115], v[114:115], v[210:211], v[208:209] op_sel:[0,1,1] op_sel_hi:[1,1,1]
    v_pk_fma_f32 v[116:117], v[116:117], v[210:211], v[208:209] op_sel:[0,1,1] op_sel_hi:[1,1,1]
    v_pk_fma_f32 v[118:119], v[118:119], v[210:211], v[208:209] op_sel:[0,1,1] op_sel_hi:[1,1,1]
    v_pk_mul_f32 v[112:113], v[112:113], v[96:97]
    v_pk_mul_f32 v[114:115], v[114:115], v[98:99]
    v_pk_mul_f32 v[116:117], v[116:117], v[100:101]
    v_pk_mul_f32 v[118:119], v[118:119], v[102:103]
    v_exp_f32 v112, v112
    v_exp_f32 v113, v113
    buffer_load_dwordx4 a[164:167], v14, s[8:11], s63 offen offset:1024 sc1
    v_exp_f32 v114, v114
    v_exp_f32 v115, v115
    v_exp_f32 v116, v116
    v_exp_f32 v117, v117
    v_exp_f32 v118, v118
    v_exp_f32 v119, v119
    v_pk_fma_f32 v[112:113], v[112:113], v[212:213], v[212:213] op_sel:[0,1,1] op_sel_hi:[1,1,1]
    v_pk_fma_f32 v[114:115], v[114:115], v[212:213], v[212:213] op_sel:[0,1,1] op_sel_hi:[1,1,1]
    v_pk_fma_f32 v[116:117], v[116:117], v[212:213], v[212:213] op_sel:[0,1,1] op_sel_hi:[1,1,1]
    v_pk_fma_f32 v[118:119], v[118:119], v[212:213], v[212:213] op_sel:[0,1,1] op_sel_hi:[1,1,1]
    v_rcp_f32 v112, v112
    v_rcp_f32 v113, v113
    v_rcp_f32 v114, v114
    v_rcp_f32 v115, v115
    v_rcp_f32 v116, v116
    v_rcp_f32 v117, v117
    v_rcp_f32 v118, v118
    v_rcp_f32 v119, v119
    v_pk_mul_f32 v[112:113], v[112:113], v[96:97]
    v_pk_mul_f32 v[114:115], v[114:115], v[98:99]
    v_pk_mul_f32 v[116:117], v[116:117], v[100:101]
    v_pk_mul_f32 v[118:119], v[118:119], v[102:103]
    v_cvt_pk_bf16_f32 v136, v112, v113
    v_cvt_pk_bf16_f32 v137, v114, v115
    v_cvt_pk_bf16_f32 v138, v116, v117
    v_cvt_pk_bf16_f32 v139, v118, v119
    buffer_store_dwordx4 v[136:139], v11, s[8:11], s20 offen offset:2048 sc1
    s_waitcnt vmcnt(6)
    s_mov_b64 exec, 1
    buffer_store_dword v13, v14, s[8:11], s22 offen sc1
    s_mov_b64 exec, -1
    s_nop 0
    buffer_load_dwordx4 a[168:171], v14, s[8:11], s63 offen offset:2048 sc1
    v_pk_mul_f32 v[112:113], v[104:105], v[104:105]
    v_pk_mul_f32 v[114:115], v[106:107], v[106:107]
    v_pk_mul_f32 v[116:117], v[108:109], v[108:109]
    v_pk_mul_f32 v[118:119], v[110:111], v[110:111]
    v_pk_fma_f32 v[112:113], v[112:113], v[210:211], v[208:209] op_sel:[0,1,1] op_sel_hi:[1,1,1]
    v_pk_fma_f32 v[114:115], v[114:115], v[210:211], v[208:209] op_sel:[0,1,1] op_sel_hi:[1,1,1]
    v_pk_fma_f32 v[116:117], v[116:117], v[210:211], v[208:209] op_sel:[0,1,1] op_sel_hi:[1,1,1]
    v_pk_fma_f32 v[118:119], v[118:119], v[210:211], v[208:209] op_sel:[0,1,1] op_sel_hi:[1,1,1]
    v_pk_mul_f32 v[112:113], v[112:113], v[104:105]
    v_pk_mul_f32 v[114:115], v[114:115], v[106:107]
    v_pk_mul_f32 v[116:117], v[116:117], v[108:109]
    v_pk_mul_f32 v[118:119], v[118:119], v[110:111]
    v_exp_f32 v112, v112
    v_exp_f32 v113, v113
    v_exp_f32 v114, v114
    v_exp_f32 v115, v115
    v_exp_f32 v116, v116
    v_exp_f32 v117, v117
    v_exp_f32 v118, v118
    v_exp_f32 v119, v119
    v_pk_fma_f32 v[112:113], v[112:113], v[212:213], v[212:213] op_sel:[0,1,1] op_sel_hi:[1,1,1]
    v_pk_fma_f32 v[114:115], v[114:115], v[212:213], v[212:213] op_sel:[0,1,1] op_sel_hi:[1,1,1]
    v_pk_fma_f32 v[116:117], v[116:117], v[212:213], v[212:213] op_sel:[0,1,1] op_sel_hi:[1,1,1]
    v_pk_fma_f32 v[118:119], v[118:119], v[212:213], v[212:213] op_sel:[0,1,1] op_sel_hi:[1,1,1]
    v_rcp_f32 v112, v112
    v_rcp_f32 v113, v113
    v_rcp_f32 v114, v114
    v_rcp_f32 v115, v115
    v_rcp_f32 v116, v116
    v_rcp_f32 v117, v117
    v_rcp_f32 v118, v118
    buffer_load_dwordx4 a[172:175], v14, s[8:11], s63 offen offset:3072 sc1
    v_rcp_f32 v119, v119
    v_pk_mul_f32 v[112:113], v[112:113], v[104:105]
    v_pk_mul_f32 v[114:115], v[114:115], v[106:107]
    v_pk_mul_f32 v[116:117], v[116:117], v[108:109]
    v_pk_mul_f32 v[118:119], v[118:119], v[110:111]
    v_cvt_pk_bf16_f32 v140, v112, v113
    v_cvt_pk_bf16_f32 v141, v114, v115
    v_cvt_pk_bf16_f32 v142, v116, v117
    v_cvt_pk_bf16_f32 v143, v118, v119
    buffer_store_dwordx4 v[140:143], v11, s[8:11], s20 offen offset:2560 sc1
    s_waitcnt lgkmcnt(0)
    s_cmp_eq_u32 s24, s55
    s_cselect_b32 s24, s25, s24
    s_cmp_eq_u32 s24, s55
    s_cbranch_scc0 L_spin_ff_a0
L_ret_ff_a0:
    s_add_u32 s67, s40, 0
    buffer_load_dwordx4 v[176:179], v1, s[8:11], s67 offen sc1
    buffer_load_dwordx4 v[180:183], v2, s[8:11], s67 offen sc1
    buffer_load_dwordx4 v[184:187], v3, s[8:11], s67 offen sc1
    buffer_load_dwordx4 v[188:191], v4, s[8:11], s67 offen sc1
    s_add_u32 s67, s40, 4096
    buffer_load_dwordx4 v[192:195], v1, s[8:11], s67 offen sc1
    buffer_load_dwordx4 v[196:199], v2, s[8:11], s67 offen sc1
    buffer_load_dwordx4 v[200:203], v3, s[8:11], s67 offen sc1
    buffer_load_dwordx4 v[204:207], v4, s[8:11], s67 offen sc1
    buffer_load_dwordx4 a[176:179], v15, s[8:11], s63 offen sc1
    s_add_u32 s63, s63, 5120
    buffer_load_dwordx4 a[180:183], v14, s[8:11], s63 offen offset:0 sc1
    v_and_b32 v12, 15, v0
    v_lshrrev_b32 v11, 4, v0
    v_lshlrev_b32 v11, 3, v11
    s_mul_i32 s64, s52, 3072
    s_add_u32 s64, s64, 122880
    v_add_u32 v8, s64, v11
    v_mul_u32_u24 v6, 160, v12
    v_add_u32 v5, v6, v8
    s_sub_u32 s65, s52, 1
    s_and_b32 s65, s65, 3
    s_mul_i32 s64, s65, 3072
    s_add_u32 s64, s64, 122880
    v_add3_u32 v6, v6, v11, s64
    v_lshlrev_b32 v12, 3, v12
    v_add_u32_e64 v254, s64, v12
    ds_read_b64 v[254:255], v254 offset:2880
    ds_read_b64 v[226:227], v6 offset:0
    ds_read_b64 v[230:231], v6 offset:32
    ds_read_b64 v[234:235], v6 offset:64
    ds_read_b64 v[238:239], v6 offset:96
    ds_read_b64 v[242:243], v6 offset:128
    ds_read_b64 v[98:99], v8 offset:2720
    ds_read_b64 v[102:103], v8 offset:2752
    ds_read_b64 v[106:107], v8 offset:2784
    ds_read_b64 v[110:111], v8 offset:2816
    ds_read_b64 v[114:115], v8 offset:2848
    ds_read_b64 v[244:245], v8 offset:2560
    ds_read_b64 v[246:247], v8 offset:2592
    ds_read_b64 v[248:249], v8 offset:2624
    ds_read_b64 v[250:251], v8 offset:2656
    ds_read_b64 v[252:253], v8 offset:2688
    s_buffer_load_dwordx8 s[32:39], s[8:11], s42 offset:8 glc
    s_waitcnt vmcnt(10)
    s_mov_b64 exec, 1
    buffer_store_dword v13, v14, s[8:11], s23 offen sc1
    s_mov_b64 exec, -1
    s_waitcnt vmcnt(10)
    v_mfma_f32_16x16x32_bf16 v[16:19], a[0:3], v[176:179], 0
    s_waitcnt lgkmcnt(0)
    s_cmp_eq_u32 s32, s55
    s_cselect_b32 s32, s33, s32
    s_lshl_b32 s64, s65, 7
    v_mfma_f32_16x16x32_bf16 v[20:23], a[4:7], v[176:179], 0
    s_cmp_eq_u32 s32, s55
    s_cbranch_scc0 L_spin_ff_a1
L_ret_ff_a1:
    s_andn2_b32 s48, s48, 0x180
    v_mfma_f32_16x16x32_bf16 v[24:27], a[8:11], v[176:179], 0
    s_add_u32 s48, s48, s64
    s_buffer_load_dwordx8 s[24:31], s[8:11], s42 offset:16 glc
    v_mul_u32_u24 v10, 160, v12
    v_mfma_f32_16x16x32_bf16 v[28:31], a[12:15], v[176:179], 0
    s_add_u32 s67, s40, 8192
    v_add3_u32 v10, v10, v11, s46
    v_lshlrev_b32 v10, 1, v10
    v_mfma_f32_16x16x32_bf16 v[32:35], a[16:19], v[176:179], 0
    s_waitcnt vmcnt(9)
    buffer_load_dwordx4 a[240:243], v1, s[8:11], s67 offen sc1
    s_mul_i32 s64, s65, 5120
    v_mfma_f32_16x16x32_bf16 v[36:39], a[0:3], v[180:183], 0
    v_add_u32 v7, s64, v14
    v_lshl_add_u32 v6, v0, 2, s64
    v_mfma_f32_16x16x32_bf16 v[40:43], a[4:7], v[180:183], 0
    s_mul_i32 m0, s52, 5120
    v_add_u32 v11, m0, v14
    v_and_b32 v9, 7, v0
    v_mfma_f32_16x16x32_bf16 v[44:47], a[8:11], v[180:183], 0
    v_min_u32 v9, 4, v9
    v_lshl_add_u32 v9, v9, 2, s42
    v_mfma_f32_16x16x32_bf16 v[48:51], a[12:15], v[180:183], 0
    buffer_load_dwordx4 a[244:247], v2, s[8:11], s67 offen sc1
    v_and_b32 v8, 8, v0
    v_mfma_f32_16x16x32_bf16 v[52:55], a[16:19], v[180:183], 0
    s_waitcnt vmcnt(10)
    v_lshlrev_b32 v8, 6, v8
    v_xor_b32 v9, v9, v8
    v_mfma_f32_16x16x32_bf16 v[56:59], a[0:3], v[184:187], 0
    s_mul_i32 s64, s52, 15360
    v_add_u32 v8, s64, v14
    s_mov_b32 s72, 0x07060100
    v_mfma_f32_16x16x32_bf16 v[60:63], a[4:7], v[184:187], 0
    s_add_u32 s65, s45, 3072
    s_add_u32 s74, s44, 3072
    s_mov_b32 s68, 0xbfb8aa3b
    v_mfma_f32_16x16x32_bf16 v[64:67], a[8:11], v[184:187], 0
    s_mov_b32 s69, 0xbfb8aa3b
    buffer_load_dwordx4 a[248:251], v3, s[8:11], s67 offen sc1
    v_lshlrev_b32 v96, 16, v98
    v_mfma_f32_16x16x32_bf16 v[68:71], a[12:15], v[184:187], 0
    v_and_b32 v97, 0xffff0000, v98
    v_lshlrev_b32 v98, 16, v99
    v_mfma_f32_16x16x32_bf16 v[72:75], a[16:19], v[184:187], 0
    s_waitcnt vmcnt(10)
    v_and_b32 v99, 0xffff0000, v99
    v_lshlrev_b32 v100, 16, v102
    v_mfma_f32_16x16x32_bf16 v[76:79], a[0:3], v[188:191], 0
    v_and_b32 v101, 0xffff0000, v102
    v_lshlrev_b32 v102, 16, v103
    v_mfma_f32_16x16x32_bf16 v[80:83], a[4:7], v[188:191], 0
    buffer_load_dwordx4 a[252:255], v4, s[8:11], s67 offen sc1
    v_and_b32 v103, 0xffff0000, v103
    v_mfma_f32_16x16x32_bf16 v[84:87], a[8:11], v[188:191], 0
    v_lshlrev_b32 v104, 16, v106
    v_and_b32 v105, 0xffff0000, v106
    v_mfma_f32_16x16x32_bf16 v[88:91], a[12:15], v[188:191], 0
    s_add_u32 s67, s40, 12288
    v_lshlrev_b32 v106, 16, v107
    v_and_b32 v107, 0xffff0000, v107
    v_mfma_f32_16x16x32_bf16 v[92:95], a[16:19], v[188:191], 0
    s_waitcnt vmcnt(10)
    v_lshlrev_b32 v108, 16, v110
    v_and_b32 v109, 0xffff0000, v110
    v_mfma_f32_16x16x32_bf16 v[16:19], a[20:23], v[192:195], v[16:19]
    buffer_load_dwordx4 v[208:211], v1, s[8:11], s67 offen sc1
    v_lshlrev_b32 v110, 16, v111
    v_mfma_f32_16x16x32_bf16 v[20:23], a[24:27], v[192:195], v[20:23]
    v_and_b32 v111, 0xffff0000, v111
    v_lshlrev_b32 v112, 16, v114
    v_mfma_f32_16x16x32_bf16 v[24:27], a[28:31], v[192:195], v[24:27]
    buffer_load_dwordx4 a[184:187], v14, s[8:11], s63 offen offset:1024 sc1
    v_and_b32 v113, 0xffff0000, v114
    v_mfma_f32_16x16x32_bf16 v[28:31], a[32:35], v[192:195], v[28:31]
    v_lshlrev_b32 v114, 16, v115
    v_and_b32 v115, 0xffff0000, v115
    v_mfma_f32_16x16x32_bf16 v[32:35], a[36:39], v[192:195], v[32:35]
    s_waitcnt vmcnt(11)
    buffer_load_dwordx4 v[212:215], v2, s[8:11], s67 offen sc1
    v_mfma_f32_16x16x32_bf16 v[36:39], a[20:23], v[196:199], v[36:39]
    v_cmp_ne_u32 vcc, s55, v255
    s_nop 3
    s_cbranch_vccnz L_spin_ff_st
L_ret_ff_st:
    v_mfma_f32_16x16x32_bf16 v[40:43], a[24:27], v[196:199], v[40:43]
    v_and_b32 v255, 0xffff0000, v254
    v_mfma_f32_16x16x32_bf16 v[44:47], a[28:31], v[196:199], v[44:47]
    s_cmp_lg_u32 s3, 0
    s_waitcnt lgkmcnt(0)
    s_cselect_b32 s26, s55, s26
    v_mfma_f32_16x16x32_bf16 v[48:51], a[32:35], v[196:199], v[48:51]
    buffer_load_dwordx4 v[216:219], v3, s[8:11], s67 offen sc1
    v_mfma_f32_16x16x32_bf16 v[52:55], a[36:39], v[196:199], v[52:55]
    s_waitcnt vmcnt(12)
    s_cmp_eq_u32 s24, s55
    s_cselect_b32 s24, s25, s24
    v_mfma_f32_16x16x32_bf16 v[56:59], a[20:23], v[200:203], v[56:59]
    s_cmp_eq_u32 s24, s55
    s_cselect_b32 s24, s26, s24
    v_mfma_f32_16x16x32_bf16 v[60:63], a[24:27], v[200:203], v[60:63]
    s_cmp_eq_u32 s24, s55
    s_cbranch_scc0 L_spin_ff_a2
L_ret_ff_a2:
    v_mfma_f32_16x16x32_bf16 v[64:67], a[28:31], v[200:203], v[64:67]
    buffer_load_dwordx4 v[220:223], v4, s[8:11], s67 offen sc1
    v_mfma_f32_16x16x32_bf16 v[68:71], a[32:35], v[200:203], v[68:71]
    v_rcp_f32 v255, v255
    v_mfma_f32_16x16x32_bf16 v[72:75], a[36:39], v[200:203], v[72:75]
    s_waitcnt vmcnt(12)
    v_lshlrev_b32 v254, 16, v254
    v_mul_f32 v254, v254, v255
    v_mfma_f32_16x16x32_bf16 v[76:79], a[20:23], v[204:207], v[76:79]
    s_add_u32 s67, s40, 16384
    v_lshlrev_b32 v224, 16, v226
    v_and_b32 v225, 0xffff0000, v226
    v_mfma_f32_16x16x32_bf16 v[80:83], a[24:27], v[204:207], v[80:83]
    buffer_load_dwordx4 v[136:139], v2, s[8:11], s67 offen sc1
    buffer_load_dwordx4 a[188:191], v14, s[8:11], s63 offen offset:2048 sc1
    v_mfma_f32_16x16x32_bf16 v[84:87], a[28:31], v[204:207], v[84:87]
    v_lshlrev_b32 v226, 16, v227
    v_and_b32 v227, 0xffff0000, v227
    v_mfma_f32_16x16x32_bf16 v[88:91], a[32:35], v[204:207], v[88:91]
    s_add_u32 s67, s40, 20480
    v_fma_f32 v224, v224, v255, v254
    v_fma_f32 v225, v225, v255, v254
    v_mfma_f32_16x16x32_bf16 v[92:95], a[36:39], v[204:207], v[92:95]
    s_waitcnt vmcnt(10)
    v_fma_f32 v226, v226, v255, v254
    v_fma_f32 v227, v227, v255, v254
    v_mfma_f32_16x16x32_bf16 v[16:19], a[40:43], a[240:243], v[16:19]
    buffer_load_dwordx4 v[140:143], v2, s[8:11], s67 offen sc1
    v_lshlrev_b32 v228, 16, v230
    v_mfma_f32_16x16x32_bf16 v[20:23], a[44:47], a[240:243], v[20:23]
    s_buffer_load_dwordx8 s[32:39], s[8:11], s43 offset:0 glc
    v_and_b32 v229, 0xffff0000, v230
    v_mfma_f32_16x16x32_bf16 v[24:27], a[48:51], a[240:243], v[24:27]
    v_lshlrev_b32 v230, 16, v231
    v_and_b32 v231, 0xffff0000, v231
    v_mfma_f32_16x16x32_bf16 v[28:31], a[52:55], a[240:243], v[28:31]
    s_add_u32 s67, s40, 24576
    s_or_b32 s67, s67, s3
    v_mfma_f32_16x16x32_bf16 v[32:35], a[56:59], a[240:243], v[32:35]
    s_waitcnt vmcnt(10)
    buffer_load_dwordx4 v[144:147], v2, s[8:11], s67 offen sc1
    v_fma_f32 v228, v228, v255, v254
    v_mfma_f32_16x16x32_bf16 v[36:39], a[40:43], a[244:247], v[36:39]
    v_fma_f32 v229, v229, v255, v254
    v_fma_f32 v230, v230, v255, v254
    v_mfma_f32_16x16x32_bf16 v[40:43], a[44:47], a[244:247], v[40:43]
    v_fma_f32 v231, v231, v255, v254
    v_lshlrev_b32 v232, 16, v234
    v_mfma_f32_16x16x32_bf16 v[44:47], a[48:51], a[244:247], v[44:47]
    s_add_u32 s67, s40, 16384
    v_and_b32 v233, 0xffff0000, v234
    v_lshlrev_b32 v234, 16, v235
    v_mfma_f32_16x16x32_bf16 v[48:51], a[52:55], a[244:247], v[48:51]
    buffer_load_dwordx4 v[148:151], v3, s[8:11], s67 offen sc1
    v_and_b32 v235, 0xffff0000, v235
    v_mfma_f32_16x16x32_bf16 v[52:55], a[56:59], a[244:247], v[52:55]
    s_waitcnt vmcnt(11)
    v_fma_f32 v232, v232, v255, v254
    v_fma_f32 v233, v233, v255, v254
    v_mfma_f32_16x16x32_bf16 v[56:59], a[40:43], a[248:251], v[56:59]
    buffer_load_dwordx4 a[192:195], v14, s[8:11], s63 offen offset:3072 sc1
    v_fma_f32 v234, v234, v255, v254
    v_mfma_f32_16x16x32_bf16 v[60:63], a[44:47], a[248:251], v[60:63]
    s_add_u32 s67, s40, 20480
    v_fma_f32 v235, v235, v255, v254
    v_lshlrev_b32 v236, 16, v238
    v_mfma_f32_16x16x32_bf16 v[64:67], a[48:51], a[248:251], v[64:67]
    buffer_load_dwordx4 v[152:155], v3, s[8:11], s67 offen sc1
    v_and_b32 v237, 0xffff0000, v238
    v_mfma_f32_16x16x32_bf16 v[68:71], a[52:55], a[248:251], v[68:71]
    v_lshlrev_b32 v238, 16, v239
    v_and_b32 v239, 0xffff0000, v239
    v_mfma_f32_16x16x32_bf16 v[72:75], a[56:59], a[248:251], v[72:75]
    s_waitcnt vmcnt(12)
    v_fma_f32 v236, v236, v255, v254
    v_fma_f32 v237, v237, v255, v254
    v_mfma_f32_16x16x32_bf16 v[76:79], a[40:43], a[252:255], v[76:79]
    s_add_u32 s67, s40, 24576
    s_or_b32 s67, s67, s3
    v_mfma_f32_16x16x32_bf16 v[80:83], a[44:47], a[252:255], v[80:83]
    buffer_load_dwordx4 v[156:159], v3, s[8:11], s67 offen sc1
    v_fma_f32 v238, v238, v255, v254
    v_mfma_f32_16x16x32_bf16 v[84:87], a[48:51], a[252:255], v[84:87]
    v_fma_f32 v239, v239, v255, v254
    v_lshlrev_b32 v240, 16, v242
    v_mfma_f32_16x16x32_bf16 v[88:91], a[52:55], a[252:255], v[88:91]
    s_add_u32 s67, s40, 16384
    v_and_b32 v241, 0xffff0000, v242
    v_lshlrev_b32 v242, 16, v243
    v_mfma_f32_16x16x32_bf16 v[92:95], a[56:59], a[252:255], v[92:95]
    s_waitcnt vmcnt(12)
    v_and_b32 v243, 0xffff0000, v243
    v_fma_f32 v240, v240, v255, v254
    v_mfma_f32_16x16x32_bf16 v[16:19], a[60:63], v[208:211], v[16:19]
    buffer_load_dwordx4 v[160:163], v4, s[8:11], s67 offen sc1
    v_fma_f32 v241, v241, v255, v254
    v_mfma_f32_16x16x32_bf16 v[20:23], a[64:67], v[208:211], v[20:23]
    v_fma_f32 v242, v242, v255, v254
    v_fma_f32 v243, v243, v255, v254
    v_mfma_f32_16x16x32_bf16 v[24:27], a[68:71], v[208:211], v[24:27]
    v_lshlrev_b32 v12, 16, v244
    v_mul_f32 v224, v224, v12
    v_mfma_f32_16x16x32_bf16 v[28:31], a[72:75], v[208:211], v[28:31]
    s_add_u32 s67, s40, 20480
    v_and_b32 v12, 0xffff0000, v244
    v_mul_f32 v225, v225, v12
    v_mfma_f32_16x16x32_bf16 v[32:35], a[76:79], v[208:211], v[32:35]
    s_waitcnt vmcnt(11)
    buffer_load_dwordx4 v[164:167], v4, s[8:11], s67 offen sc1
    buffer_load_dwordx4 a[196:199], v15, s[8:11], s63 offen sc1
    v_mfma_f32_16x16x32_bf16 v[36:39], a[60:63], v[212:215], v[36:39]
    v_lshlrev_b32 v12, 16, v245
    v_mul_f32 v226, v226, v12
    v_mfma_f32_16x16x32_bf16 v[40:43], a[64:67], v[212:215], v[40:43]
    v_and_b32 v12, 0xffff0000, v245
    v_mul_f32 v227, v227, v12
    v_mfma_f32_16x16x32_bf16 v[44:47], a[68:71], v[212:215], v[44:47]
    s_add_u32 s67, s40, 24576
    s_or_b32 s67, s67, s3
    v_mfma_f32_16x16x32_bf16 v[48:51], a[72:75], v[212:215], v[48:51]
    buffer_load_dwordx4 v[168:171], v4, s[8:11], s67 offen sc1
    v_lshlrev_b32 v12, 16, v246
    v_mfma_f32_16x16x32_bf16 v[52:55], a[76:79], v[212:215], v[52:55]
    s_waitcnt vmcnt(13)
    s_cmp_lg_u32 s3, 0
    s_waitcnt lgkmcnt(0)
    s_cselect_b32 s38, s55, s38
    v_mfma_f32_16x16x32_bf16 v[56:59], a[60:63], v[216:219], v[56:59]
    s_cmp_eq_u32 s32, s55
    s_cselect_b32 s32, s33, s32
    v_mul_f32 v228, v228, v12
    v_mfma_f32_16x16x32_bf16 v[60:63], a[64:67], v[216:219], v[60:63]
    s_add_u32 s67, s40, 16384
    s_cmp_eq_u32 s32, s55
    s_cselect_b32 s32, s34, s32
    v_mfma_f32_16x16x32_bf16 v[64:67], a[68:71], v[216:219], v[64:67]
    buffer_load_dwordx4 v[172:175], v1, s[8:11], s67 offen sc1
    v_and_b32 v12, 0xffff0000, v246
    v_mfma_f32_16x16x32_bf16 v[68:71], a[72:75], v[216:219], v[68:71]
    s_cmp_eq_u32 s32, s55
    s_cselect_b32 s32, s35, s32
    v_mul_f32 v229, v229, v12
    v_mfma_f32_16x16x32_bf16 v[72:75], a[76:79], v[216:219], v[72:75]
    s_waitcnt vmcnt(13)
    s_cmp_eq_u32 s32, s55
    s_cselect_b32 s32, s36, s32
    v_mfma_f32_16x16x32_bf16 v[76:79], a[60:63], v[220:223], v[76:79]
    s_add_u32 s67, s40, 20480
    s_cmp_eq_u32 s32, s55
    s_cselect_b32 s32, s37, s32
    v_mfma_f32_16x16x32_bf16 v[80:83], a[64:67], v[220:223], v[80:83]
    buffer_load_dwordx4 v[176:179], v1, s[8:11], s67 offen sc1
    v_lshlrev_b32 v12, 16, v247
    v_mfma_f32_16x16x32_bf16 v[84:87], a[68:71], v[220:223], v[84:87]
    s_cmp_eq_u32 s32, s55
    s_cselect_b32 s32, s38, s32
    v_mul_f32 v230, v230, v12
    v_mfma_f32_16x16x32_bf16 v[88:91], a[72:75], v[220:223], v[88:91]
    s_cmp_eq_u32 s32, s55
    s_cbranch_scc0 L_spin_ff_a3
L_ret_ff_a3:
    v_and_b32 v12, 0xffff0000, v247
    v_mfma_f32_16x16x32_bf16 v[92:95], a[76:79], v[220:223], v[92:95]
    s_waitcnt vmcnt(13)
    s_add_u32 s67, s40, 24576
    s_or_b32 s67, s67, s3
    v_mfma_f32_16x16x32_bf16 v[36:39], a[80:83], v[136:139], v[36:39]
    buffer_load_dwordx4 v[180:183], v1, s[8:11], s67 offen sc1
    v_mul_f32 v231, v231, v12
    v_mfma_f32_16x16x32_bf16 v[40:43], a[84:87], v[136:139], v[40:43]
    s_add_u32 s63, s63, 5120
    buffer_load_dwordx4 a[200:203], v14, s[8:11], s63 offen offset:0 sc1
    v_lshlrev_b32 v12, 16, v248
    v_mfma_f32_16x16x32_bf16 v[44:47], a[88:91], v[136:139], v[44:47]
    v_mul_f32 v232, v232, v12
    v_and_b32 v12, 0xffff0000, v248
    v_mfma_f32_16x16x32_bf16 v[48:51], a[92:95], v[136:139], v[48:51]
    s_add_u32 s67, s41, 0
    v_mul_f32 v233, v233, v12
    v_lshlrev_b32 v12, 16, v249
    v_mfma_f32_16x16x32_bf16 v[52:55], a[96:99], v[136:139], v[52:55]
    s_waitcnt vmcnt(13)
    buffer_load_dwordx4 v[184:187], v4, s[8:11], s67 offen sc1
    v_mul_f32 v234, v234, v12
    v_mfma_f32_16x16x32_bf16 v[36:39], a[100:103], v[140:143], v[36:39]
    v_and_b32 v12, 0xffff0000, v249
    v_mul_f32 v235, v235, v12
    v_mfma_f32_16x16x32_bf16 v[40:43], a[104:107], v[140:143], v[40:43]
    s_barrier
    v_lshlrev_b32 v12, 16, v250
    v_mfma_f32_16x16x32_bf16 v[44:47], a[108:111], v[140:143], v[44:47]
    s_add_u32 s67, s41, 4096
    v_mul_f32 v236, v236, v12
    v_and_b32 v12, 0xffff0000, v250
    v_mfma_f32_16x16x32_bf16 v[48:51], a[112:115], v[140:143], v[48:51]
    buffer_load_dwordx4 v[188:191], v4, s[8:11], s67 offen sc1
    v_mul_f32 v237, v237, v12
    v_mfma_f32_16x16x32_bf16 v[52:55], a[116:119], v[140:143], v[52:55]
    s_waitcnt vmcnt(14)
    v_lshlrev_b32 v12, 16, v251
    v_mul_f32 v238, v238, v12
    v_mfma_f32_16x16x32_bf16 v[36:39], a[120:123], v[144:147], v[36:39]
    v_and_b32 v12, 0xffff0000, v251
    v_mul_f32 v239, v239, v12
    v_mfma_f32_16x16x32_bf16 v[40:43], a[124:127], v[144:147], v[40:43]
    s_add_u32 s67, s41, 8192
    v_lshlrev_b32 v12, 16, v252
    v_mul_f32 v240, v240, v12
    v_mfma_f32_16x16x32_bf16 v[44:47], a[128:131], v[144:147], v[44:47]
    buffer_load_dwordx4 v[192:195], v4, s[8:11], s67 offen sc1
    v_and_b32 v12, 0xffff0000, v252
    v_mfma_f32_16x16x32_bf16 v[48:51], a[132:135], v[144:147], v[48:51]
    v_mul_f32 v241, v241, v12
    v_lshlrev_b32 v12, 16, v253
    v_mfma_f32_16x16x32_bf16 v[52:55], a[136:139], v[144:147], v[52:55]
    s_waitcnt vmcnt(14)
    v_mul_f32 v242, v242, v12
    v_and_b32 v12, 0xffff0000, v253
    v_mfma_f32_16x16x32_bf16 v[56:59], a[80:83], v[148:151], v[56:59]
    s_add_u32 s67, s41, 12288
    buffer_load_dwordx4 a[204:207], v14, s[8:11], s63 offen offset:1024 sc1
    v_mul_f32 v243, v243, v12
    v_mfma_f32_16x16x32_bf16 v[60:63], a[84:87], v[148:151], v[60:63]
    s_sub_u32 s64, s52, 1
    buffer_load_dwordx4 v[196:199], v4, s[8:11], s67 offen sc1
    s_and_b32 s64, s64, 3
    v_mfma_f32_16x16x32_bf16 v[64:67], a[88:91], v[148:151], v[64:67]
    s_mul_i32 s64, s64, 15360
    ds_write_b128 v8, v[36:39] offset:40960
    v_mfma_f32_16x16x32_bf16 v[68:71], a[92:95], v[148:151], v[68:71]
    s_add_u32 s67, s41, 16384
    v_add_u32 v253, s64, v14
    s_sub_u32 s64, s52, 2
    v_mfma_f32_16x16x32_bf16 v[72:75], a[96:99], v[148:151], v[72:75]
    s_waitcnt vmcnt(14)
    ds_write_b128 v8, v[40:43] offset:41984
    v_mfma_f32_16x16x32_bf16 v[56:59], a[100:103], v[152:155], v[56:59]
    s_and_b32 s64, s64, 3
    buffer_load_dwordx4 v[200:203], v4, s[8:11], s67 offen sc1
    s_mul_i32 s64, s64, 15360
    v_mfma_f32_16x16x32_bf16 v[60:63], a[104:107], v[152:155], v[60:63]
    ds_write_b128 v8, v[44:47] offset:43008
    v_mfma_f32_16x16x32_bf16 v[64:67], a[108:111], v[152:155], v[64:67]
    v_add_u32 v254, s64, v14
    s_sub_u32 s64, s52, 3
    v_mfma_f32_16x16x32_bf16 v[68:71], a[112:115], v[152:155], v[68:71]
    s_add_u32 s67, s41, 20480
    ds_write_b128 v8, v[48:51] offset:44032
    v_mfma_f32_16x16x32_bf16 v[72:75], a[116:119], v[152:155], v[72:75]
    s_waitcnt vmcnt(14)
    buffer_load_dwordx4 v[204:207], v4, s[8:11], s67 offen sc1
    s_and_b32 s64, s64, 3
    v_mfma_f32_16x16x32_bf16 v[56:59], a[120:123], v[156:159], v[56:59]
    s_mul_i32 s64, s64, 15360
    ds_write_b128 v8, v[52:55] offset:45056
    v_mfma_f32_16x16x32_bf16 v[60:63], a[124:127], v[156:159], v[60:63]
    v_add_u32 v255, s64, v14
    v_mfma_f32_16x16x32_bf16 v[64:67], a[128:131], v[156:159], v[64:67]
    s_add_u32 s67, s41, 24576
    s_or_b32 s67, s67, s3
    v_mfma_f32_16x16x32_bf16 v[68:71], a[132:135], v[156:159], v[68:71]
    buffer_load_dwordx4 a[240:243], v4, s[8:11], s67 offen sc1
    v_mfma_f32_16x16x32_bf16 v[72:75], a[136:139], v[156:159], v[72:75]
    s_waitcnt vmcnt(15)
    buffer_load_dwordx4 a[208:211], v14, s[8:11], s63 offen offset:2048 sc1
    v_mfma_f32_16x16x32_bf16 v[76:79], a[80:83], v[160:163], v[76:79]
    ds_write_b128 v8, v[56:59] offset:46080
    v_mfma_f32_16x16x32_bf16 v[80:83], a[84:87], v[160:163], v[80:83]
    v_mfma_f32_16x16x32_bf16 v[84:87], a[88:91], v[160:163], v[84:87]
    ds_write_b128 v8, v[60:63] offset:47104
    v_mfma_f32_16x16x32_bf16 v[88:91], a[92:95], v[160:163], v[88:91]
    s_add_u32 s67, s41, 0
    v_mfma_f32_16x16x32_bf16 v[92:95], a[96:99], v[160:163], v[92:95]
    s_waitcnt vmcnt(15)
    ds_write_b128 v8, v[64:67] offset:48128
    v_mfma_f32_16x16x32_bf16 v[76:79], a[100:103], v[164:167], v[76:79]
    buffer_load_dwordx4 a[244:247], v3, s[8:11], s67 offen sc1
    v_mfma_f32_16x16x32_bf16 v[80:83], a[104:107], v[164:167], v[80:83]
    ds_write_b128 v8, v[68:71] offset:49152
    v_mfma_f32_16x16x32_bf16 v[84:87], a[108:111], v[164:167], v[84:87]
    v_mfma_f32_16x16x32_bf16 v[88:91], a[112:115], v[164:167], v[88:91]
    s_add_u32 s67, s41, 4096
    ds_write_b128 v8, v[72:75] offset:50176
    v_mfma_f32_16x16x32_bf16 v[92:95], a[116:119], v[164:167], v[92:95]
    s_waitcnt vmcnt(14)
    buffer_load_dwordx4 a[248:251], v3, s[8:11], s67 offen sc1
    v_mfma_f32_16x16x32_bf16 v[76:79], a[120:123], v[168:171], v[76:79]
    v_mfma_f32_16x16x32_bf16 v[80:83], a[124:127], v[168:171], v[80:83]
    v_mfma_f32_16x16x32_bf16 v[84:87], a[128:131], v[168:171], v[84:87]
    s_add_u32 s67, s41, 8192
    v_mfma_f32_16x16x32_bf16 v[88:91], a[132:135], v[168:171], v[88:91]
    buffer_load_dwordx4 a[252:255], v3, s[8:11], s67 offen sc1
    buffer_load_dwordx4 a[212:215], v14, s[8:11], s63 offen offset:3072 sc1
    v_mfma_f32_16x16x32_bf16 v[92:95], a[136:139], v[168:171], v[92:95]
    s_waitcnt vmcnt(16) lgkmcnt(0)
    s_barrier
    v_mfma_f32_16x16x32_bf16 v[16:19], a[80:83], v[172:175], v[16:19]
    ds_write_b128 v8, v[76:79] offset:51200
    v_mfma_f32_16x16x32_bf16 v[20:23], a[84:87], v[172:175], v[20:23]
    s_add_u32 s67, s41, 12288
    ds_read_b128 v[36:39], v253 offset:40960
    ds_read_b128 v[40:43], v253 offset:41984
    v_mfma_f32_16x16x32_bf16 v[24:27], a[88:91], v[172:175], v[24:27]
    buffer_load_dwordx4 v[208:211], v3, s[8:11], s67 offen sc1
    ds_read_b128 v[44:47], v253 offset:43008
    v_mfma_f32_16x16x32_bf16 v[28:31], a[92:95], v[172:175], v[28:31]
    ds_write_b128 v8, v[80:83] offset:52224
    v_mfma_f32_16x16x32_bf16 v[32:35], a[96:99], v[172:175], v[32:35]
    s_waitcnt vmcnt(16)
    ds_read_b128 v[48:51], v253 offset:44032
    ds_read_b128 v[52:55], v253 offset:45056
    v_mfma_f32_16x16x32_bf16 v[16:19], a[100:103], v[176:179], v[16:19]
    s_add_u32 s67, s41, 16384
    ds_write_b128 v8, v[84:87] offset:53248
    v_mfma_f32_16x16x32_bf16 v[20:23], a[104:107], v[176:179], v[20:23]
    buffer_load_dwordx4 v[212:215], v3, s[8:11], s67 offen sc1
    ds_read_b128 v[56:59], v254 offset:46080
    v_mfma_f32_16x16x32_bf16 v[24:27], a[108:111], v[176:179], v[24:27]
    ds_write_b128 v8, v[88:91] offset:54272
    v_mfma_f32_16x16x32_bf16 v[28:31], a[112:115], v[176:179], v[28:31]
    s_add_u32 s67, s41, 20480
    ds_read_b128 v[60:63], v254 offset:47104
    ds_read_b128 v[64:67], v254 offset:48128
    v_mfma_f32_16x16x32_bf16 v[32:35], a[116:119], v[176:179], v[32:35]
    s_waitcnt vmcnt(16)
    ds_write_b128 v8, v[92:95] offset:55296
    v_mfma_f32_16x16x32_bf16 v[16:19], a[120:123], v[180:183], v[16:19]
    buffer_load_dwordx4 v[216:219], v3, s[8:11], s67 offen sc1
    ds_read_b128 v[68:71], v254 offset:49152
    v_mfma_f32_16x16x32_bf16 v[20:23], a[124:127], v[180:183], v[20:23]
    ds_read_b128 v[72:75], v254 offset:50176
    v_mfma_f32_16x16x32_bf16 v[24:27], a[128:131], v[180:183], v[24:27]
    buffer_load_dwordx4 a[216:219], v15, s[8:11], s63 offen sc1
    v_mfma_f32_16x16x32_bf16 v[28:31], a[132:135], v[180:183], v[28:31]
    s_add_u32 s67, s41, 24576
    s_or_b32 s67, s67, s3
    v_mfma_f32_16x16x32_bf16 v[32:35], a[136:139], v[180:183], v[32:35]
    s_waitcnt vmcnt(9)
    buffer_load_dwordx4 v[220:223], v3, s[8:11], s67 offen sc1
    v_mfma_f32_16x16x32_bf16 v[96:99], a[0:3], v[184:187], v[96:99]
    s_waitcnt lgkmcnt(2)
    s_barrier
    v_mfma_f32_16x16x32_bf16 v[96:99], a[20:23], v[188:191], v[96:99]
    s_waitcnt lgkmcnt(0)
    ds_read_b128 v[76:79], v255 offset:51200
    ds_read_b128 v[80:83], v255 offset:52224
    v_mfma_f32_16x16x32_bf16 v[96:99], a[40:43], v[192:195], v[96:99]
    ds_read_b128 v[84:87], v255 offset:53248
    ds_read_b128 v[88:91], v255 offset:54272
    v_mfma_f32_16x16x32_bf16 v[96:99], a[60:63], v[196:199], v[96:99]
    ds_read_b128 v[92:95], v255 offset:55296
    v_add_f32 v36, v36, v56
    v_mfma_f32_16x16x32_bf16 v[96:99], a[80:83], v[200:203], v[96:99]
    v_add_f32 v37, v37, v57
    v_add_f32 v38, v38, v58
    v_mfma_f32_16x16x32_bf16 v[96:99], a[100:103], v[204:207], v[96:99]
    v_add_f32 v39, v39, v59
    v_add_f32 v40, v40, v60
    v_mfma_f32_16x16x32_bf16 v[96:99], a[120:123], a[240:243], v[96:99]
    v_add_f32 v41, v41, v61
    v_add_f32 v42, v42, v62
    v_mfma_f32_16x16x32_bf16 v[100:103], a[4:7], v[184:187], v[100:103]
    v_add_f32 v43, v43, v63
    v_add_f32 v44, v44, v64
    v_mfma_f32_16x16x32_bf16 v[100:103], a[24:27], v[188:191], v[100:103]
    v_add_f32 v45, v45, v65
    v_add_f32 v46, v46, v66
    v_mfma_f32_16x16x32_bf16 v[100:103], a[44:47], v[192:195], v[100:103]
    s_add_u32 s67, s41, 0
    v_add_f32 v47, v47, v67
    v_add_f32 v48, v48, v68
    v_mfma_f32_16x16x32_bf16 v[100:103], a[64:67], v[196:199], v[100:103]
    buffer_load_dwordx4 v[136:139], v2, s[8:11], s67 offen sc1
    v_add_f32 v49, v49, v69
    v_mfma_f32_16x16x32_bf16 v[100:103], a[84:87], v[200:203], v[100:103]
    ds_write_b128 v11, v[96:99] offset:0
    v_mfma_f32_16x16x32_bf16 v[100:103], a[104:107], v[204:207], v[100:103]
    s_add_u32 s63, s63, 5120
    buffer_load_dwordx4 a[220:223], v14, s[8:11], s63 offen offset:0 sc1
    v_add_f32 v50, v50, v70
    v_mfma_f32_16x16x32_bf16 v[100:103], a[124:127], a[240:243], v[100:103]
    s_add_u32 s67, s41, 4096
    v_add_f32 v51, v51, v71
    v_add_f32 v52, v52, v72
    v_mfma_f32_16x16x32_bf16 v[104:107], a[8:11], v[184:187], v[104:107]
    buffer_load_dwordx4 v[140:143], v2, s[8:11], s67 offen sc1
    v_add_f32 v53, v53, v73
    v_mfma_f32_16x16x32_bf16 v[104:107], a[28:31], v[188:191], v[104:107]
    s_waitcnt lgkmcnt(0)
    v_add_f32 v54, v54, v74
    v_add_f32 v55, v55, v75
    v_mfma_f32_16x16x32_bf16 v[104:107], a[48:51], v[192:195], v[104:107]
    s_barrier
    v_add_f32 v16, v16, v36
    v_mfma_f32_16x16x32_bf16 v[104:107], a[68:71], v[196:199], v[104:107]
    s_add_u32 s67, s41, 8192
    ds_read_b128 v[116:119], v7 offset:0
    v_add_f32 v17, v17, v37
    v_mfma_f32_16x16x32_bf16 v[104:107], a[88:91], v[200:203], v[104:107]
    buffer_load_dwordx4 v[144:147], v2, s[8:11], s67 offen sc1
    v_add_f32 v18, v18, v38
    v_mfma_f32_16x16x32_bf16 v[104:107], a[108:111], v[204:207], v[104:107]
    ds_write_b128 v11, v[100:103] offset:1024
    v_mfma_f32_16x16x32_bf16 v[104:107], a[128:131], a[240:243], v[104:107]
    v_add_f32 v19, v19, v39
    v_add_f32 v20, v20, v40
    v_mfma_f32_16x16x32_bf16 v[108:111], a[12:15], v[184:187], v[108:111]
    s_add_u32 s67, s41, 12288
    v_add_f32 v21, v21, v41
    v_add_f32 v22, v22, v42
    v_mfma_f32_16x16x32_bf16 v[108:111], a[32:35], v[188:191], v[108:111]
    buffer_load_dwordx4 v[148:151], v2, s[8:11], s67 offen sc1
    v_add_f32 v23, v23, v43
    v_mfma_f32_16x16x32_bf16 v[108:111], a[52:55], v[192:195], v[108:111]
    s_waitcnt lgkmcnt(0)
    v_add_f32 v24, v24, v44
    v_add_f32 v25, v25, v45
    v_mfma_f32_16x16x32_bf16 v[108:111], a[72:75], v[196:199], v[108:111]
    s_barrier
    v_add_f32 v26, v26, v46
    v_mfma_f32_16x16x32_bf16 v[108:111], a[92:95], v[200:203], v[108:111]
    s_add_u32 s67, s41, 16384
    ds_read_b128 v[120:123], v7 offset:1024
    v_add_f32 v27, v27, v47
    v_mfma_f32_16x16x32_bf16 v[108:111], a[112:115], v[204:207], v[108:111]
    buffer_load_dwordx4 v[152:155], v2, s[8:11], s67 offen sc1
    buffer_load_dwordx4 a[224:227], v14, s[8:11], s63 offen offset:1024 sc1
    v_mfma_f32_16x16x32_bf16 v[108:111], a[132:135], a[240:243], v[108:111]
    ds_write_b128 v11, v[104:107] offset:2048
    v_mfma_f32_16x16x32_bf16 v[112:115], a[16:19], v[184:187], v[112:115]
    v_add_f32 v28, v28, v48
    v_add_f32 v29, v29, v49
    v_mfma_f32_16x16x32_bf16 v[112:115], a[36:39], v[188:191], v[112:115]
    s_add_u32 s67, s41, 20480
    v_add_f32 v30, v30, v50
    v_add_f32 v31, v31, v51
    v_mfma_f32_16x16x32_bf16 v[112:115], a[56:59], v[192:195], v[112:115]
    buffer_load_dwordx4 v[156:159], v2, s[8:11], s67 offen sc1
    v_add_f32 v32, v32, v52
    v_mfma_f32_16x16x32_bf16 v[112:115], a[76:79], v[196:199], v[112:115]
    s_waitcnt lgkmcnt(0)
    ds_write_b128 v11, v[108:111] offset:3072
    v_mfma_f32_16x16x32_bf16 v[112:115], a[96:99], v[200:203], v[112:115]
    s_barrier
    v_add_f32 v33, v33, v53
    v_mfma_f32_16x16x32_bf16 v[112:115], a[116:119], v[204:207], v[112:115]
    s_add_u32 s67, s41, 24576
    s_or_b32 s67, s67, s3
    v_mfma_f32_16x16x32_bf16 v[112:115], a[136:139], a[240:243], v[112:115]
    s_waitcnt vmcnt(8)
    buffer_load_dwordx4 v[160:163], v2, s[8:11], s67 offen sc1
    ds_read_b128 v[124:127], v7 offset:2048
    v_mfma_f32_16x16x32_bf16 v[116:119], a[0:3], a[244:247], v[116:119]
    s_waitcnt lgkmcnt(1)
    v_add_f32 v34, v34, v54
    v_add_f32 v35, v35, v55
    v_mfma_f32_16x16x32_bf16 v[116:119], a[20:23], a[248:251], v[116:119]
    s_barrier
    v_mfma_f32_16x16x32_bf16 v[116:119], a[40:43], a[252:255], v[116:119]
    ds_read_b128 v[128:131], v7 offset:3072
    v_add_f32 v16, v16, v76
    v_mfma_f32_16x16x32_bf16 v[116:119], a[60:63], v[208:211], v[116:119]
    ds_write_b128 v11, v[112:115] offset:4096
    v_mfma_f32_16x16x32_bf16 v[116:119], a[80:83], v[212:215], v[116:119]
    v_add_f32 v17, v17, v77
    v_add_f32 v18, v18, v78
    v_mfma_f32_16x16x32_bf16 v[116:119], a[100:103], v[216:219], v[116:119]
    buffer_load_dwordx4 a[228:231], v14, s[8:11], s63 offen offset:2048 sc1
    v_add_f32 v19, v19, v79
    v_mfma_f32_16x16x32_bf16 v[116:119], a[120:123], v[220:223], v[116:119]
    v_add_f32 v20, v20, v80
    v_add_f32 v21, v21, v81
    v_mfma_f32_16x16x32_bf16 v[120:123], a[4:7], a[244:247], v[120:123]
    s_waitcnt lgkmcnt(0)
    buffer_load_dword v9, v9, s[8:11], 0 offen offset:28 sc1
    v_add_f32 v22, v22, v82
    v_mfma_f32_16x16x32_bf16 v[120:123], a[24:27], a[248:251], v[120:123]
    s_barrier
    v_add_f32 v23, v23, v83
    v_mfma_f32_16x16x32_bf16 v[120:123], a[44:47], a[252:255], v[120:123]
    s_add_u32 s67, s41, 0
    ds_read_b128 v[132:135], v7 offset:4096
    v_add_f32 v24, v24, v84
    v_mfma_f32_16x16x32_bf16 v[120:123], a[64:67], v[208:211], v[120:123]
    buffer_load_dwordx4 v[176:179], v1, s[8:11], s67 offen sc1
    v_add_f32 v25, v25, v85
    v_mfma_f32_16x16x32_bf16 v[120:123], a[84:87], v[212:215], v[120:123]
    ds_write_b128 v11, v[116:119] offset:20480
    v_mfma_f32_16x16x32_bf16 v[120:123], a[104:107], v[216:219], v[120:123]
    v_add_f32 v26, v26, v86
    v_add_f32 v27, v27, v87
    v_mfma_f32_16x16x32_bf16 v[120:123], a[124:127], v[220:223], v[120:123]
    s_add_u32 s67, s41, 4096
    v_add_f32 v28, v28, v88
    v_add_f32 v29, v29, v89
    v_mfma_f32_16x16x32_bf16 v[124:127], a[8:11], a[244:247], v[124:127]
    buffer_load_dwordx4 v[180:183], v1, s[8:11], s67 offen sc1
    v_add_f32 v30, v30, v90
    v_mfma_f32_16x16x32_bf16 v[124:127], a[28:31], a[248:251], v[124:127]
    s_waitcnt lgkmcnt(0)
    v_add_f32 v31, v31, v91
    v_add_f32 v32, v32, v92
    v_mfma_f32_16x16x32_bf16 v[124:127], a[48:51], a[252:255], v[124:127]
    s_barrier
    v_add_f32 v33, v33, v93
    v_mfma_f32_16x16x32_bf16 v[124:127], a[68:71], v[208:211], v[124:127]
    s_add_u32 s67, s41, 8192
    ds_read_b128 v[96:99], v7 offset:20480
    v_add_f32 v34, v34, v94
    v_mfma_f32_16x16x32_bf16 v[124:127], a[88:91], v[212:215], v[124:127]
    buffer_load_dwordx4 v[184:187], v1, s[8:11], s67 offen sc1
    v_add_f32 v35, v35, v95
    v_mfma_f32_16x16x32_bf16 v[124:127], a[108:111], v[216:219], v[124:127]
    ds_write_b128 v11, v[120:123] offset:21504
    v_mfma_f32_16x16x32_bf16 v[124:127], a[128:131], v[220:223], v[124:127]
    buffer_load_dwordx4 a[232:235], v14, s[8:11], s63 offen offset:3072 sc1
    v_cvt_pk_bf16_f32 v16, v16, v17
    v_mfma_f32_16x16x32_bf16 v[128:131], a[12:15], a[244:247], v[128:131]
    s_add_u32 s67, s41, 12288
    v_cvt_pk_bf16_f32 v17, v18, v19
    v_cvt_pk_bf16_f32 v18, v20, v21
    v_mfma_f32_16x16x32_bf16 v[128:131], a[32:35], a[248:251], v[128:131]
    buffer_load_dwordx4 v[188:191], v1, s[8:11], s67 offen sc1
    v_cvt_pk_bf16_f32 v19, v22, v22
    v_mfma_f32_16x16x32_bf16 v[128:131], a[52:55], a[252:255], v[128:131]
    s_waitcnt lgkmcnt(0)
    v_perm_b32 v19, v19, v13, s72
    v_cvt_pk_bf16_f32 v20, v23, v24
    v_mfma_f32_16x16x32_bf16 v[128:131], a[72:75], v[208:211], v[128:131]
    s_barrier
    v_cvt_pk_bf16_f32 v21, v25, v26
    v_mfma_f32_16x16x32_bf16 v[128:131], a[92:95], v[212:215], v[128:131]
    s_add_u32 s67, s41, 16384
    ds_read_b128 v[100:103], v7 offset:21504
    v_cvt_pk_bf16_f32 v22, v27, v28
    v_mfma_f32_16x16x32_bf16 v[128:131], a[112:115], v[216:219], v[128:131]
    buffer_load_dwordx4 v[192:195], v1, s[8:11], s67 offen sc1
    v_cvt_pk_bf16_f32 v23, v29, v29
    v_mfma_f32_16x16x32_bf16 v[128:131], a[132:135], v[220:223], v[128:131]
    ds_write_b128 v11, v[124:127] offset:22528
    v_mfma_f32_16x16x32_bf16 v[132:135], a[16:19], a[244:247], v[132:135]
    v_perm_b32 v23, v23, v13, s72
    v_cvt_pk_bf16_f32 v24, v30, v31
    v_mfma_f32_16x16x32_bf16 v[132:135], a[36:39], a[248:251], v[132:135]
    s_add_u32 s67, s41, 20480
    v_cvt_pk_bf16_f32 v25, v32, v33
    v_cvt_pk_bf16_f32 v26, v34, v35
    v_mfma_f32_16x16x32_bf16 v[132:135], a[56:59], a[252:255], v[132:135]
    buffer_load_dwordx4 v[196:199], v1, s[8:11], s67 offen sc1
    v_mov_b32 v27, v13
    v_mfma_f32_16x16x32_bf16 v[132:135], a[76:79], v[208:211], v[132:135]
    s_waitcnt lgkmcnt(0)
    ds_write_b128 v11, v[128:131] offset:23552
    v_mfma_f32_16x16x32_bf16 v[132:135], a[96:99], v[212:215], v[132:135]
    s_barrier
    v_mfma_f32_16x16x32_bf16 v[132:135], a[116:119], v[216:219], v[132:135]
    s_add_u32 s67, s41, 24576
    s_or_b32 s67, s67, s3
    v_mfma_f32_16x16x32_bf16 v[132:135], a[136:139], v[220:223], v[132:135]
    s_waitcnt vmcnt(9)
    buffer_load_dwordx4 v[200:203], v1, s[8:11], s67 offen sc1
    ds_read_b128 v[104:107], v7 offset:22528
    v_mfma_f32_16x16x32_bf16 v[96:99], a[0:3], v[136:139], v[96:99]
    s_waitcnt lgkmcnt(1)
    buffer_load_dwordx4 a[236:239], v15, s[8:11], s63 offen sc1
    ds_read_b64 v[38:39], v5 offset:0
    v_mfma_f32_16x16x32_bf16 v[96:99], a[20:23], v[140:143], v[96:99]
    s_barrier
    v_mfma_f32_16x16x32_bf16 v[96:99], a[40:43], v[144:147], v[96:99]
    ds_read_b128 v[108:111], v7 offset:23552
    ds_read_b64 v[42:43], v5 offset:32
    v_mfma_f32_16x16x32_bf16 v[96:99], a[60:63], v[148:151], v[96:99]
    ds_write_b128 v11, v[132:135] offset:24576
    v_mfma_f32_16x16x32_bf16 v[96:99], a[80:83], v[152:155], v[96:99]
    buffer_store_dwordx4 v[16:19], v14, s[8:11], s44 offen offset:0 sc1
    v_mfma_f32_16x16x32_bf16 v[96:99], a[100:103], v[156:159], v[96:99]
    ds_read_b64 v[46:47], v5 offset:64
    ds_read_b64 v[50:51], v5 offset:96
    v_mfma_f32_16x16x32_bf16 v[96:99], a[120:123], v[160:163], v[96:99]
    ds_read_b64 v[54:55], v5 offset:128
    v_mfma_f32_16x16x32_bf16 v[100:103], a[4:7], v[136:139], v[100:103]
    s_waitcnt vmcnt(10) lgkmcnt(3)
    v_cmp_ne_u32 vcc, s55, v9
    v_mfma_f32_16x16x32_bf16 v[100:103], a[24:27], v[140:143], v[100:103]
    s_barrier
    v_mfma_f32_16x16x32_bf16 v[100:103], a[44:47], v[144:147], v[100:103]
    s_waitcnt lgkmcnt(0)
    ds_read_b128 v[112:115], v7 offset:24576
    v_lshlrev_b32 v36, 16, v38
    v_mfma_f32_16x16x32_bf16 v[100:103], a[64:67], v[148:151], v[100:103]
    ds_write_b128 v11, v[96:99] offset:0
    v_mfma_f32_16x16x32_bf16 v[100:103], a[84:87], v[152:155], v[100:103]
    v_and_b32 v37, 0xffff0000, v38
    v_lshlrev_b32 v38, 16, v39
    v_mfma_f32_16x16x32_bf16 v[100:103], a[104:107], v[156:159], v[100:103]
    v_and_b32 v39, 0xffff0000, v39
    v_lshlrev_b32 v40, 16, v42
    v_mfma_f32_16x16x32_bf16 v[100:103], a[124:127], v[160:163], v[100:103]
    s_add_u32 s67, s40, 28672
    v_and_b32 v41, 0xffff0000, v42
    s_cbranch_vccnz L_spin_ff_yf
L_ret_ff_yf:
    v_mfma_f32_16x16x32_bf16 v[104:107], a[8:11], v[136:139], v[104:107]
    s_waitcnt lgkmcnt(0)
    buffer_load_dwordx4 v[204:207], v4, s[8:11], s67 offen sc1
    v_lshlrev_b32 v42, 16, v43
    v_mfma_f32_16x16x32_bf16 v[104:107], a[28:31], v[140:143], v[104:107]
    s_barrier
    v_and_b32 v43, 0xffff0000, v43
    v_mfma_f32_16x16x32_bf16 v[104:107], a[48:51], v[144:147], v[104:107]
    ds_read_b128 v[116:119], v7 offset:0
    v_lshlrev_b32 v44, 16, v46
    v_mfma_f32_16x16x32_bf16 v[104:107], a[68:71], v[148:151], v[104:107]
    s_add_u32 s67, s40, 32768
    ds_write_b128 v11, v[100:103] offset:1024
    v_mfma_f32_16x16x32_bf16 v[104:107], a[88:91], v[152:155], v[104:107]
    buffer_load_dwordx4 a[240:243], v4, s[8:11], s67 offen sc1
    v_and_b32 v45, 0xffff0000, v46
    v_mfma_f32_16x16x32_bf16 v[104:107], a[108:111], v[156:159], v[104:107]
    buffer_store_dwordx4 v[20:23], v14, s[8:11], s44 offen offset:1024 sc1
    v_mfma_f32_16x16x32_bf16 v[104:107], a[128:131], v[160:163], v[104:107]
    v_lshlrev_b32 v46, 16, v47
    v_and_b32 v47, 0xffff0000, v47
    v_mfma_f32_16x16x32_bf16 v[108:111], a[12:15], v[136:139], v[108:111]
    s_add_u32 s67, s40, 36864
    v_lshlrev_b32 v48, 16, v50
    v_and_b32 v49, 0xffff0000, v50
    v_mfma_f32_16x16x32_bf16 v[108:111], a[32:35], v[140:143], v[108:111]
    s_waitcnt lgkmcnt(0)
    buffer_load_dwordx4 a[244:247], v4, s[8:11], s67 offen sc1
    v_lshlrev_b32 v50, 16, v51
    v_mfma_f32_16x16x32_bf16 v[108:111], a[52:55], v[144:147], v[108:111]
    s_barrier
    v_and_b32 v51, 0xffff0000, v51
    v_mfma_f32_16x16x32_bf16 v[108:111], a[72:75], v[148:151], v[108:111]
    ds_read_b128 v[120:123], v7 offset:1024
    v_lshlrev_b32 v52, 16, v54
    v_mfma_f32_16x16x32_bf16 v[108:111], a[92:95], v[152:155], v[108:111]
    s_add_u32 s67, s40, 40960
    ds_write_b128 v11, v[104:107] offset:2048
    v_mfma_f32_16x16x32_bf16 v[108:111], a[112:115], v[156:159], v[108:111]
    buffer_load_dwordx4 a[248:251], v4, s[8:11], s67 offen sc1
    v_and_b32 v53, 0xffff0000, v54
    v_mfma_f32_16x16x32_bf16 v[108:111], a[132:135], v[160:163], v[108:111]
    v_lshlrev_b32 v54, 16, v55
    v_and_b32 v55, 0xffff0000, v55
    v_mfma_f32_16x16x32_bf16 v[112:115], a[16:19], v[136:139], v[112:115]
    v_mfma_f32_16x16x32_bf16 v[112:115], a[36:39], v[140:143], v[112:115]
    s_add_u32 s67, s40, 45056
    v_mfma_f32_16x16x32_bf16 v[112:115], a[56:59], v[144:147], v[112:115]
    s_waitcnt lgkmcnt(0)
    buffer_load_dwordx4 a[252:255], v4, s[8:11], s67 offen sc1
    v_mfma_f32_16x16x32_bf16 v[112:115], a[76:79], v[148:151], v[112:115]
    s_barrier
    v_mfma_f32_16x16x32_bf16 v[112:115], a[96:99], v[152:155], v[112:115]
    ds_read_b128 v[124:127], v7 offset:2048
    v_mfma_f32_16x16x32_bf16 v[112:115], a[116:119], v[156:159], v[112:115]
    s_add_u32 s67, s40, 28672
    ds_write_b128 v11, v[108:111] offset:3072
    v_mfma_f32_16x16x32_bf16 v[112:115], a[136:139], v[160:163], v[112:115]
    s_waitcnt vmcnt(8)
    buffer_store_dwordx4 v[24:27], v14, s[8:11], s44 offen offset:2048 sc1
    v_mfma_f32_16x16x32_bf16 v[116:119], a[0:3], v[176:179], v[116:119]
    buffer_load_dwordx4 v[208:211], v3, s[8:11], s67 offen sc1
    v_mfma_f32_16x16x32_bf16 v[116:119], a[20:23], v[180:183], v[116:119]
    v_mfma_f32_16x16x32_bf16 v[116:119], a[40:43], v[184:187], v[116:119]
    v_mfma_f32_16x16x32_bf16 v[116:119], a[60:63], v[188:191], v[116:119]
    s_add_u32 s67, s40, 32768
    ds_write_b128 v11, v[112:115] offset:4096
    v_mfma_f32_16x16x32_bf16 v[116:119], a[80:83], v[192:195], v[116:119]
    s_waitcnt lgkmcnt(1)
    buffer_load_dwordx4 v[212:215], v3, s[8:11], s67 offen sc1
    v_mfma_f32_16x16x32_bf16 v[116:119], a[100:103], v[196:199], v[116:119]
    s_barrier
    v_mfma_f32_16x16x32_bf16 v[116:119], a[120:123], v[200:203], v[116:119]
    ds_read_b128 v[128:131], v7 offset:3072
    v_mfma_f32_16x16x32_bf16 v[120:123], a[4:7], v[176:179], v[120:123]
    s_add_u32 s67, s40, 36864
    v_mfma_f32_16x16x32_bf16 v[120:123], a[24:27], v[180:183], v[120:123]
    s_waitcnt lgkmcnt(1)
    buffer_load_dwordx4 v[216:219], v3, s[8:11], s67 offen sc1
    v_mfma_f32_16x16x32_bf16 v[120:123], a[44:47], v[184:187], v[120:123]
    s_barrier
    v_mfma_f32_16x16x32_bf16 v[120:123], a[64:67], v[188:191], v[120:123]
    ds_read_b128 v[132:135], v7 offset:4096
    v_mfma_f32_16x16x32_bf16 v[120:123], a[84:87], v[192:195], v[120:123]
    s_add_u32 s67, s40, 40960
    v_mfma_f32_16x16x32_bf16 v[120:123], a[104:107], v[196:199], v[120:123]
    buffer_load_dwordx4 v[220:223], v3, s[8:11], s67 offen sc1
    v_mfma_f32_16x16x32_bf16 v[120:123], a[124:127], v[200:203], v[120:123]
    v_mfma_f32_16x16x32_bf16 v[124:127], a[8:11], v[176:179], v[124:127]
    v_mfma_f32_16x16x32_bf16 v[124:127], a[28:31], v[180:183], v[124:127]
    s_add_u32 s67, s40, 45056
    v_mfma_f32_16x16x32_bf16 v[124:127], a[48:51], v[184:187], v[124:127]
    buffer_load_dwordx4 a[0:3], v3, s[8:11], s67 offen sc1
    v_mfma_f32_16x16x32_bf16 v[124:127], a[68:71], v[188:191], v[124:127]
    s_waitcnt lgkmcnt(0)
    v_mfma_f32_16x16x32_bf16 v[124:127], a[88:91], v[192:195], v[124:127]
    s_buffer_load_dword s24, s[8:11], s45 offset:12 glc
    v_mfma_f32_16x16x32_bf16 v[124:127], a[108:111], v[196:199], v[124:127]
    v_mfma_f32_16x16x32_bf16 v[124:127], a[128:131], v[200:203], v[124:127]
    v_mfma_f32_16x16x32_bf16 v[128:131], a[12:15], v[176:179], v[128:131]
    v_mfma_f32_16x16x32_bf16 v[128:131], a[32:35], v[180:183], v[128:131]
    v_mfma_f32_16x16x32_bf16 v[128:131], a[52:55], v[184:187], v[128:131]
    v_mfma_f32_16x16x32_bf16 v[128:131], a[72:75], v[188:191], v[128:131]
    s_add_u32 s67, s40, 28672
    v_mfma_f32_16x16x32_bf16 v[128:131], a[92:95], v[192:195], v[128:131]
    buffer_load_dwordx4 a[20:23], v2, s[8:11], s67 offen sc1
    v_mfma_f32_16x16x32_bf16 v[128:131], a[112:115], v[196:199], v[128:131]
    v_mfma_f32_16x16x32_bf16 v[128:131], a[132:135], v[200:203], v[128:131]
    v_mfma_f32_16x16x32_bf16 v[132:135], a[16:19], v[176:179], v[132:135]
    s_add_u32 s67, s40, 32768
    v_mfma_f32_16x16x32_bf16 v[132:135], a[36:39], v[180:183], v[132:135]
    buffer_load_dwordx4 a[40:43], v2, s[8:11], s67 offen sc1
    v_mfma_f32_16x16x32_bf16 v[132:135], a[56:59], v[184:187], v[132:135]
    v_mfma_f32_16x16x32_bf16 v[132:135], a[76:79], v[188:191], v[132:135]
    v_mfma_f32_16x16x32_bf16 v[132:135], a[96:99], v[192:195], v[132:135]
    s_add_u32 s67, s40, 36864
    v_mfma_f32_16x16x32_bf16 v[132:135], a[116:119], v[196:199], v[132:135]
    buffer_load_dwordx4 a[60:63], v2, s[8:11], s67 offen sc1
    v_mfma_f32_16x16x32_bf16 v[132:135], a[136:139], v[200:203], v[132:135]
    s_waitcnt vmcnt(9)
    v_mfma_f32_16x16x32_bf16 v[136:139], a[140:143], v[204:207], 0
    v_mfma_f32_16x16x32_bf16 v[136:139], a[160:163], a[240:243], v[136:139]
    s_add_u32 s67, s40, 40960
    v_mfma_f32_16x16x32_bf16 v[136:139], a[180:183], a[244:247], v[136:139]
    buffer_load_dwordx4 a[80:83], v2, s[8:11], s67 offen sc1
    v_mfma_f32_16x16x32_bf16 v[136:139], a[200:203], a[248:251], v[136:139]
    v_mfma_f32_16x16x32_bf16 v[136:139], a[220:223], a[252:255], v[136:139]
    v_mfma_f32_16x16x32_bf16 v[140:143], a[144:147], v[204:207], 0
    s_add_u32 s67, s40, 45056
    v_mfma_f32_16x16x32_bf16 v[140:143], a[164:167], a[240:243], v[140:143]
    buffer_load_dwordx4 a[100:103], v2, s[8:11], s67 offen sc1
    v_mfma_f32_16x16x32_bf16 v[140:143], a[184:187], a[244:247], v[140:143]
    v_mfma_f32_16x16x32_bf16 v[140:143], a[204:207], a[248:251], v[140:143]
    s_nop 1
    ds_write_b128 v11, v[136:139] offset:20480
    v_mfma_f32_16x16x32_bf16 v[140:143], a[224:227], a[252:255], v[140:143]
    v_mfma_f32_16x16x32_bf16 v[144:147], a[148:151], v[204:207], 0
    v_mfma_f32_16x16x32_bf16 v[144:147], a[168:171], a[240:243], v[144:147]
    s_waitcnt lgkmcnt(0)
    s_xor_b32 s24, s24, s55
    s_and_b32 s24, s24, 0xffff
    s_cmp_eq_u32 s24, 0
    s_cbranch_scc0 L_spin_ff_gf
L_ret_ff_gf:
    v_mfma_f32_16x16x32_bf16 v[144:147], a[188:191], a[244:247], v[144:147]
    v_mfma_f32_16x16x32_bf16 v[144:147], a[208:211], a[248:251], v[144:147]
    s_barrier
    v_mfma_f32_16x16x32_bf16 v[144:147], a[228:231], a[252:255], v[144:147]
    s_add_u32 s67, s40, 28672
    ds_read_b128 v[156:159], v7 offset:20480
    v_mfma_f32_16x16x32_bf16 v[148:151], a[152:155], v[204:207], 0
    buffer_load_dwordx4 a[120:123], v1, s[8:11], s67 offen sc1
    v_mfma_f32_16x16x32_bf16 v[148:151], a[172:175], a[240:243], v[148:151]
    ds_write_b128 v11, v[140:143] offset:21504
    v_mfma_f32_16x16x32_bf16 v[148:151], a[192:195], a[244:247], v[148:151]
    buffer_load_dwordx4 v[76:79], v14, s[8:11], s45 offen offset:0 sc1
    v_mfma_f32_16x16x32_bf16 v[148:151], a[212:215], a[248:251], v[148:151]
    s_add_u32 s67, s40, 32768
    ds_write_b128 v11, v[144:147] offset:22528
    v_mfma_f32_16x16x32_bf16 v[148:151], a[232:235], a[252:255], v[148:151]
    buffer_load_dwordx4 a[4:7], v1, s[8:11], s67 offen sc1
    v_mfma_f32_16x16x32_bf16 v[152:155], a[156:159], v[204:207], 0
    s_waitcnt lgkmcnt(1)
    buffer_load_dwordx4 v[80:83], v14, s[8:11], s45 offen offset:1024 sc1
    v_mfma_f32_16x16x32_bf16 v[152:155], a[176:179], a[240:243], v[152:155]
    s_barrier
    v_mfma_f32_16x16x32_bf16 v[152:155], a[196:199], a[244:247], v[152:155]
    s_add_u32 s67, s40, 36864
    ds_read_b128 v[160:163], v7 offset:21504
    v_mfma_f32_16x16x32_bf16 v[152:155], a[216:219], a[248:251], v[152:155]
    buffer_load_dwordx4 a[24:27], v1, s[8:11], s67 offen sc1
    buffer_load_dwordx4 v[84:87], v14, s[8:11], s45 offen offset:2048 sc1
    v_mfma_f32_16x16x32_bf16 v[152:155], a[236:239], a[252:255], v[152:155]
    s_waitcnt vmcnt(11) lgkmcnt(1)
    ds_write_b128 v11, v[148:151] offset:23552
    v_mfma_f32_16x16x32_bf16 v[156:159], a[140:143], v[208:211], v[156:159]
    s_barrier
    v_mfma_f32_16x16x32_bf16 v[156:159], a[160:163], v[212:215], v[156:159]
    s_add_u32 s67, s40, 40960
    ds_read_b128 v[164:167], v7 offset:22528
    v_mfma_f32_16x16x32_bf16 v[156:159], a[180:183], v[216:219], v[156:159]
    buffer_load_dwordx4 a[44:47], v1, s[8:11], s67 offen sc1
    v_mfma_f32_16x16x32_bf16 v[156:159], a[200:203], v[220:223], v[156:159]
    ds_write_b128 v11, v[152:155] offset:24576
    v_mfma_f32_16x16x32_bf16 v[156:159], a[220:223], a[0:3], v[156:159]
    s_waitcnt lgkmcnt(3)
    v_mfma_f32_16x16x32_bf16 v[160:163], a[144:147], v[208:211], v[160:163]
    s_add_u32 s67, s40, 45056
    v_mfma_f32_16x16x32_bf16 v[160:163], a[164:167], v[212:215], v[160:163]
    s_waitcnt lgkmcnt(2)
    buffer_load_dwordx4 a[64:67], v1, s[8:11], s67 offen sc1
    v_mfma_f32_16x16x32_bf16 v[160:163], a[184:187], v[216:219], v[160:163]
    s_barrier
    v_mfma_f32_16x16x32_bf16 v[160:163], a[204:207], v[220:223], v[160:163]
    ds_read_b128 v[168:171], v7 offset:23552
    v_mfma_f32_16x16x32_bf16 v[160:163], a[224:227], a[0:3], v[160:163]
    s_waitcnt lgkmcnt(1)
    ds_write_b128 v11, v[156:159] offset:0
    v_mfma_f32_16x16x32_bf16 v[164:167], a[148:151], v[208:211], v[164:167]
    s_barrier
    v_mfma_f32_16x16x32_bf16 v[164:167], a[168:171], v[212:215], v[164:167]
    ds_read_b128 v[172:175], v7 offset:24576
    v_mfma_f32_16x16x32_bf16 v[164:167], a[188:191], v[216:219], v[164:167]
    v_mfma_f32_16x16x32_bf16 v[164:167], a[208:211], v[220:223], v[164:167]
    ds_write_b128 v11, v[160:163] offset:1024
    v_mfma_f32_16x16x32_bf16 v[164:167], a[228:231], a[0:3], v[164:167]
    s_waitcnt lgkmcnt(3)
    s_add_u32 s67, s41, 28672
    v_mfma_f32_16x16x32_bf16 v[168:171], a[152:155], v[208:211], v[168:171]
    s_waitcnt lgkmcnt(2)
    buffer_load_dwordx4 a[84:87], v4, s[8:11], s67 offen sc1
    v_mfma_f32_16x16x32_bf16 v[168:171], a[172:175], v[212:215], v[168:171]
    s_barrier
    v_mfma_f32_16x16x32_bf16 v[168:171], a[192:195], v[216:219], v[168:171]
    ds_read_b128 v[136:139], v7 offset:0
    v_mfma_f32_16x16x32_bf16 v[168:171], a[212:215], v[220:223], v[168:171]
    s_add_u32 s67, s41, 32768
    ds_write_b128 v11, v[164:167] offset:2048
    v_mfma_f32_16x16x32_bf16 v[168:171], a[232:235], a[0:3], v[168:171]
    s_waitcnt lgkmcnt(2)
    buffer_load_dwordx4 a[104:107], v4, s[8:11], s67 offen sc1
    v_mfma_f32_16x16x32_bf16 v[172:175], a[156:159], v[208:211], v[172:175]
    s_barrier
    v_mfma_f32_16x16x32_bf16 v[172:175], a[176:179], v[212:215], v[172:175]
    ds_read_b128 v[140:143], v7 offset:1024
    s_add_u32 s73, s44, 6144
    v_mfma_f32_16x16x32_bf16 v[172:175], a[196:199], v[216:219], v[172:175]
    s_add_u32 s67, s41, 36864
    s_mov_b64 exec, 1
    buffer_store_dword v13, v14, s[8:11], s73 offen sc1
    s_mov_b64 exec, -1
    v_mfma_f32_16x16x32_bf16 v[172:175], a[216:219], v[220:223], v[172:175]
    buffer_load_dwordx4 a[124:127], v4, s[8:11], s67 offen sc1
    v_mfma_f32_16x16x32_bf16 v[172:175], a[236:239], a[0:3], v[172:175]
    s_waitcnt vmcnt(12) lgkmcnt(1)
    ds_write_b128 v11, v[168:171] offset:3072
    v_mfma_f32_16x16x32_bf16 v[136:139], a[140:143], a[20:23], v[136:139]
    s_barrier
    v_mfma_f32_16x16x32_bf16 v[136:139], a[160:163], a[40:43], v[136:139]
    s_add_u32 s67, s41, 40960
    ds_read_b128 v[144:147], v7 offset:2048
    v_mfma_f32_16x16x32_bf16 v[136:139], a[180:183], a[60:63], v[136:139]
    buffer_load_dwordx4 a[8:11], v4, s[8:11], s67 offen sc1
    v_mfma_f32_16x16x32_bf16 v[136:139], a[200:203], a[80:83], v[136:139]
    ds_write_b128 v11, v[172:175] offset:4096
    v_mfma_f32_16x16x32_bf16 v[136:139], a[220:223], a[100:103], v[136:139]
    s_waitcnt vmcnt(11) lgkmcnt(3)
    v_xor_b32 v8, s55, v79
    s_waitcnt vmcnt(9)
    v_bitop3_b32 v8, v8, v83, s55 bitop3:0xf6
    v_mfma_f32_16x16x32_bf16 v[140:143], a[144:147], a[20:23], v[140:143]
    s_add_u32 s67, s41, 45056
    s_waitcnt vmcnt(7)
    v_bitop3_b32 v8, v8, v87, s55 bitop3:0xf6
    v_and_b32 v8, 0xffff, v8
    v_mfma_f32_16x16x32_bf16 v[140:143], a[164:167], a[40:43], v[140:143]
    s_waitcnt lgkmcnt(2)
    buffer_load_dwordx4 a[28:31], v4, s[8:11], s67 offen sc1
    v_mfma_f32_16x16x32_bf16 v[140:143], a[184:187], a[60:63], v[140:143]
    s_barrier
    v_mfma_f32_16x16x32_bf16 v[140:143], a[204:207], a[80:83], v[140:143]
    ds_read_b128 v[148:151], v7 offset:3072
    v_mfma_f32_16x16x32_bf16 v[140:143], a[224:227], a[100:103], v[140:143]
    s_waitcnt lgkmcnt(1)
    ds_write_b128 v11, v[136:139] offset:20480
    v_mfma_f32_16x16x32_bf16 v[144:147], a[148:151], a[20:23], v[144:147]
    s_barrier
    v_mfma_f32_16x16x32_bf16 v[144:147], a[168:171], a[40:43], v[144:147]
    ds_read_b128 v[152:155], v7 offset:4096
    v_mfma_f32_16x16x32_bf16 v[144:147], a[188:191], a[60:63], v[144:147]
    v_cmp_ne_u32 vcc, 0, v8
    s_nop 3
    s_cbranch_vccnz L_spin_ff_xf
L_ret_ff_xf:
    v_mfma_f32_16x16x32_bf16 v[144:147], a[208:211], a[80:83], v[144:147]
    ds_write_b128 v11, v[140:143] offset:21504
    v_mfma_f32_16x16x32_bf16 v[144:147], a[228:231], a[100:103], v[144:147]
    s_waitcnt lgkmcnt(3)
    s_add_u32 s67, s41, 28672
    v_lshlrev_b32 v56, 16, v76
    v_and_b32 v57, 0xffff0000, v76
    v_mfma_f32_16x16x32_bf16 v[148:151], a[152:155], a[20:23], v[148:151]
    s_waitcnt lgkmcnt(2)
    buffer_load_dwordx4 a[48:51], v3, s[8:11], s67 offen sc1
    v_lshlrev_b32 v58, 16, v77
    v_mfma_f32_16x16x32_bf16 v[148:151], a[172:175], a[40:43], v[148:151]
    s_barrier
    v_and_b32 v59, 0xffff0000, v77
    v_mfma_f32_16x16x32_bf16 v[148:151], a[192:195], a[60:63], v[148:151]
    ds_read_b128 v[156:159], v7 offset:20480
    v_lshlrev_b32 v60, 16, v78
    v_mfma_f32_16x16x32_bf16 v[148:151], a[212:215], a[80:83], v[148:151]
    s_add_u32 s67, s41, 32768
    ds_write_b128 v11, v[144:147] offset:22528
    v_mfma_f32_16x16x32_bf16 v[148:151], a[232:235], a[100:103], v[148:151]
    s_waitcnt lgkmcnt(2)
    buffer_load_dwordx4 a[68:71], v3, s[8:11], s67 offen sc1
    v_and_b32 v61, 0xffff0000, v78
    v_mfma_f32_16x16x32_bf16 v[152:155], a[156:159], a[20:23], v[152:155]
    s_barrier
    v_and_b32 v62, 0xffff0000, v79
    v_mfma_f32_16x16x32_bf16 v[152:155], a[176:179], a[40:43], v[152:155]
    ds_read_b128 v[160:163], v7 offset:21504
    v_lshlrev_b32 v63, 16, v80
    v_mfma_f32_16x16x32_bf16 v[152:155], a[196:199], a[60:63], v[152:155]
    s_add_u32 s67, s41, 36864
    v_and_b32 v64, 0xffff0000, v80
    v_lshlrev_b32 v65, 16, v81
    v_mfma_f32_16x16x32_bf16 v[152:155], a[216:219], a[80:83], v[152:155]
    buffer_load_dwordx4 a[88:91], v3, s[8:11], s67 offen sc1
    v_and_b32 v66, 0xffff0000, v81
    v_mfma_f32_16x16x32_bf16 v[152:155], a[236:239], a[100:103], v[152:155]
    s_waitcnt vmcnt(9) lgkmcnt(1)
    ds_write_b128 v11, v[148:151] offset:23552
    v_mfma_f32_16x16x32_bf16 v[156:159], a[140:143], a[120:123], v[156:159]
    s_barrier
    v_lshlrev_b32 v67, 16, v82
    v_mfma_f32_16x16x32_bf16 v[156:159], a[160:163], a[4:7], v[156:159]
    s_add_u32 s67, s41, 40960
    ds_read_b128 v[164:167], v7 offset:22528
    v_and_b32 v68, 0xffff0000, v82
    v_mfma_f32_16x16x32_bf16 v[156:159], a[180:183], a[24:27], v[156:159]
    buffer_load_dwordx4 a[108:111], v3, s[8:11], s67 offen sc1
    v_and_b32 v69, 0xffff0000, v83
    v_mfma_f32_16x16x32_bf16 v[156:159], a[200:203], a[44:47], v[156:159]
    ds_write_b128 v11, v[152:155] offset:24576
    v_mfma_f32_16x16x32_bf16 v[156:159], a[220:223], a[64:67], v[156:159]
    s_waitcnt lgkmcnt(3)
    v_lshlrev_b32 v70, 16, v84
    v_and_b32 v71, 0xffff0000, v84
    v_mfma_f32_16x16x32_bf16 v[160:163], a[144:147], a[120:123], v[160:163]
    s_add_u32 s67, s41, 45056
    v_lshlrev_b32 v72, 16, v85
    v_and_b32 v73, 0xffff0000, v85
    v_mfma_f32_16x16x32_bf16 v[160:163], a[164:167], a[4:7], v[160:163]
    s_waitcnt lgkmcnt(2)
    buffer_load_dwordx4 a[128:131], v3, s[8:11], s67 offen sc1
    v_lshlrev_b32 v74, 16, v86
    v_mfma_f32_16x16x32_bf16 v[160:163], a[184:187], a[24:27], v[160:163]
    s_barrier
    v_and_b32 v75, 0xffff0000, v86
    v_mfma_f32_16x16x32_bf16 v[160:163], a[204:207], a[44:47], v[160:163]
    ds_read_b128 v[168:171], v7 offset:23552
    v_add_f32 v116, v116, v56
    v_mfma_f32_16x16x32_bf16 v[160:163], a[224:227], a[64:67], v[160:163]
    s_waitcnt lgkmcnt(1)
    v_add_f32 v117, v117, v57
    v_add_f32 v118, v118, v58
    v_mfma_f32_16x16x32_bf16 v[164:167], a[148:151], a[120:123], v[164:167]
    s_barrier
    v_add_f32 v119, v119, v59
    v_mfma_f32_16x16x32_bf16 v[164:167], a[168:171], a[4:7], v[164:167]
    ds_read_b128 v[172:175], v7 offset:24576
    v_add_f32 v120, v120, v60
    v_mfma_f32_16x16x32_bf16 v[164:167], a[188:191], a[24:27], v[164:167]
    v_add_f32 v121, v121, v61
    v_add_f32 v122, v122, v62
    v_mfma_f32_16x16x32_bf16 v[164:167], a[208:211], a[44:47], v[164:167]
    v_cvt_pk_bf16_f32 v16, v156, v157
    v_cvt_pk_bf16_f32 v17, v158, v159
    v_mfma_f32_16x16x32_bf16 v[164:167], a[228:231], a[64:67], v[164:167]
    s_waitcnt lgkmcnt(1)
    s_add_u32 s67, s41, 28672
    v_cvt_pk_bf16_f32 v18, v160, v161
    v_cvt_pk_bf16_f32 v19, v162, v162
    v_mfma_f32_16x16x32_bf16 v[168:171], a[152:155], a[120:123], v[168:171]
    buffer_load_dwordx4 a[12:15], v2, s[8:11], s67 offen sc1
    v_perm_b32 v19, v19, v13, s72
    v_mfma_f32_16x16x32_bf16 v[168:171], a[172:175], a[4:7], v[168:171]
    buffer_store_dwordx4 v[16:19], v14, s[8:11], s74 offen offset:0 sc1
    v_mfma_f32_16x16x32_bf16 v[168:171], a[192:195], a[24:27], v[168:171]
    v_add_f32 v123, v123, v63
    v_add_f32 v124, v124, v64
    v_mfma_f32_16x16x32_bf16 v[168:171], a[212:215], a[44:47], v[168:171]
    s_waitcnt lgkmcnt(0)
    s_add_u32 s67, s41, 32768
    v_add_f32 v125, v125, v65
    v_add_f32 v126, v126, v66
    v_mfma_f32_16x16x32_bf16 v[168:171], a[232:235], a[64:67], v[168:171]
    buffer_load_dwordx4 a[32:35], v2, s[8:11], s67 offen sc1
    s_buffer_load_dword s24, s[8:11], s45 offset:6144 glc
    v_mfma_f32_16x16x32_bf16 v[172:175], a[156:159], a[120:123], v[172:175]
    v_add_f32 v127, v127, v67
    v_add_f32 v128, v128, v68
    v_mfma_f32_16x16x32_bf16 v[172:175], a[176:179], a[4:7], v[172:175]
    v_add_f32 v129, v129, v69
    v_add_f32 v130, v130, v70
    v_mfma_f32_16x16x32_bf16 v[172:175], a[196:199], a[24:27], v[172:175]
    s_add_u32 s67, s41, 36864
    v_add_f32 v131, v131, v71
    v_add_f32 v132, v132, v72
    v_mfma_f32_16x16x32_bf16 v[172:175], a[216:219], a[44:47], v[172:175]
    buffer_load_dwordx4 a[52:55], v2, s[8:11], s67 offen sc1
    v_cvt_pk_bf16_f32 v20, v163, v164
    v_mfma_f32_16x16x32_bf16 v[172:175], a[236:239], a[64:67], v[172:175]
    s_waitcnt vmcnt(9)
    v_cvt_pk_bf16_f32 v21, v165, v166
    v_cvt_pk_bf16_f32 v22, v167, v168
    v_mfma_f32_16x16x32_bf16 v[96:99], a[140:143], a[84:87], v[224:227]
    v_cvt_pk_bf16_f32 v23, v169, v169
    v_perm_b32 v23, v23, v13, s72
    v_mfma_f32_16x16x32_bf16 v[96:99], a[160:163], a[104:107], v[96:99]
    s_add_u32 s67, s41, 40960
    buffer_store_dwordx4 v[20:23], v14, s[8:11], s74 offen offset:1024 sc1
    v_mfma_f32_16x16x32_bf16 v[96:99], a[180:183], a[124:127], v[96:99]
    buffer_load_dwordx4 a[72:75], v2, s[8:11], s67 offen sc1
    v_add_f32 v133, v133, v73
    v_mfma_f32_16x16x32_bf16 v[96:99], a[200:203], a[8:11], v[96:99]
    v_cvt_pk_bf16_f32 v24, v170, v171
    v_cvt_pk_bf16_f32 v25, v172, v173
    v_mfma_f32_16x16x32_bf16 v[96:99], a[220:223], a[28:31], v[96:99]
    v_cvt_pk_bf16_f32 v26, v174, v175
    v_mov_b32 v27, v13
    v_mfma_f32_16x16x32_bf16 v[100:103], a[144:147], a[84:87], v[228:231]
    s_add_u32 s67, s41, 45056
    buffer_store_dwordx4 v[24:27], v14, s[8:11], s74 offen offset:2048 sc1
    v_mfma_f32_16x16x32_bf16 v[100:103], a[164:167], a[104:107], v[100:103]
    buffer_load_dwordx4 a[92:95], v2, s[8:11], s67 offen sc1
    v_add_f32 v134, v134, v74
    v_mfma_f32_16x16x32_bf16 v[100:103], a[184:187], a[124:127], v[100:103]
    v_add_f32 v135, v135, v75
    v_mul_f32 v56, s68, v116
    v_mfma_f32_16x16x32_bf16 v[100:103], a[204:207], a[8:11], v[100:103]
    ds_write_b128 v11, v[96:99] offset:0
    v_mfma_f32_16x16x32_bf16 v[100:103], a[224:227], a[28:31], v[100:103]
    v_mul_f32 v57, s68, v117
    v_mul_f32 v58, s68, v118
    v_mfma_f32_16x16x32_bf16 v[104:107], a[148:151], a[84:87], v[232:235]
    v_mul_f32 v59, s68, v119
    v_mfma_f32_16x16x32_bf16 v[104:107], a[168:171], a[104:107], v[104:107]
    s_waitcnt lgkmcnt(0)
    s_cmp_eq_u32 s24, s55
    s_cbranch_scc0 L_spin_ff_gy
L_ret_ff_gy:
    v_mfma_f32_16x16x32_bf16 v[104:107], a[188:191], a[124:127], v[104:107]
    v_exp_f32 v56, v56
    v_mfma_f32_16x16x32_bf16 v[104:107], a[208:211], a[8:11], v[104:107]
    s_barrier
    v_mfma_f32_16x16x32_bf16 v[104:107], a[228:231], a[28:31], v[104:107]
    s_add_u32 s67, s41, 28672
    ds_read_b128 v[136:139], v7 offset:0
    v_mfma_f32_16x16x32_bf16 v[108:111], a[152:155], a[84:87], v[236:239]
    buffer_load_dwordx4 a[112:115], v1, s[8:11], s67 offen sc1
    v_mfma_f32_16x16x32_bf16 v[108:111], a[172:175], a[104:107], v[108:111]
    ds_write_b128 v11, v[100:103] offset:1024
    v_mfma_f32_16x16x32_bf16 v[108:111], a[192:195], a[124:127], v[108:111]
    v_exp_f32 v57, v57
    v_mfma_f32_16x16x32_bf16 v[108:111], a[212:215], a[8:11], v[108:111]
    s_add_u32 s67, s41, 32768
    ds_write_b128 v11, v[104:107] offset:2048
    v_mfma_f32_16x16x32_bf16 v[108:111], a[232:235], a[28:31], v[108:111]
    buffer_load_dwordx4 a[132:135], v1, s[8:11], s67 offen sc1
    v_mfma_f32_16x16x32_bf16 v[112:115], a[156:159], a[84:87], v[240:243]
    s_waitcnt lgkmcnt(1)
    v_exp_f32 v58, v58
    v_mfma_f32_16x16x32_bf16 v[112:115], a[176:179], a[104:107], v[112:115]
    s_barrier
    v_mfma_f32_16x16x32_bf16 v[112:115], a[196:199], a[124:127], v[112:115]
    s_add_u32 s67, s41, 36864
    ds_read_b128 v[140:143], v7 offset:1024
    v_mfma_f32_16x16x32_bf16 v[112:115], a[216:219], a[8:11], v[112:115]
    buffer_load_dwordx4 a[16:19], v1, s[8:11], s67 offen sc1
    v_mfma_f32_16x16x32_bf16 v[112:115], a[236:239], a[28:31], v[112:115]
    s_waitcnt vmcnt(11) lgkmcnt(1)
    ds_write_b128 v11, v[108:111] offset:3072
    v_mfma_f32_16x16x32_bf16 v[136:139], a[140:143], a[48:51], v[136:139]
    s_barrier
    v_mfma_f32_16x16x32_bf16 v[136:139], a[160:163], a[68:71], v[136:139]
    s_add_u32 s67, s41, 40960
    ds_read_b128 v[144:147], v7 offset:2048
    v_mfma_f32_16x16x32_bf16 v[136:139], a[180:183], a[88:91], v[136:139]
    buffer_load_dwordx4 a[36:39], v1, s[8:11], s67 offen sc1
    v_mfma_f32_16x16x32_bf16 v[136:139], a[200:203], a[108:111], v[136:139]
    ds_write_b128 v11, v[112:115] offset:4096
    v_mfma_f32_16x16x32_bf16 v[136:139], a[220:223], a[128:131], v[136:139]
    s_waitcnt lgkmcnt(3)
    v_exp_f32 v59, v59
    v_mfma_f32_16x16x32_bf16 v[140:143], a[144:147], a[48:51], v[140:143]
    s_add_u32 s67, s41, 45056
    v_add_f32 v56, 1.0, v56
    v_add_f32 v57, 1.0, v57
    v_mfma_f32_16x16x32_bf16 v[140:143], a[164:167], a[68:71], v[140:143]
    s_waitcnt lgkmcnt(2)
    buffer_load_dwordx4 a[56:59], v1, s[8:11], s67 offen sc1
    v_add_f32 v58, 1.0, v58
    v_mfma_f32_16x16x32_bf16 v[140:143], a[184:187], a[88:91], v[140:143]
    s_barrier
    v_add_f32 v59, 1.0, v59
    v_mfma_f32_16x16x32_bf16 v[140:143], a[204:207], a[108:111], v[140:143]
    ds_read_b128 v[148:151], v7 offset:3072
    v_mfma_f32_16x16x32_bf16 v[140:143], a[224:227], a[128:131], v[140:143]
    s_waitcnt lgkmcnt(1)
    ds_write_b128 v11, v[136:139] offset:20480
    v_mfma_f32_16x16x32_bf16 v[144:147], a[148:151], a[48:51], v[144:147]
    s_barrier
    v_mfma_f32_16x16x32_bf16 v[144:147], a[168:171], a[68:71], v[144:147]
    ds_read_b128 v[152:155], v7 offset:4096
    v_mfma_f32_16x16x32_bf16 v[144:147], a[188:191], a[88:91], v[144:147]
    v_rcp_f32 v56, v56
    v_mfma_f32_16x16x32_bf16 v[144:147], a[208:211], a[108:111], v[144:147]
    ds_write_b128 v11, v[140:143] offset:21504
    v_mfma_f32_16x16x32_bf16 v[144:147], a[228:231], a[128:131], v[144:147]
    s_waitcnt lgkmcnt(2)
    v_rcp_f32 v57, v57
    v_mfma_f32_16x16x32_bf16 v[148:151], a[152:155], a[48:51], v[148:151]
    s_barrier
    v_mfma_f32_16x16x32_bf16 v[148:151], a[172:175], a[68:71], v[148:151]
    ds_read_b128 v[96:99], v7 offset:20480
    v_mfma_f32_16x16x32_bf16 v[148:151], a[192:195], a[88:91], v[148:151]
    s_waitcnt lgkmcnt(1)
    v_rcp_f32 v58, v58
    v_mfma_f32_16x16x32_bf16 v[148:151], a[212:215], a[108:111], v[148:151]
    s_barrier
    v_mfma_f32_16x16x32_bf16 v[148:151], a[232:235], a[128:131], v[148:151]
    ds_read_b128 v[100:103], v7 offset:21504
    v_mfma_f32_16x16x32_bf16 v[152:155], a[156:159], a[48:51], v[152:155]
    ds_write_b128 v11, v[144:147] offset:22528
    v_mfma_f32_16x16x32_bf16 v[152:155], a[176:179], a[68:71], v[152:155]
    v_rcp_f32 v59, v59
    v_mfma_f32_16x16x32_bf16 v[152:155], a[196:199], a[88:91], v[152:155]
    v_mul_f32 v56, v56, v116
    v_mul_f32 v57, v57, v117
    v_mfma_f32_16x16x32_bf16 v[152:155], a[216:219], a[108:111], v[152:155]
    ds_write_b128 v11, v[148:151] offset:23552
    v_mfma_f32_16x16x32_bf16 v[152:155], a[236:239], a[128:131], v[152:155]
    s_waitcnt vmcnt(5) lgkmcnt(1)
    v_mul_f32 v58, v58, v118
    v_mul_f32 v59, v59, v119
    v_mfma_f32_16x16x32_bf16 v[96:99], a[140:143], a[12:15], v[96:99]
    s_barrier
    v_mul_f32 v60, s68, v120
    v_mfma_f32_16x16x32_bf16 v[96:99], a[160:163], a[32:35], v[96:99]
    ds_read_b128 v[104:107], v7 offset:22528
    v_mul_f32 v61, s68, v121
    v_mfma_f32_16x16x32_bf16 v[96:99], a[180:183], a[52:55], v[96:99]
    s_waitcnt lgkmcnt(1)
    v_mul_f32 v62, s68, v122
    v_mul_f32 v63, s68, v123
    v_mfma_f32_16x16x32_bf16 v[96:99], a[200:203], a[72:75], v[96:99]
    s_barrier
    v_mfma_f32_16x16x32_bf16 v[96:99], a[220:223], a[92:95], v[96:99]
    ds_read_b128 v[108:111], v7 offset:23552
    v_mfma_f32_16x16x32_bf16 v[100:103], a[144:147], a[12:15], v[100:103]
    ds_write_b128 v11, v[152:155] offset:24576
    v_mfma_f32_16x16x32_bf16 v[100:103], a[164:167], a[32:35], v[100:103]
    v_exp_f32 v60, v60
    v_mfma_f32_16x16x32_bf16 v[100:103], a[184:187], a[52:55], v[100:103]
    v_exp_f32 v61, v61
    v_mfma_f32_16x16x32_bf16 v[100:103], a[204:207], a[72:75], v[100:103]
    ds_write_b128 v11, v[96:99] offset:0
    v_mfma_f32_16x16x32_bf16 v[100:103], a[224:227], a[92:95], v[100:103]
    s_waitcnt lgkmcnt(1)
    v_exp_f32 v62, v62
    v_mfma_f32_16x16x32_bf16 v[104:107], a[148:151], a[12:15], v[104:107]
    s_barrier
    v_mfma_f32_16x16x32_bf16 v[104:107], a[168:171], a[32:35], v[104:107]
    ds_read_b128 v[112:115], v7 offset:24576
    v_mfma_f32_16x16x32_bf16 v[104:107], a[188:191], a[52:55], v[104:107]
    s_waitcnt lgkmcnt(1)
    v_exp_f32 v63, v63
    v_mfma_f32_16x16x32_bf16 v[104:107], a[208:211], a[72:75], v[104:107]
    s_barrier
    v_add_f32 v60, 1.0, v60
    v_mfma_f32_16x16x32_bf16 v[104:107], a[228:231], a[92:95], v[104:107]
    ds_read_b128 v[136:139], v7 offset:0
    buffer_load_dwordx4 v[244:247], v14, s[8:11], s65 offen offset:0 sc1
    v_mfma_f32_16x16x32_bf16 v[108:111], a[152:155], a[12:15], v[108:111]
    ds_write_b128 v11, v[100:103] offset:1024
    v_mfma_f32_16x16x32_bf16 v[108:111], a[172:175], a[32:35], v[108:111]
    buffer_load_dwordx4 v[248:251], v14, s[8:11], s65 offen offset:1024 sc1
    v_add_f32 v61, 1.0, v61
    v_mfma_f32_16x16x32_bf16 v[108:111], a[192:195], a[52:55], v[108:111]
    v_add_f32 v62, 1.0, v62
    v_add_f32 v63, 1.0, v63
    v_mfma_f32_16x16x32_bf16 v[108:111], a[212:215], a[72:75], v[108:111]
    ds_write_b128 v11, v[104:107] offset:2048
    v_mfma_f32_16x16x32_bf16 v[108:111], a[232:235], a[92:95], v[108:111]
    s_waitcnt lgkmcnt(1)
    buffer_load_dwordx4 v[252:255], v14, s[8:11], s65 offen offset:2048 sc1
    v_mfma_f32_16x16x32_bf16 v[112:115], a[156:159], a[12:15], v[112:115]
    s_barrier
    v_mfma_f32_16x16x32_bf16 v[112:115], a[176:179], a[32:35], v[112:115]
    ds_read_b128 v[140:143], v7 offset:1024
    v_mfma_f32_16x16x32_bf16 v[112:115], a[196:199], a[52:55], v[112:115]
    s_waitcnt lgkmcnt(1)
    v_rcp_f32 v60, v60
    v_mfma_f32_16x16x32_bf16 v[112:115], a[216:219], a[72:75], v[112:115]
    s_barrier
    v_mfma_f32_16x16x32_bf16 v[112:115], a[236:239], a[92:95], v[112:115]
    s_waitcnt vmcnt(3)
    ds_read_b128 v[144:147], v7 offset:2048
    v_mfma_f32_16x16x32_bf16 v[136:139], a[140:143], a[112:115], v[136:139]
    ds_write_b128 v11, v[108:111] offset:3072
    v_mfma_f32_16x16x32_bf16 v[136:139], a[160:163], a[132:135], v[136:139]
    v_rcp_f32 v61, v61
    v_mfma_f32_16x16x32_bf16 v[136:139], a[180:183], a[16:19], v[136:139]
    v_rcp_f32 v62, v62
    v_mfma_f32_16x16x32_bf16 v[136:139], a[200:203], a[36:39], v[136:139]
    ds_write_b128 v11, v[112:115] offset:4096
    v_mfma_f32_16x16x32_bf16 v[136:139], a[220:223], a[56:59], v[136:139]
    s_waitcnt lgkmcnt(1)
    v_rcp_f32 v63, v63
    v_mfma_f32_16x16x32_bf16 v[140:143], a[144:147], a[112:115], v[140:143]
    s_barrier
    v_mul_f32 v60, v60, v120
    v_mfma_f32_16x16x32_bf16 v[140:143], a[164:167], a[132:135], v[140:143]
    ds_read_b128 v[148:151], v7 offset:3072
    v_mul_f32 v61, v61, v121
    v_mfma_f32_16x16x32_bf16 v[140:143], a[184:187], a[16:19], v[140:143]
    s_waitcnt lgkmcnt(1)
    v_mul_f32 v62, v62, v122
    v_mul_f32 v63, v63, v123
    v_mfma_f32_16x16x32_bf16 v[140:143], a[204:207], a[36:39], v[140:143]
    s_barrier
    v_mul_f32 v64, s68, v124
    v_mfma_f32_16x16x32_bf16 v[140:143], a[224:227], a[56:59], v[140:143]
    ds_read_b128 v[152:155], v7 offset:4096
    v_mul_f32 v65, s68, v125
    v_mfma_f32_16x16x32_bf16 v[144:147], a[148:151], a[112:115], v[144:147]
    v_mul_f32 v66, s68, v126
    v_mul_f32 v67, s68, v127
    v_mfma_f32_16x16x32_bf16 v[144:147], a[168:171], a[132:135], v[144:147]
    v_exp_f32 v64, v64
    v_mfma_f32_16x16x32_bf16 v[144:147], a[188:191], a[16:19], v[144:147]
    v_exp_f32 v65, v65
    v_mfma_f32_16x16x32_bf16 v[144:147], a[208:211], a[36:39], v[144:147]
    v_exp_f32 v66, v66
    v_mfma_f32_16x16x32_bf16 v[144:147], a[228:231], a[56:59], v[144:147]
    s_waitcnt lgkmcnt(1)
    v_exp_f32 v67, v67
    v_mfma_f32_16x16x32_bf16 v[148:151], a[152:155], a[112:115], v[148:151]
    v_add_f32 v64, 1.0, v64
    v_add_f32 v65, 1.0, v65
    v_mfma_f32_16x16x32_bf16 v[148:151], a[172:175], a[132:135], v[148:151]
    s_waitcnt lgkmcnt(0)
    v_add_f32 v66, 1.0, v66
    v_add_f32 v67, 1.0, v67
    v_mfma_f32_16x16x32_bf16 v[148:151], a[192:195], a[16:19], v[148:151]
    v_rcp_f32 v64, v64
    v_mfma_f32_16x16x32_bf16 v[148:151], a[212:215], a[36:39], v[148:151]
    v_rcp_f32 v65, v65
    v_mfma_f32_16x16x32_bf16 v[148:151], a[232:235], a[56:59], v[148:151]
    v_rcp_f32 v66, v66
    v_mfma_f32_16x16x32_bf16 v[152:155], a[156:159], a[112:115], v[152:155]
    v_rcp_f32 v67, v67
    v_mfma_f32_16x16x32_bf16 v[152:155], a[176:179], a[132:135], v[152:155]
    v_mul_f32 v64, v64, v124
    v_mul_f32 v65, v65, v125
    v_mfma_f32_16x16x32_bf16 v[152:155], a[196:199], a[16:19], v[152:155]
    v_mul_f32 v66, v66, v126
    v_mul_f32 v67, v67, v127
    v_mfma_f32_16x16x32_bf16 v[152:155], a[216:219], a[36:39], v[152:155]
    v_mfma_f32_16x16x32_bf16 v[152:155], a[236:239], a[56:59], v[152:155]
    s_waitcnt vmcnt(2)
    v_xor_b32 v8, s55, v247
    s_waitcnt vmcnt(1)
    v_bitop3_b32 v8, v8, v251, s55 bitop3:0xf6
    s_waitcnt vmcnt(0)
    v_bitop3_b32 v8, v8, v255, s55 bitop3:0xf6
    v_and_b32 v8, 0xffff, v8
    v_cmp_ne_u32 vcc, 0, v8
    s_nop 3
    s_cbranch_vccnz L_spin_ff_xy
L_ret_ff_xy:
    v_lshlrev_b32 v76, 16, v244
    v_and_b32 v77, 0xffff0000, v244
    v_lshlrev_b32 v78, 16, v245
    v_and_b32 v79, 0xffff0000, v245
    v_pk_add_f32 v[136:137], v[136:137], v[76:77]
    v_pk_add_f32 v[138:139], v[138:139], v[78:79]
    v_pk_fma_f32 v[56:57], v[56:57], v[136:137], v[36:37]
    v_pk_fma_f32 v[58:59], v[58:59], v[138:139], v[38:39]
    global_store_dwordx4 v10, v[56:59], s[12:13] offset:0 sc1
    v_lshlrev_b32 v80, 16, v246
    v_and_b32 v81, 0xffff0000, v246
    v_and_b32 v82, 0xffff0000, v247
    v_lshlrev_b32 v83, 16, v248
    v_pk_add_f32 v[140:141], v[140:141], v[80:81]
    v_pk_add_f32 v[142:143], v[142:143], v[82:83]
    v_pk_fma_f32 v[60:61], v[60:61], v[140:141], v[40:41]
    v_pk_fma_f32 v[62:63], v[62:63], v[142:143], v[42:43]
    global_store_dwordx4 v10, v[60:63], s[12:13] offset:64 sc1
    v_and_b32 v84, 0xffff0000, v248
    v_lshlrev_b32 v85, 16, v249
    v_and_b32 v86, 0xffff0000, v249
    v_lshlrev_b32 v87, 16, v250
    v_pk_add_f32 v[144:145], v[144:145], v[84:85]
    v_pk_add_f32 v[146:147], v[146:147], v[86:87]
    v_pk_fma_f32 v[64:65], v[64:65], v[144:145], v[44:45]
    v_pk_fma_f32 v[66:67], v[66:67], v[146:147], v[46:47]
    global_store_dwordx4 v10, v[64:67], s[12:13] offset:128 sc1
    v_pk_mul_f32 v[68:69], v[128:129], s[68:69]
    v_pk_mul_f32 v[70:71], v[130:131], s[68:69]
    v_exp_f32 v68, v68
    v_exp_f32 v69, v69
    v_exp_f32 v70, v70
    v_exp_f32 v71, v71
    v_pk_add_f32 v[68:69], v[68:69], 1.0 op_sel_hi:[1,0]
    v_pk_add_f32 v[70:71], v[70:71], 1.0 op_sel_hi:[1,0]
    v_rcp_f32 v68, v68
    v_rcp_f32 v69, v69
    v_rcp_f32 v70, v70
    v_rcp_f32 v71, v71
    v_pk_mul_f32 v[68:69], v[68:69], v[128:129]
    v_pk_mul_f32 v[70:71], v[70:71], v[130:131]
    v_and_b32 v88, 0xffff0000, v250
    v_and_b32 v89, 0xffff0000, v251
    v_lshlrev_b32_e64 v90, 16, v252
    v_and_b32 v91, 0xffff0000, v252
    v_pk_add_f32 v[148:149], v[148:149], v[88:89]
    v_pk_add_f32 v[150:151], v[150:151], v[90:91]
    v_pk_fma_f32 v[68:69], v[68:69], v[148:149], v[48:49]
    v_pk_fma_f32 v[70:71], v[70:71], v[150:151], v[50:51]
    global_store_dwordx4 v10, v[68:71], s[12:13] offset:192 sc1
    v_pk_mul_f32 v[72:73], v[132:133], s[68:69]
    v_pk_mul_f32 v[74:75], v[134:135], s[68:69]
    v_exp_f32 v72, v72
    v_exp_f32 v73, v73
    v_exp_f32 v74, v74
    v_exp_f32 v75, v75
    v_pk_add_f32 v[72:73], v[72:73], 1.0 op_sel_hi:[1,0]
    v_pk_add_f32 v[74:75], v[74:75], 1.0 op_sel_hi:[1,0]
    v_rcp_f32 v72, v72
    v_rcp_f32 v73, v73
    v_rcp_f32 v74, v74
    v_rcp_f32 v75, v75
    v_pk_mul_f32 v[72:73], v[72:73], v[132:133]
    v_pk_mul_f32 v[74:75], v[74:75], v[134:135]
    v_lshlrev_b32 v92, 16, v253
    v_and_b32 v93, 0xffff0000, v253
    v_lshlrev_b32 v94, 16, v254
    v_and_b32 v95, 0xffff0000, v254
    v_pk_add_f32 v[152:153], v[152:153], v[92:93]
    v_pk_add_f32 v[154:155], v[154:155], v[94:95]
    v_pk_fma_f32 v[72:73], v[72:73], v[152:153], v[52:53]
    v_pk_fma_f32 v[74:75], v[74:75], v[154:155], v[54:55]
    global_store_dwordx4 v10, v[72:75], s[12:13] offset:256 sc1
    s_endpgm
L_s5:
    s_mov_b32 s56, 5120
    s_mov_b32 s57, 81920
    s_mov_b32 s58, 87040
    s_mov_b32 s76, 40960
    s_lshl_b32 s70, s61, 2
    v_lshrrev_b32 v12, 4, v0
    v_add_u32 v12, s70, v12
    v_and_b32 v2, 7, v0
    v_xor_b32 v2, v2, v12
    v_lshlrev_b32 v2, 4, v2
    v_lshrrev_b32 v12, 5, v0
    v_lshlrev_b32 v12, 4, v12
    v_bfe_u32 v13, v0, 3, 1
    v_lshl_add_u32 v12, v13, 3, v12
    v_bfe_u32 v13, v0, 4, 1
    v_add_u32 v12, v12, v13
    s_lshl_b32 s70, s53, 2
    s_add_u32 s70, s70, s61
    s_lshl_b32 s70, s70, 4
    s_add_u32 s70, s70, s62
    s_lshl_b32 s70, s70, 1
    v_add_u32 v12, s70, v12
    v_mul_u32_u24 v12, 1280, v12
    v_add_u32 v1, v2, v12
    s_lshl_b32 s70, s52, 3
    v_lshrrev_b32 v12, 3, v0
    v_add_u32 v12, s70, v12
    v_mul_u32_u24 v12, 1280, v12
    v_add_u32 v206, v2, v12
    s_mul_i32 s70, s68, 1280
    v_add_u32 v2, s70, v206
    v_lshrrev_b32 v12, 1, v7
    v_xor_b32 v12, v12, v8
    v_lshlrev_b32 v12, 4, v12
    v_lshl_add_u32 v12, v7, 7, v12
    s_lshl_b32 s70, s61, 13
    s_add_u32 s70, s70, 40960
    v_add_u32 v3, s70, v12
    v_xor_b32 v4, 64, v3
    s_mul_i32 s70, s62, 6144
    s_add_u32 s70, s70, 57344
    v_add_u32 v5, s70, v12
    v_xor_b32 v6, 64, v5
    v_lshlrev_b32 v14, 4, v0
    v_add_u32 v15, 4096, v14
    s_lshl_b32 s70, s61, 2
    v_add_u32 v9, s70, v8
    s_and_b32 s72, s2, 6
    s_lshl_b32 s72, s72, 1
    s_lshr_b32 s73, s2, 2
    s_and_b32 s73, s73, 2
    s_lshr_b32 s74, s2, 6
    s_xor_b32 s73, s73, s74
    s_add_u32 s72, s72, s73
    s_lshl_b32 s72, s72, 1
    s_and_b32 s74, s2, 1
    s_add_u32 s72, s72, s74
    s_add_u32 m0, s59, 40960
    s_nop 0
    buffer_load_dwordx4 v1, s[4:7], 0 offen offset:0 lds
    s_xor_b32 s73, s72, 1
    s_lshr_b32 s50, s72, 1
    s_lshl_b32 s50, s50, 12
    s_add_u32 s50, s50, 17563648
    s_lshl_b32 s74, s74, 2
    s_add_u32 s74, s74, s52
    s_cmp_ge_u32 s74, 6
    s_cselect_b32 s3, 1073741824, 0
    s_lshl_b32 s49, s74, 5
    s_add_u32 s49, s49, s50
    s_lshl_b32 s75, s73, 3
    s_add_u32 s75, s75, s74
    s_mul_i32 s40, s75, 49152
    s_lshl_b32 s42, s75, 6
    s_add_u32 s42, s42, 17317888
    s_lshl_b32 s75, s72, 3
    s_add_u32 s75, s75, s74
    s_mul_i32 s41, s75, 49152
    s_lshl_b32 s43, s75, 6
    s_add_u32 s43, s43, 17317888
    s_bfe_u32 s75, s2, 0x30003
    s_mul_i32 s47, s75, 160
    s_lshl_b32 s63, s75, 3
    s_add_u32 s63, s63, s74
    s_mul_i32 s63, s63, 61440
    s_add_u32 s63, s63, 12582912
    s_add_u32 m0, s59, 57344
    s_nop 0
    buffer_load_dwordx4 v2, s[24:27], 0 offen offset:0 lds
    s_mul_i32 s74, s75, 5
    s_lshr_b32 s74, s74, 2
    s_lshl_b32 s74, s74, 6
    s_add_u32 s50, s50, s74
    s_lshl_b32 s74, s74, 2
    s_add_u32 s49, s49, s74
    s_lshl_b32 s74, s52, 5
    s_add_u32 s50, s50, s74
    s_add_u32 s50, s50, 3072
    s_lshl_b32 s75, s75, 2
    s_add_u32 s75, s75, s52
    s_lshl_b32 s74, s73, 5
    s_add_u32 s74, s74, s75
    s_mul_i32 s44, s74, 6272
    s_add_u32 s44, s44, 17825792
    s_lshl_b32 s74, s72, 5
    s_add_u32 s74, s74, s75
    s_mul_i32 s45, s74, 6272
    s_add_u32 s45, s45, 17825792
    s_lshl_b32 s74, s72, 2
    s_add_u32 s74, s74, s52
    s_mul_i32 s46, s74, 20480
    s_add_u32 s46, s46, s47
    s_lshl_b32 s48, s74, 7
    s_add_u32 s48, s48, 16777216
    s_buffer_load_dword s66, s[8:11], s42 glc
    s_add_u32 m0, s59, 69632
    s_nop 0
    buffer_load_dwordx4 v2, s[28:31], 0 offen offset:0 lds
    s_lshl_b32 s72, s77, 1
    s_add_u32 s72, s72, s62
    s_lshl_b32 s73, s53, 1
    s_add_u32 s73, s73, s61
    s_lshl_b32 s73, s73, 3
    s_add_u32 s18, s72, 56
    s_and_b32 s74, s18, 7
    s_add_u32 s74, s74, s73
    s_lshr_b32 s18, s18, 3
    s_lshl_b32 s21, s74, 4
    s_add_u32 s21, s21, s18
    s_lshl_b32 s21, s21, 2
    s_add_u32 s21, s21, 17317888
    s_mul_i32 s74, s74, 12
    s_add_u32 s18, s18, s74
    s_lshl_b32 s18, s18, 12
    s_add_u32 s19, s72, 70
    s_and_b32 s74, s19, 7
    s_add_u32 s74, s74, s73
    s_lshr_b32 s19, s19, 3
    s_lshl_b32 s22, s74, 4
    s_add_u32 s22, s22, s19
    s_lshl_b32 s22, s22, 2
    s_add_u32 s22, s22, 17317888
    s_mul_i32 s74, s74, 12
    s_add_u32 s19, s19, s74
    s_add_u32 m0, s59, 45056
    s_nop 0
    buffer_load_dwordx4 v1, s[4:7], s56 offen offset:0 lds
    s_lshl_b32 s19, s19, 12
    s_add_u32 s20, s72, 83
    s_and_b32 s74, s20, 7
    s_add_u32 s74, s74, s73
    s_lshr_b32 s20, s20, 3
    s_lshl_b32 s23, s74, 4
    s_add_u32 s23, s23, s20
    s_lshl_b32 s23, s23, 2
    s_add_u32 s23, s23, 17317888
    s_mul_i32 s74, s74, 12
    s_add_u32 s20, s20, s74
    s_lshl_b32 s20, s20, 12
    s_cmp_lt_u32 s60, 624
    s_cselect_b32 s75, 0, 1073741824
    s_add_u32 s19, s19, s75
    s_add_u32 s20, s20, s75
    s_add_u32 s22, s22, s75
    s_add_u32 s23, s23, s75
    s_lshl_b32 s73, s73, 6
    s_add_u32 s73, s73, 16777216
    s_lshl_b32 s74, s60, 4
    s_add_u32 s74, s74, 16973824
    s_waitcnt vmcnt(17)
    v_lshlrev_b32 v18, 16, v18
    v_mul_f32 v18, 0x3fb8aa3b, v18
    v_exp_f32 v18, v18
    s_add_u32 m0, s59, 61440
    s_nop 0
    buffer_load_dwordx4 v2, s[24:27], s76 offen offset:0 lds
    v_lshlrev_b32 v16, 16, v16
    v_lshlrev_b32 v17, 16, v17
    v_cvt_pk_bf16_f32 v18, v18, v18
    v_and_b32 v18, 0xffff0000, v18
    v_mul_f32 v72, v18, v16
    v_mul_f32 v73, v18, v17
    v_mul_f32 v72, 0x3fb8aa3b, v72
    v_mul_f32 v73, 0x3e22f983, v73
    v_mul_f32 v56, 0x3f800000, v72
    v_mul_f32 v57, 0x3f800000, v73
    v_exp_f32 v56, v56
    v_fract_f32 v57, v57
    v_cos_f32 v64, v57
    v_sin_f32 v65, v57
    v_mul_f32 v64, v56, v64
    v_mul_f32_e64 v65, v56, v65
    v_pk_mul_f32 v[56:57], v[64:65], v[64:65] op_sel:[0,0] op_sel_hi:[0,1]
    v_pk_fma_f32 v[66:67], v[64:65], v[64:65], v[56:57] op_sel:[1,1,0] op_sel_hi:[1,0,1] neg_lo:[1,0,0]
    v_pk_mul_f32 v[56:57], v[66:67], v[66:67] op_sel:[0,0] op_sel_hi:[0,1]
    v_pk_fma_f32 v[66:67], v[66:67], v[66:67], v[56:57] op_sel:[1,1,0] op_sel_hi:[1,0,1] neg_lo:[1,0,0]
    v_pk_mul_f32 v[56:57], v[66:67], v[66:67] op_sel:[0,0] op_sel_hi:[0,1]
    v_pk_fma_f32 v[66:67], v[66:67], v[66:67], v[56:57] op_sel:[1,1,0] op_sel_hi:[1,0,1] neg_lo:[1,0,0]
    v_pk_mul_f32 v[56:57], v[66:67], v[66:67] op_sel:[0,0] op_sel_hi:[0,1]
    s_add_u32 m0, s59, 49152
    s_nop 0
    s_nop 0
    buffer_load_dwordx4 v1, s[4:7], s57 offen offset:0 lds
    v_pk_fma_f32 v[68:69], v[66:67], v[66:67], v[56:57] op_sel:[1,1,0] op_sel_hi:[1,0,1] neg_lo:[1,0,0]
    v_pk_mul_f32 v[56:57], v[68:69], v[68:69] op_sel:[0,0] op_sel_hi:[0,1]
    v_pk_fma_f32 v[70:71], v[68:69], v[68:69], v[56:57] op_sel:[1,1,0] op_sel_hi:[1,0,1] neg_lo:[1,0,0]
    v_pk_mul_f32 v[56:57], v[70:71], v[70:71] op_sel:[0,0] op_sel_hi:[0,1]
    v_pk_fma_f32 v[70:71], v[70:71], v[70:71], v[56:57] op_sel:[1,1,0] op_sel_hi:[1,0,1] neg_lo:[1,0,0]
    v_pk_mul_f32 v[56:57], v[70:71], v[70:71] op_sel:[0,0] op_sel_hi:[0,1]
    v_pk_fma_f32 v[70:71], v[70:71], v[70:71], v[56:57] op_sel:[1,1,0] op_sel_hi:[1,0,1] neg_lo:[1,0,0]
    v_pk_mul_f32 v[56:57], v[70:71], v[70:71] op_sel:[0,0] op_sel_hi:[0,1]
    v_pk_fma_f32 v[70:71], v[70:71], v[70:71], v[56:57] op_sel:[1,1,0] op_sel_hi:[1,0,1] neg_lo:[1,0,0]
    v_pk_mul_f32 v[56:57], v[70:71], v[70:71] op_sel:[0,0] op_sel_hi:[0,1]
    v_pk_fma_f32 v[70:71], v[70:71], v[70:71], v[56:57] op_sel:[1,1,0] op_sel_hi:[1,0,1] neg_lo:[1,0,0]
    v_add_f32 v56, -1.0, v64
    v_mul_f32 v57, v16, v16
    v_fmac_f32 v57, v17, v17
    v_rcp_f32 v57, v57
    v_mul_f32 v74, v56, v16
    v_fmac_f32 v74, v65, v17
    v_mul_f32 v75, v65, v16
    v_fma_f32 v75, -v56, v17, v75
    v_add_f32 v57, v57, v57
    v_mul_f32 v74, v74, v57
    v_mul_f32 v75, v75, v57
    v_mov_b64 v[204:205], v[68:69]
    s_lshl_b32 s70, s52, 12
    v_mul_u32_u24 v12, 48, v0
    s_add_u32 m0, s59, 73728
    s_nop 0
    buffer_load_dwordx4 v2, s[28:31], s76 offen offset:0 lds
    v_add_u32 v12, s70, v12
    ds_write_b128 v12, v[64:67] offset:0
    ds_write_b128 v12, v[68:71] offset:16
    ds_write_b128 v12, v[72:75] offset:32
    v_lshl_add_u32 v12, v0, 3, s70
    ds_write_b64 v12, v[74:75] offset:3072
    v_mul_u32_u24 v12, 48, v7
    v_add_u32_e64 v12, s70, v12
    ds_read_b128 v[168:171], v12 offset:0
    ds_read_b128 v[172:175], v12 offset:16
    ds_read_b128 v[176:179], v12 offset:32
    ds_read_b128 v[180:183], v12 offset:768
    ds_read_b128 v[184:187], v12 offset:784
    ds_read_b128 v[188:191], v12 offset:800
    ds_read_b128 v[192:195], v12 offset:1536
    ds_read_b128 v[196:199], v12 offset:1552
    ds_read_b128 v[200:203], v12 offset:1568
    v_and_b32 v13, 1, v8
    v_lshl_add_u32 v12, v13, 6, s70
    ds_read_b128 v[208:211], v12 offset:3456
    ds_read_b128 v[212:215], v12 offset:3472
    ds_read_b128 v[216:219], v12 offset:3488
    ds_read_b128 v[220:223], v12 offset:3504
    v_lshrrev_b32 v12, 1, v8
    v_lshl_add_u32 v207, v12, 4, v7
    v_lshlrev_b32 v207, 7, v207
    s_add_u32 m0, s59, 65536
    s_nop 0
    buffer_load_dwordx4 v2, s[24:27], s57 offen offset:0 lds
    s_lshl_b32 s70, s52, 1
    v_add_u32 v62, s70, v13
    v_lshrrev_b32 v63, 1, v7
    v_xor_b32 v62, v62, v63
    v_lshl_add_u32 v207, v62, 4, v207
    v_lshlrev_b32 v13, 8, v13
    v_lshl_add_u32 v13, v7, 4, v13
    s_lshl_b32 s70, s65, 2
    v_add_u32 v12, s70, v12
    s_mov_b32 s71, 486400
    v_mul_u32_u24 v62, 52, v12
    v_lshrrev_b32 v62, 8, v62
    v_mul_u32_u24 v62, s71, v62
    v_lshl_add_u32 v62, v12, 10, v62
    v_add_u32 v224, v62, v13
    v_add_u32 v12, 2, v12
    v_mul_u32_u24 v62, 52, v12
    v_lshrrev_b32 v62, 8, v62
    v_mul_u32_u24 v62, s71, v62
    v_lshl_add_u32 v62, v12, 10, v62
    v_add_u32 v225, v62, v13
    v_add_u32 v12, 2, v12
    s_cmp_ge_u32 s64, 5
    s_cselect_b32 s70, 3, 0
    s_add_u32 s70, s70, s64
    s_lshl_b32 s71, s65, 4
    s_add_u32 m0, s59, 53248
    s_nop 0
    buffer_load_dwordx4 v1, s[4:7], s58 offen offset:0 lds
    s_add_u32 s70, s70, s71
    s_lshl_b32 s70, s70, 2
    s_add_u32 s51, s70, 17566720
    s_lshl_b32 s70, s64, 2
    s_add_u32 s70, s70, s52
    s_mul_i32 s71, s70, 86
    s_lshr_b32 s71, s71, 8
    s_mul_i32 s67, s71, 3
    s_sub_u32 s70, s70, s67
    s_mul_i32 s70, s70, 27
    s_add_u32 s70, s70, 1
    s_lshr_b32 s70, s70, 1
    s_add_u32 s70, s70, s71
    s_and_b32 s71, s70, 7
    s_mul_i32 s71, s71, 12
    s_lshr_b32 s70, s70, 3
    s_add_u32 s70, s70, s71
    s_mul_i32 s70, s70, 5120
    s_add_u32 s72, s70, 12618752
    s_mul_i32 s65, s65, 81920
    s_lshl_b32 s70, s64, 7
    s_add_u32 s70, s70, s65
    s_cmp_lt_u32 s64, 10
    s_cselect_b32 s64, s70, 1073741824
    s_cselect_b32 s72, s72, 1073741824
    s_cselect_b32 s51, s51, 1073741824
    s_add_u32 m0, s59, 77824
    s_nop 0
    buffer_load_dwordx4 v2, s[28:31], s57 offen offset:0 lds
    s_add_u32 s65, s64, 40960
    s_waitcnt vmcnt(22)
    v_readfirstlane_b32 s55, v255
    s_nop 0
    s_mul_i32 s55, s55, 0x9e3779b1
    s_add_u32 s55, s55, 0x7f4a7c15
    v_mov_b32 v13, s55
    v_mov_b32 v250, 0
    v_mov_b32 v251, 0
    s_waitcnt vmcnt(21)
    v_dot2c_f32_bf16 v250, 0x3f803f80, v240
    v_dot2c_f32_bf16 v251, v240, v240
    v_dot2c_f32_bf16 v250, 0x3f803f80, v241
    v_dot2c_f32_bf16 v251, v241, v241
    s_waitcnt vmcnt(20)
    v_dot2c_f32_bf16 v250, 0x3f803f80, v242
    v_dot2c_f32_bf16 v251, v242, v242
    v_dot2c_f32_bf16 v250, 0x3f803f80, v243
    v_dot2c_f32_bf16 v251, v243, v243
    s_waitcnt vmcnt(19)
    v_dot2c_f32_bf16 v250, 0x3f803f80, v244
    v_dot2c_f32_bf16 v251, v244, v244
    s_add_u32 m0, s59, 81792
    s_nop 0
    buffer_load_dwordx4 v1, s[4:7], 0 offen offset:128 lds
    v_dot2c_f32_bf16 v250, 0x3f803f80, v245
    v_dot2c_f32_bf16 v251, v245, v245
    s_waitcnt vmcnt(19)
    v_dot2c_f32_bf16 v250, 0x3f803f80, v246
    v_dot2c_f32_bf16 v251, v246, v246
    v_dot2c_f32_bf16 v250, 0x3f803f80, v247
    v_dot2c_f32_bf16 v251, v247, v247
    s_waitcnt vmcnt(18)
    v_dot2c_f32_bf16 v250, 0x3f803f80, v248
    v_dot2c_f32_bf16 v251, v248, v248
    v_dot2c_f32_bf16 v250, 0x3f803f80, v249
    v_dot2c_f32_bf16 v251, v249, v249
    s_nop 1
    v_add_f32_dpp v250, v250, v250 row_ror:8 row_mask:0xf bank_mask:0xf
    v_add_f32_dpp v251, v251, v251 row_ror:8 row_mask:0xf bank_mask:0xf
    s_add_u32 m0, s59, 98176
    s_nop 0
    buffer_load_dwordx4 v2, s[24:27], 0 offen offset:128 lds
    v_add_f32_dpp v250, v250, v250 row_ror:4 row_mask:0xf bank_mask:0xf
    v_add_f32_dpp v251, v251, v251 row_ror:4 row_mask:0xf bank_mask:0xf
    s_nop 0
    v_add_f32_dpp v250, v250, v250 row_ror:2 row_mask:0xf bank_mask:0xf
    v_add_f32_dpp v251, v251, v251 row_ror:2 row_mask:0xf bank_mask:0xf
    s_nop 0
    v_add_f32_dpp v250, v250, v250 row_ror:1 row_mask:0xf bank_mask:0xf
    v_add_f32_dpp v251, v251, v251 row_ror:1 row_mask:0xf bank_mask:0xf
    v_mov_b32 v252, v250
    v_mov_b32 v253, v251
    s_nop 0
    v_permlane16_swap_b32 v250, v252
    v_permlane16_swap_b32 v251, v253
    s_add_u32 m0, s59, 110464
    s_nop 0
    buffer_load_dwordx4 v2, s[28:31], 0 offen offset:128 lds
    v_add_f32 v250, v250, v252
    v_add_f32 v251, v251, v253
    v_mul_f32 v250, 0x3acccccd, v250
    v_mul_f32 v251, 0x3acccccd, v251
    v_fma_f32 v251, -v250, v250, v251
    v_max_f32 v251, 0, v251
    v_cvt_pk_bf16_f32 v251, v251, v251
    v_and_b32 v251, 0xffff0000, v251
    v_add_f32 v251, 0x3727c5ac, v251
    v_cvt_pk_bf16_f32 v251, v251, v251
    v_and_b32 v251, 0xffff0000, v251
    v_sqrt_f32 v251, v251
    s_add_u32 m0, s59, 85888
    s_nop 0
    buffer_load_dwordx4 v1, s[4:7], s56 offen offset:128 lds
    v_mov_b32 v253, s55
    v_lshlrev_b32 v254, 3, v254
    v_cvt_pk_bf16_f32 v252, -v250, v251
    s_mov_b32 s70, 16777216
    s_mov_b32 exec_lo, 1
    s_mov_b32 exec_hi, 1
    buffer_store_dwordx2 v[252:253], v254, s[8:11], s70 offen sc1
    s_mov_b64 exec, -1
    v_mov_b32 v56, 0
    s_waitcnt vmcnt(21)
    v_dot2c_f32_bf16 v56, 0x3f803f80, v32
    v_dot2c_f32_bf16 v56, 0x3f803f80, v33
    s_add_u32 m0, s59, 102272
    s_nop 0
    buffer_load_dwordx4 v2, s[24:27], s76 offen offset:128 lds
    v_dot2c_f32_bf16 v56, 0x3f803f80, v34
    v_dot2c_f32_bf16 v56, 0x3f803f80, v35
    s_waitcnt vmcnt(21)
    v_dot2c_f32_bf16 v56, 0x3f803f80, v36
    v_dot2c_f32_bf16 v56, 0x3f803f80, v37
    v_dot2c_f32_bf16 v56, 0x3f803f80, v38
    v_dot2c_f32_bf16 v56, 0x3f803f80, v39
    s_waitcnt vmcnt(20)
    v_dot2c_f32_bf16 v56, 0x3f803f80, v40
    v_dot2c_f32_bf16 v56, 0x3f803f80, v41
    v_dot2c_f32_bf16 v56, 0x3f803f80, v42
    v_dot2c_f32_bf16 v56, 0x3f803f80, v43
    s_waitcnt vmcnt(19)
    v_dot2c_f32_bf16 v56, 0x3f803f80, v44
    v_dot2c_f32_bf16 v56, 0x3f803f80, v45
    s_add_u32 m0, s59, 89984
    s_nop 0
    buffer_load_dwordx4 v1, s[4:7], s57 offen offset:128 lds
    v_dot2c_f32_bf16 v56, 0x3f803f80, v46
    v_dot2c_f32_bf16 v56, 0x3f803f80, v47
    s_waitcnt vmcnt(19)
    v_dot2c_f32_bf16 v56, 0x3f803f80, v48
    v_dot2c_f32_bf16 v56, 0x3f803f80, v49
    v_dot2c_f32_bf16 v56, 0x3f803f80, v50
    v_dot2c_f32_bf16 v56, 0x3f803f80, v51
    s_nop 2
    v_add_f32_dpp v56, v56, v56 row_ror:8 row_mask:0xf bank_mask:0xf
    s_nop 1
    v_add_f32_dpp v56, v56, v56 row_ror:4 row_mask:0xf bank_mask:0xf
    s_nop 1
    v_add_f32_dpp v56, v56, v56 row_ror:2 row_mask:0xf bank_mask:0xf
    s_nop 1
    v_add_f32_dpp v56, v56, v56 row_ror:1 row_mask:0xf bank_mask:0xf
    v_mov_b32 v57, v13
    s_lshl_b32 s70, s69, 3
    s_add_u32 m0, s59, 114560
    s_nop 0
    buffer_load_dwordx4 v2, s[28:31], s76 offen offset:128 lds
    s_add_u32 s70, s70, 16973824
    v_lshlrev_b32 v11, 4, v10
    v_cmp_gt_u32 vcc, 640, v10
    v_mov_b32 v12, 1073741824
    s_nop 0
    v_cndmask_b32 v11, v12, v11, vcc
    s_mov_b32 exec_lo, 0x10001
    s_mov_b32 exec_hi, 0x10001
    buffer_store_dwordx2 v[56:57], v11, s[8:11], s70 offen sc1
    s_mov_b64 exec, -1
    s_add_u32 m0, s59, 106368
    s_nop 0
    buffer_load_dwordx4 v2, s[24:27], s57 offen offset:128 lds
    s_add_u32 m0, s59, 94080
    s_nop 0
    buffer_load_dwordx4 v1, s[4:7], s58 offen offset:128 lds
    s_add_u32 m0, s59, 118656
    s_nop 0
    buffer_load_dwordx4 v2, s[28:31], s57 offen offset:128 lds
    s_waitcnt vmcnt(12) lgkmcnt(0)
    s_barrier
    s_nop 0
    ds_read_b128 v[112:115], v3 offset:0
    ds_read_b128 v[144:147], v5 offset:0
    ds_read_b128 v[116:119], v3 offset:2048
    ds_read_b128 v[120:123], v3 offset:4096
    ds_read_b128 v[124:127], v3 offset:6144
    ds_read_b128 v[148:151], v5 offset:12288
    ds_read_b128 v[152:155], v5 offset:2048
    ds_read_b128 v[156:159], v5 offset:14336
    ds_read_b128 v[160:163], v5 offset:4096
    ds_read_b128 v[164:167], v5 offset:16384
    v_add_u32 v3, 40960, v3
    v_add_u32 v5, 40960, v5
    s_waitcnt lgkmcnt(8)
    v_mfma_f32_16x16x32_bf16 v[16:19], v[112:115], v[144:147], 0
    s_add_u32 m0, s59, 20480
    s_nop 0
    buffer_load_dwordx4 v206, s[32:35], s64 offen lds
    s_waitcnt lgkmcnt(7)
    v_mfma_f32_16x16x32_bf16 v[20:23], v[116:119], v[144:147], 0
    s_waitcnt lgkmcnt(6)
    v_mfma_f32_16x16x32_bf16 v[24:27], v[120:123], v[144:147], 0
    s_waitcnt lgkmcnt(5)
    v_mfma_f32_16x16x32_bf16 v[28:31], v[124:127], v[144:147], 0
    s_add_u32 m0, s59, 24576
    ds_read_b128 v[144:147], v6 offset:0
    s_waitcnt lgkmcnt(5)
    v_mfma_f32_16x16x32_bf16 v[32:35], v[112:115], v[148:151], 0
    ds_read_b128 v[128:131], v4 offset:0
    buffer_load_dwordx4 v206, s[32:35], s65 offen lds
    v_mfma_f32_16x16x32_bf16 v[36:39], v[116:119], v[148:151], 0
    ds_read_b128 v[132:135], v4 offset:2048
    v_mfma_f32_16x16x32_bf16 v[40:43], v[120:123], v[148:151], 0
    s_add_u32 m0, s59, 28672
    v_mfma_f32_16x16x32_bf16 v[44:47], v[124:127], v[148:151], 0
    s_waitcnt lgkmcnt(3)
    ds_read_b128 v[148:151], v6 offset:12288
    v_mfma_f32_16x16x32_bf16 v[48:51], v[112:115], v[152:155], 0
    ds_read_b128 v[136:139], v4 offset:4096
    buffer_load_dwordx4 v206, s[36:39], s64 offen lds
    v_mfma_f32_16x16x32_bf16 v[52:55], v[116:119], v[152:155], 0
    ds_read_b128 v[140:143], v4 offset:6144
    v_mfma_f32_16x16x32_bf16 v[56:59], v[120:123], v[152:155], 0
    v_mfma_f32_16x16x32_bf16 v[60:63], v[124:127], v[152:155], 0
    ds_read_b128 v[152:155], v6 offset:2048
    v_mfma_f32_16x16x32_bf16 v[64:67], v[112:115], v[156:159], 0
    s_add_u32 m0, s59, 32768
    v_mfma_f32_16x16x32_bf16 v[68:71], v[116:119], v[156:159], 0
    buffer_load_dwordx4 v206, s[36:39], s65 offen lds
    v_add_u32 v4, 40960, v4
    v_mfma_f32_16x16x32_bf16 v[72:75], v[120:123], v[156:159], 0
    v_mfma_f32_16x16x32_bf16 v[76:79], v[124:127], v[156:159], 0
    ds_read_b128 v[156:159], v6 offset:14336
    v_mfma_f32_16x16x32_bf16 v[80:83], v[112:115], v[160:163], 0
    s_add_u32 m0, s59, 122624
    v_mfma_f32_16x16x32_bf16 v[84:87], v[116:119], v[160:163], 0
    buffer_load_dwordx4 v1, s[4:7], 0 offen offset:256 lds
    v_mfma_f32_16x16x32_bf16 v[88:91], v[120:123], v[160:163], 0
    v_mfma_f32_16x16x32_bf16 v[92:95], v[124:127], v[160:163], 0
    ds_read_b128 v[160:163], v6 offset:4096
    v_mfma_f32_16x16x32_bf16 v[96:99], v[112:115], v[164:167], 0
    s_add_u32 m0, s59, 139008
    v_mfma_f32_16x16x32_bf16 v[100:103], v[116:119], v[164:167], 0
    buffer_load_dwordx4 v2, s[24:27], 0 offen offset:256 lds
    v_mfma_f32_16x16x32_bf16 v[104:107], v[120:123], v[164:167], 0
    v_mfma_f32_16x16x32_bf16 v[108:111], v[124:127], v[164:167], 0
    s_waitcnt lgkmcnt(3)
    ds_read_b128 v[164:167], v6 offset:16384
    v_add_u32 v6, 40960, v6
    v_mfma_f32_16x16x32_bf16 v[16:19], v[128:131], v[144:147], v[16:19]
    v_mfma_f32_16x16x32_bf16 v[20:23], v[132:135], v[144:147], v[20:23]
    s_add_u32 m0, s59, 151296
    v_mfma_f32_16x16x32_bf16 v[24:27], v[136:139], v[144:147], v[24:27]
    buffer_load_dwordx4 v2, s[28:31], 0 offen offset:256 lds
    v_mfma_f32_16x16x32_bf16 v[28:31], v[140:143], v[144:147], v[28:31]
    s_waitcnt vmcnt(7) lgkmcnt(0)
    s_barrier
    ds_read_b128 v[144:147], v5 offset:0
    v_mfma_f32_16x16x32_bf16 v[32:35], v[128:131], v[148:151], v[32:35]
    ds_read_b128 v[112:115], v3 offset:0
    v_mfma_f32_16x16x32_bf16 v[36:39], v[132:135], v[148:151], v[36:39]
    s_add_u32 m0, s59, 126720
    ds_read_b128 v[116:119], v3 offset:2048
    v_mfma_f32_16x16x32_bf16 v[40:43], v[136:139], v[148:151], v[40:43]
    buffer_load_dwordx4 v1, s[4:7], s56 offen offset:256 lds
    v_mfma_f32_16x16x32_bf16 v[44:47], v[140:143], v[148:151], v[44:47]
    ds_read_b128 v[148:151], v5 offset:12288
    v_mfma_f32_16x16x32_bf16 v[48:51], v[128:131], v[152:155], v[48:51]
    ds_read_b128 v[120:123], v3 offset:4096
    v_mfma_f32_16x16x32_bf16 v[52:55], v[132:135], v[152:155], v[52:55]
    s_add_u32 m0, s59, 143104
    ds_read_b128 v[124:127], v3 offset:6144
    v_mfma_f32_16x16x32_bf16 v[56:59], v[136:139], v[152:155], v[56:59]
    buffer_load_dwordx4 v2, s[24:27], s76 offen offset:256 lds
    v_mfma_f32_16x16x32_bf16 v[60:63], v[140:143], v[152:155], v[60:63]
    ds_read_b128 v[152:155], v5 offset:2048
    v_mfma_f32_16x16x32_bf16 v[64:67], v[128:131], v[156:159], v[64:67]
    v_mfma_f32_16x16x32_bf16 v[68:71], v[132:135], v[156:159], v[68:71]
    v_add_u32 v3, 40960, v3
    v_mfma_f32_16x16x32_bf16 v[72:75], v[136:139], v[156:159], v[72:75]
    s_add_u32 m0, s59, 130816
    v_mfma_f32_16x16x32_bf16 v[76:79], v[140:143], v[156:159], v[76:79]
    ds_read_b128 v[156:159], v5 offset:14336
    buffer_load_dwordx4 v1, s[4:7], s57 offen offset:256 lds
    v_mfma_f32_16x16x32_bf16 v[80:83], v[128:131], v[160:163], v[80:83]
    v_mfma_f32_16x16x32_bf16 v[84:87], v[132:135], v[160:163], v[84:87]
    v_mfma_f32_16x16x32_bf16 v[88:91], v[136:139], v[160:163], v[88:91]
    s_add_u32 m0, s59, 155392
    v_mfma_f32_16x16x32_bf16 v[92:95], v[140:143], v[160:163], v[92:95]
    ds_read_b128 v[160:163], v5 offset:4096
    buffer_load_dwordx4 v2, s[28:31], s76 offen offset:256 lds
    v_mfma_f32_16x16x32_bf16 v[96:99], v[128:131], v[164:167], v[96:99]
    v_mfma_f32_16x16x32_bf16 v[100:103], v[132:135], v[164:167], v[100:103]
    v_mfma_f32_16x16x32_bf16 v[104:107], v[136:139], v[164:167], v[104:107]
    s_add_u32 m0, s59, 147200
    v_mfma_f32_16x16x32_bf16 v[108:111], v[140:143], v[164:167], v[108:111]
    s_waitcnt lgkmcnt(3)
    ds_read_b128 v[164:167], v5 offset:16384
    v_add_u32 v5, 40960, v5
    v_mfma_f32_16x16x32_bf16 v[16:19], v[112:115], v[144:147], v[16:19]
    buffer_load_dwordx4 v2, s[24:27], s57 offen offset:256 lds
    v_mfma_f32_16x16x32_bf16 v[20:23], v[116:119], v[144:147], v[20:23]
    v_mfma_f32_16x16x32_bf16 v[24:27], v[120:123], v[144:147], v[24:27]
    v_mfma_f32_16x16x32_bf16 v[28:31], v[124:127], v[144:147], v[28:31]
    s_add_u32 m0, s59, 134912
    ds_read_b128 v[144:147], v6 offset:0
    v_mfma_f32_16x16x32_bf16 v[32:35], v[112:115], v[148:151], v[32:35]
    ds_read_b128 v[128:131], v4 offset:0
    buffer_load_dwordx4 v1, s[4:7], s58 offen offset:256 lds
    v_mfma_f32_16x16x32_bf16 v[36:39], v[116:119], v[148:151], v[36:39]
    ds_read_b128 v[132:135], v4 offset:2048
    v_mfma_f32_16x16x32_bf16 v[40:43], v[120:123], v[148:151], v[40:43]
    s_add_u32 m0, s59, 159488
    v_mfma_f32_16x16x32_bf16 v[44:47], v[124:127], v[148:151], v[44:47]
    s_waitcnt lgkmcnt(3)
    ds_read_b128 v[148:151], v6 offset:12288
    v_mfma_f32_16x16x32_bf16 v[48:51], v[112:115], v[152:155], v[48:51]
    ds_read_b128 v[136:139], v4 offset:4096
    buffer_load_dwordx4 v2, s[28:31], s57 offen offset:256 lds
    v_mfma_f32_16x16x32_bf16 v[52:55], v[116:119], v[152:155], v[52:55]
    ds_read_b128 v[140:143], v4 offset:6144
    v_mfma_f32_16x16x32_bf16 v[56:59], v[120:123], v[152:155], v[56:59]
    v_mfma_f32_16x16x32_bf16 v[60:63], v[124:127], v[152:155], v[60:63]
    ds_read_b128 v[152:155], v6 offset:2048
    v_mfma_f32_16x16x32_bf16 v[64:67], v[112:115], v[156:159], v[64:67]
    s_add_u32 m0, s59, 40576
    v_mfma_f32_16x16x32_bf16 v[68:71], v[116:119], v[156:159], v[68:71]
    buffer_load_dwordx4 v1, s[4:7], 0 offen offset:384 lds
    v_add_u32 v4, 40960, v4
    v_mfma_f32_16x16x32_bf16 v[72:75], v[120:123], v[156:159], v[72:75]
    v_mfma_f32_16x16x32_bf16 v[76:79], v[124:127], v[156:159], v[76:79]
    ds_read_b128 v[156:159], v6 offset:14336
    v_mfma_f32_16x16x32_bf16 v[80:83], v[112:115], v[160:163], v[80:83]
    s_add_u32 m0, s59, 56960
    v_mfma_f32_16x16x32_bf16 v[84:87], v[116:119], v[160:163], v[84:87]
    buffer_load_dwordx4 v2, s[24:27], 0 offen offset:384 lds
    v_mfma_f32_16x16x32_bf16 v[88:91], v[120:123], v[160:163], v[88:91]
    v_mfma_f32_16x16x32_bf16 v[92:95], v[124:127], v[160:163], v[92:95]
    ds_read_b128 v[160:163], v6 offset:4096
    v_mfma_f32_16x16x32_bf16 v[96:99], v[112:115], v[164:167], v[96:99]
    s_add_u32 m0, s59, 69248
    v_mfma_f32_16x16x32_bf16 v[100:103], v[116:119], v[164:167], v[100:103]
    buffer_load_dwordx4 v2, s[28:31], 0 offen offset:384 lds
    v_mfma_f32_16x16x32_bf16 v[104:107], v[120:123], v[164:167], v[104:107]
    v_mfma_f32_16x16x32_bf16 v[108:111], v[124:127], v[164:167], v[108:111]
    s_waitcnt lgkmcnt(3)
    ds_read_b128 v[164:167], v6 offset:16384
    v_add_u32 v6, 40960, v6
    v_mfma_f32_16x16x32_bf16 v[16:19], v[128:131], v[144:147], v[16:19]
    v_mfma_f32_16x16x32_bf16 v[20:23], v[132:135], v[144:147], v[20:23]
    s_add_u32 m0, s59, 44672
    v_mfma_f32_16x16x32_bf16 v[24:27], v[136:139], v[144:147], v[24:27]
    buffer_load_dwordx4 v1, s[4:7], s56 offen offset:384 lds
    v_mfma_f32_16x16x32_bf16 v[28:31], v[140:143], v[144:147], v[28:31]
    s_waitcnt vmcnt(4) lgkmcnt(0)
    s_barrier
    ds_read_b128 v[144:147], v5 offset:0
    v_mfma_f32_16x16x32_bf16 v[32:35], v[128:131], v[148:151], v[32:35]
    ds_read_b128 v[112:115], v3 offset:0
    ds_read_b128 v[228:231], v207 offset:20480
    v_mfma_f32_16x16x32_bf16 v[36:39], v[132:135], v[148:151], v[36:39]
    s_add_u32 m0, s59, 61056
    ds_read_b128 v[116:119], v3 offset:2048
    ds_read_b128 v[232:235], v207 offset:28672
    v_mfma_f32_16x16x32_bf16 v[40:43], v[136:139], v[148:151], v[40:43]
    buffer_load_dwordx4 v2, s[24:27], s76 offen offset:384 lds
    s_waitcnt lgkmcnt(2)
    v_lshlrev_b32 v244, 16, v228
    v_mfma_f32_16x16x32_bf16 v[44:47], v[140:143], v[148:151], v[44:47]
    ds_read_b128 v[148:151], v5 offset:12288
    s_waitcnt lgkmcnt(1)
    v_lshlrev_b32 v245, 16, v232
    v_mfma_f32_16x16x32_bf16 v[48:51], v[128:131], v[152:155], v[48:51]
    ds_read_b128 v[120:123], v3 offset:4096
    v_mul_f32 v246, v244, v208
    v_mfma_f32_16x16x32_bf16 v[52:55], v[132:135], v[152:155], v[52:55]
    s_add_u32 m0, s59, 48768
    ds_read_b128 v[124:127], v3 offset:6144
    v_mul_f32 v248, v244, v209
    v_mfma_f32_16x16x32_bf16 v[56:59], v[136:139], v[152:155], v[56:59]
    buffer_load_dwordx4 v1, s[4:7], s57 offen offset:384 lds
    v_fma_f32 v246, -v245, v209, v246
    v_mfma_f32_16x16x32_bf16 v[60:63], v[140:143], v[152:155], v[60:63]
    ds_read_b128 v[152:155], v5 offset:2048
    v_fmac_f32 v248, v245, v208
    v_mfma_f32_16x16x32_bf16 v[64:67], v[128:131], v[156:159], v[64:67]
    v_and_b32 v244, 0xffff0000, v228
    v_and_b32 v245, 0xffff0000, v232
    v_mfma_f32_16x16x32_bf16 v[68:71], v[132:135], v[156:159], v[68:71]
    v_subrev_u32 v3, 81920, v3
    v_mul_f32 v247, v244, v210
    v_mfma_f32_16x16x32_bf16 v[72:75], v[136:139], v[156:159], v[72:75]
    s_add_u32 m0, s59, 73344
    v_mul_f32 v249, v244, v211
    v_fma_f32 v247, -v245, v211, v247
    v_mfma_f32_16x16x32_bf16 v[76:79], v[140:143], v[156:159], v[76:79]
    ds_read_b128 v[156:159], v5 offset:14336
    buffer_load_dwordx4 v2, s[28:31], s76 offen offset:384 lds
    v_mfma_f32_16x16x32_bf16 v[80:83], v[128:131], v[160:163], v[80:83]
    v_fmac_f32 v249, v245, v210
    v_cvt_pk_bf16_f32 v236, v246, v247
    v_mfma_f32_16x16x32_bf16 v[84:87], v[132:135], v[160:163], v[84:87]
    v_cvt_pk_bf16_f32 v240, -v248, -v249
    v_lshlrev_b32 v244, 16, v229
    v_mfma_f32_16x16x32_bf16 v[88:91], v[136:139], v[160:163], v[88:91]
    s_add_u32 m0, s59, 65152
    v_lshlrev_b32 v245, 16, v233
    v_mul_f32 v246, v244, v212
    v_mfma_f32_16x16x32_bf16 v[92:95], v[140:143], v[160:163], v[92:95]
    ds_read_b128 v[160:163], v5 offset:4096
    buffer_load_dwordx4 v2, s[24:27], s57 offen offset:384 lds
    v_mfma_f32_16x16x32_bf16 v[96:99], v[128:131], v[164:167], v[96:99]
    v_mul_f32 v248, v244, v213
    v_fma_f32 v246, -v245, v213, v246
    v_mfma_f32_16x16x32_bf16 v[100:103], v[132:135], v[164:167], v[100:103]
    v_fmac_f32 v248, v245, v212
    v_and_b32 v244, 0xffff0000, v229
    v_mfma_f32_16x16x32_bf16 v[104:107], v[136:139], v[164:167], v[104:107]
    s_add_u32 m0, s59, 52864
    v_and_b32 v245, 0xffff0000, v233
    v_mul_f32 v247, v244, v214
    v_mfma_f32_16x16x32_bf16 v[108:111], v[140:143], v[164:167], v[108:111]
    s_waitcnt lgkmcnt(3)
    ds_read_b128 v[164:167], v5 offset:16384
    v_subrev_u32 v5, 81920, v5
    v_mfma_f32_16x16x32_bf16 v[16:19], v[112:115], v[144:147], v[16:19]
    buffer_load_dwordx4 v1, s[4:7], s58 offen offset:384 lds
    v_mul_f32 v249, v244, v215
    v_mfma_f32_16x16x32_bf16 v[20:23], v[116:119], v[144:147], v[20:23]
    v_fma_f32 v247, -v245, v215, v247
    v_fmac_f32 v249, v245, v214
    v_mfma_f32_16x16x32_bf16 v[24:27], v[120:123], v[144:147], v[24:27]
    v_cvt_pk_bf16_f32 v237, v246, v247
    v_cvt_pk_bf16_f32 v241, -v248, -v249
    v_mfma_f32_16x16x32_bf16 v[28:31], v[124:127], v[144:147], v[28:31]
    s_add_u32 m0, s59, 77440
    ds_read_b128 v[144:147], v6 offset:0
    v_lshlrev_b32 v244, 16, v230
    v_mfma_f32_16x16x32_bf16 v[32:35], v[112:115], v[148:151], v[32:35]
    ds_read_b128 v[128:131], v4 offset:0
    buffer_load_dwordx4 v2, s[28:31], s57 offen offset:384 lds
    v_mfma_f32_16x16x32_bf16 v[36:39], v[116:119], v[148:151], v[36:39]
    ds_read_b128 v[132:135], v4 offset:2048
    v_lshlrev_b32 v245, 16, v234
    v_mfma_f32_16x16x32_bf16 v[40:43], v[120:123], v[148:151], v[40:43]
    s_add_u32 m0, s59, 81408
    v_mul_f32 v246, v244, v216
    v_mul_f32 v248, v244, v217
    v_mfma_f32_16x16x32_bf16 v[44:47], v[124:127], v[148:151], v[44:47]
    s_waitcnt lgkmcnt(3)
    ds_read_b128 v[148:151], v6 offset:12288
    v_fma_f32 v246, -v245, v217, v246
    v_mfma_f32_16x16x32_bf16 v[48:51], v[112:115], v[152:155], v[48:51]
    ds_read_b128 v[136:139], v4 offset:4096
    buffer_load_dwordx4 v1, s[4:7], 0 offen offset:512 lds
    v_mfma_f32_16x16x32_bf16 v[52:55], v[116:119], v[152:155], v[52:55]
    ds_read_b128 v[140:143], v4 offset:6144
    v_fmac_f32 v248, v245, v216
    v_mfma_f32_16x16x32_bf16 v[56:59], v[120:123], v[152:155], v[56:59]
    v_and_b32 v244, 0xffff0000, v230
    v_and_b32 v245, 0xffff0000, v234
    v_mfma_f32_16x16x32_bf16 v[60:63], v[124:127], v[152:155], v[60:63]
    ds_read_b128 v[152:155], v6 offset:2048
    v_mul_f32 v247, v244, v218
    v_mfma_f32_16x16x32_bf16 v[64:67], v[112:115], v[156:159], v[64:67]
    s_add_u32 m0, s59, 97792
    v_mul_f32 v249, v244, v219
    v_fma_f32 v247, -v245, v219, v247
    v_mfma_f32_16x16x32_bf16 v[68:71], v[116:119], v[156:159], v[68:71]
    buffer_load_dwordx4 v2, s[24:27], 0 offen offset:512 lds
    v_subrev_u32 v4, 81920, v4
    v_mfma_f32_16x16x32_bf16 v[72:75], v[120:123], v[156:159], v[72:75]
    v_fmac_f32 v249, v245, v218
    v_cvt_pk_bf16_f32 v238, v246, v247
    v_mfma_f32_16x16x32_bf16 v[76:79], v[124:127], v[156:159], v[76:79]
    ds_read_b128 v[156:159], v6 offset:14336
    v_cvt_pk_bf16_f32 v242, -v248, -v249
    v_mfma_f32_16x16x32_bf16 v[80:83], v[112:115], v[160:163], v[80:83]
    s_add_u32 m0, s59, 110080
    v_lshlrev_b32 v244, 16, v231
    v_lshlrev_b32 v245, 16, v235
    v_mfma_f32_16x16x32_bf16 v[84:87], v[116:119], v[160:163], v[84:87]
    buffer_load_dwordx4 v2, s[28:31], 0 offen offset:512 lds
    v_mul_f32 v246, v244, v220
    v_mfma_f32_16x16x32_bf16 v[88:91], v[120:123], v[160:163], v[88:91]
    v_mul_f32 v248, v244, v221
    v_fma_f32 v246, -v245, v221, v246
    v_mfma_f32_16x16x32_bf16 v[92:95], v[124:127], v[160:163], v[92:95]
    ds_read_b128 v[160:163], v6 offset:4096
    v_fmac_f32 v248, v245, v220
    v_mfma_f32_16x16x32_bf16 v[96:99], v[112:115], v[164:167], v[96:99]
    s_add_u32 m0, s59, 85504
    v_and_b32 v244, 0xffff0000, v231
    v_and_b32 v245, 0xffff0000, v235
    v_mfma_f32_16x16x32_bf16 v[100:103], v[116:119], v[164:167], v[100:103]
    buffer_load_dwordx4 v1, s[4:7], s56 offen offset:512 lds
    v_mul_f32 v247, v244, v222
    v_mfma_f32_16x16x32_bf16 v[104:107], v[120:123], v[164:167], v[104:107]
    v_mul_f32 v249, v244, v223
    v_fma_f32 v247, -v245, v223, v247
    v_mfma_f32_16x16x32_bf16 v[108:111], v[124:127], v[164:167], v[108:111]
    s_waitcnt lgkmcnt(3)
    ds_read_b128 v[164:167], v6 offset:16384
    v_subrev_u32 v6, 81920, v6
    v_mfma_f32_16x16x32_bf16 v[16:19], v[128:131], v[144:147], v[16:19]
    v_fmac_f32 v249, v245, v222
    v_cvt_pk_bf16_f32 v239, v246, v247
    v_mfma_f32_16x16x32_bf16 v[20:23], v[132:135], v[144:147], v[20:23]
    s_add_u32 m0, s59, 101888
    v_cvt_pk_bf16_f32 v243, -v248, -v249
    v_mfma_f32_16x16x32_bf16 v[24:27], v[136:139], v[144:147], v[24:27]
    buffer_load_dwordx4 v2, s[24:27], s76 offen offset:512 lds
    v_mfma_f32_16x16x32_bf16 v[28:31], v[140:143], v[144:147], v[28:31]
    s_waitcnt vmcnt(5) lgkmcnt(0)
    s_barrier
    ds_read_b128 v[144:147], v5 offset:0
    v_mfma_f32_16x16x32_bf16 v[32:35], v[128:131], v[148:151], v[32:35]
    ds_read_b128 v[112:115], v3 offset:0
    v_mfma_f32_16x16x32_bf16 v[36:39], v[132:135], v[148:151], v[36:39]
    s_add_u32 m0, s59, 89600
    ds_read_b128 v[116:119], v3 offset:2048
    v_mfma_f32_16x16x32_bf16 v[40:43], v[136:139], v[148:151], v[40:43]
    buffer_load_dwordx4 v1, s[4:7], s57 offen offset:512 lds
    v_mfma_f32_16x16x32_bf16 v[44:47], v[140:143], v[148:151], v[44:47]
    ds_read_b128 v[148:151], v5 offset:12288
    v_mfma_f32_16x16x32_bf16 v[48:51], v[128:131], v[152:155], v[48:51]
    ds_read_b128 v[120:123], v3 offset:4096
    v_mfma_f32_16x16x32_bf16 v[52:55], v[132:135], v[152:155], v[52:55]
    s_add_u32 m0, s59, 114176
    ds_read_b128 v[124:127], v3 offset:6144
    v_mfma_f32_16x16x32_bf16 v[56:59], v[136:139], v[152:155], v[56:59]
    buffer_load_dwordx4 v2, s[28:31], s76 offen offset:512 lds
    v_mfma_f32_16x16x32_bf16 v[60:63], v[140:143], v[152:155], v[60:63]
    ds_read_b128 v[152:155], v5 offset:2048
    v_mfma_f32_16x16x32_bf16 v[64:67], v[128:131], v[156:159], v[64:67]
    buffer_store_dwordx4 v[236:239], v224, s[8:11], s72 offen offset:0 sc1
    v_mfma_f32_16x16x32_bf16 v[68:71], v[132:135], v[156:159], v[68:71]
    v_add_u32 v3, 40960, v3
    v_mfma_f32_16x16x32_bf16 v[72:75], v[136:139], v[156:159], v[72:75]
    s_add_u32 m0, s59, 105984
    buffer_store_dwordx4 v[240:243], v224, s[8:11], s72 offen offset:512 sc1
    v_mfma_f32_16x16x32_bf16 v[76:79], v[140:143], v[156:159], v[76:79]
    ds_read_b128 v[156:159], v5 offset:14336
    buffer_load_dwordx4 v2, s[24:27], s57 offen offset:512 lds
    v_mfma_f32_16x16x32_bf16 v[80:83], v[128:131], v[160:163], v[80:83]
    ds_read_b128 v[228:231], v207 offset:24576
    ds_read_b128 v[232:235], v207 offset:32768
    v_mfma_f32_16x16x32_bf16 v[84:87], v[132:135], v[160:163], v[84:87]
    s_waitcnt lgkmcnt(1)
    v_lshlrev_b32 v244, 16, v228
    s_waitcnt lgkmcnt(0)
    v_lshlrev_b32 v245, 16, v232
    v_mfma_f32_16x16x32_bf16 v[88:91], v[136:139], v[160:163], v[88:91]
    s_add_u32 m0, s59, 93696
    v_mul_f32 v246, v244, v208
    v_mul_f32 v248, v244, v209
    v_mfma_f32_16x16x32_bf16 v[92:95], v[140:143], v[160:163], v[92:95]
    ds_read_b128 v[160:163], v5 offset:4096
    buffer_load_dwordx4 v1, s[4:7], s58 offen offset:512 lds
    v_mfma_f32_16x16x32_bf16 v[96:99], v[128:131], v[164:167], v[96:99]
    v_fma_f32 v246, -v245, v209, v246
    v_fmac_f32 v248, v245, v208
    v_mfma_f32_16x16x32_bf16 v[100:103], v[132:135], v[164:167], v[100:103]
    v_and_b32 v244, 0xffff0000, v228
    v_and_b32 v245, 0xffff0000, v232
    v_mfma_f32_16x16x32_bf16 v[104:107], v[136:139], v[164:167], v[104:107]
    s_add_u32 m0, s59, 118272
    v_mul_f32 v247, v244, v210
    v_mul_f32 v249, v244, v211
    v_mfma_f32_16x16x32_bf16 v[108:111], v[140:143], v[164:167], v[108:111]
    ds_read_b128 v[164:167], v5 offset:16384
    v_add_u32 v5, 40960, v5
    v_mfma_f32_16x16x32_bf16 v[16:19], v[112:115], v[144:147], v[16:19]
    buffer_load_dwordx4 v2, s[28:31], s57 offen offset:512 lds
    v_fma_f32 v247, -v245, v211, v247
    v_mfma_f32_16x16x32_bf16 v[20:23], v[116:119], v[144:147], v[20:23]
    v_fmac_f32 v249, v245, v210
    v_cvt_pk_bf16_f32 v236, v246, v247
    v_mfma_f32_16x16x32_bf16 v[24:27], v[120:123], v[144:147], v[24:27]
    v_cvt_pk_bf16_f32 v240, -v248, -v249
    v_lshlrev_b32 v244, 16, v229
    v_mfma_f32_16x16x32_bf16 v[28:31], v[124:127], v[144:147], v[28:31]
    s_add_u32 m0, s59, 122240
    ds_read_b128 v[144:147], v6 offset:0
    v_lshlrev_b32 v245, 16, v233
    v_mfma_f32_16x16x32_bf16 v[32:35], v[112:115], v[148:151], v[32:35]
    ds_read_b128 v[128:131], v4 offset:0
    buffer_load_dwordx4 v1, s[4:7], 0 offen offset:640 lds
    v_mfma_f32_16x16x32_bf16 v[36:39], v[116:119], v[148:151], v[36:39]
    ds_read_b128 v[132:135], v4 offset:2048
    v_mul_f32 v246, v244, v212
    v_mfma_f32_16x16x32_bf16 v[40:43], v[120:123], v[148:151], v[40:43]
    s_add_u32 m0, s59, 138624
    v_mul_f32 v248, v244, v213
    v_fma_f32 v246, -v245, v213, v246
    v_mfma_f32_16x16x32_bf16 v[44:47], v[124:127], v[148:151], v[44:47]
    s_waitcnt lgkmcnt(3)
    ds_read_b128 v[148:151], v6 offset:12288
    v_fmac_f32 v248, v245, v212
    v_mfma_f32_16x16x32_bf16 v[48:51], v[112:115], v[152:155], v[48:51]
    ds_read_b128 v[136:139], v4 offset:4096
    buffer_load_dwordx4 v2, s[24:27], 0 offen offset:640 lds
    v_mfma_f32_16x16x32_bf16 v[52:55], v[116:119], v[152:155], v[52:55]
    ds_read_b128 v[140:143], v4 offset:6144
    v_and_b32 v244, 0xffff0000, v229
    v_mfma_f32_16x16x32_bf16 v[56:59], v[120:123], v[152:155], v[56:59]
    v_and_b32 v245, 0xffff0000, v233
    v_mul_f32 v247, v244, v214
    v_mfma_f32_16x16x32_bf16 v[60:63], v[124:127], v[152:155], v[60:63]
    ds_read_b128 v[152:155], v6 offset:2048
    v_mul_f32 v249, v244, v215
    v_mfma_f32_16x16x32_bf16 v[64:67], v[112:115], v[156:159], v[64:67]
    s_add_u32 m0, s59, 150912
    v_fma_f32 v247, -v245, v215, v247
    v_fmac_f32 v249, v245, v214
    v_mfma_f32_16x16x32_bf16 v[68:71], v[116:119], v[156:159], v[68:71]
    buffer_load_dwordx4 v2, s[28:31], 0 offen offset:640 lds
    v_add_u32 v4, 40960, v4
    v_mfma_f32_16x16x32_bf16 v[72:75], v[120:123], v[156:159], v[72:75]
    v_cvt_pk_bf16_f32 v237, v246, v247
    v_cvt_pk_bf16_f32 v241, -v248, -v249
    v_mfma_f32_16x16x32_bf16 v[76:79], v[124:127], v[156:159], v[76:79]
    ds_read_b128 v[156:159], v6 offset:14336
    v_lshlrev_b32 v244, 16, v230
    v_mfma_f32_16x16x32_bf16 v[80:83], v[112:115], v[160:163], v[80:83]
    s_add_u32 m0, s59, 126336
    v_lshlrev_b32 v245, 16, v234
    v_mul_f32 v246, v244, v216
    v_mfma_f32_16x16x32_bf16 v[84:87], v[116:119], v[160:163], v[84:87]
    buffer_load_dwordx4 v1, s[4:7], s56 offen offset:640 lds
    v_mul_f32 v248, v244, v217
    v_mfma_f32_16x16x32_bf16 v[88:91], v[120:123], v[160:163], v[88:91]
    v_fma_f32 v246, -v245, v217, v246
    v_fmac_f32 v248, v245, v216
    v_mfma_f32_16x16x32_bf16 v[92:95], v[124:127], v[160:163], v[92:95]
    ds_read_b128 v[160:163], v6 offset:4096
    v_and_b32 v244, 0xffff0000, v230
    v_mfma_f32_16x16x32_bf16 v[96:99], v[112:115], v[164:167], v[96:99]
    s_add_u32 m0, s59, 142720
    v_and_b32 v245, 0xffff0000, v234
    v_mul_f32 v247, v244, v218
    v_mfma_f32_16x16x32_bf16 v[100:103], v[116:119], v[164:167], v[100:103]
    buffer_load_dwordx4 v2, s[24:27], s76 offen offset:640 lds
    v_mul_f32 v249, v244, v219
    v_mfma_f32_16x16x32_bf16 v[104:107], v[120:123], v[164:167], v[104:107]
    v_fma_f32 v247, -v245, v219, v247
    v_fmac_f32 v249, v245, v218
    v_mfma_f32_16x16x32_bf16 v[108:111], v[124:127], v[164:167], v[108:111]
    s_waitcnt lgkmcnt(3)
    ds_read_b128 v[164:167], v6 offset:16384
    v_add_u32 v6, 40960, v6
    v_mfma_f32_16x16x32_bf16 v[16:19], v[128:131], v[144:147], v[16:19]
    v_cvt_pk_bf16_f32 v238, v246, v247
    v_cvt_pk_bf16_f32 v242, -v248, -v249
    v_mfma_f32_16x16x32_bf16 v[20:23], v[132:135], v[144:147], v[20:23]
    s_add_u32 m0, s59, 130432
    v_lshlrev_b32 v244, 16, v231
    v_lshlrev_b32 v245, 16, v235
    v_mfma_f32_16x16x32_bf16 v[24:27], v[136:139], v[144:147], v[24:27]
    buffer_load_dwordx4 v1, s[4:7], s57 offen offset:640 lds
    v_mul_f32 v246, v244, v220
    v_mfma_f32_16x16x32_bf16 v[28:31], v[140:143], v[144:147], v[28:31]
    s_waitcnt vmcnt(6) lgkmcnt(0)
    s_barrier
    ds_read_b128 v[144:147], v5 offset:0
    v_mfma_f32_16x16x32_bf16 v[32:35], v[128:131], v[148:151], v[32:35]
    ds_read_b128 v[112:115], v3 offset:0
    v_mul_f32 v248, v244, v221
    v_mfma_f32_16x16x32_bf16 v[36:39], v[132:135], v[148:151], v[36:39]
    s_add_u32 m0, s59, 155008
    ds_read_b128 v[116:119], v3 offset:2048
    v_fma_f32 v246, -v245, v221, v246
    v_mfma_f32_16x16x32_bf16 v[40:43], v[136:139], v[148:151], v[40:43]
    buffer_load_dwordx4 v2, s[28:31], s76 offen offset:640 lds
    v_fmac_f32 v248, v245, v220
    v_mfma_f32_16x16x32_bf16 v[44:47], v[140:143], v[148:151], v[44:47]
    ds_read_b128 v[148:151], v5 offset:12288
    v_and_b32 v244, 0xffff0000, v231
    v_mfma_f32_16x16x32_bf16 v[48:51], v[128:131], v[152:155], v[48:51]
    ds_read_b128 v[120:123], v3 offset:4096
    v_and_b32 v245, 0xffff0000, v235
    v_mfma_f32_16x16x32_bf16 v[52:55], v[132:135], v[152:155], v[52:55]
    s_add_u32 m0, s59, 146816
    ds_read_b128 v[124:127], v3 offset:6144
    v_mul_f32 v247, v244, v222
    v_mfma_f32_16x16x32_bf16 v[56:59], v[136:139], v[152:155], v[56:59]
    buffer_load_dwordx4 v2, s[24:27], s57 offen offset:640 lds
    v_mul_f32 v249, v244, v223
    v_mfma_f32_16x16x32_bf16 v[60:63], v[140:143], v[152:155], v[60:63]
    ds_read_b128 v[152:155], v5 offset:2048
    v_fma_f32 v247, -v245, v223, v247
    v_mfma_f32_16x16x32_bf16 v[64:67], v[128:131], v[156:159], v[64:67]
    v_fmac_f32 v249, v245, v222
    v_cvt_pk_bf16_f32 v239, v246, v247
    v_mfma_f32_16x16x32_bf16 v[68:71], v[132:135], v[156:159], v[68:71]
    v_add_u32 v3, 40960, v3
    v_cvt_pk_bf16_f32 v243, -v248, -v249
    v_mfma_f32_16x16x32_bf16 v[72:75], v[136:139], v[156:159], v[72:75]
    s_add_u32 m0, s59, 134528
    buffer_store_dwordx4 v[236:239], v225, s[8:11], s72 offen offset:0 sc1
    v_mfma_f32_16x16x32_bf16 v[76:79], v[140:143], v[156:159], v[76:79]
    ds_read_b128 v[156:159], v5 offset:14336
    buffer_load_dwordx4 v1, s[4:7], s58 offen offset:640 lds
    v_mfma_f32_16x16x32_bf16 v[80:83], v[128:131], v[160:163], v[80:83]
    buffer_store_dwordx4 v[240:243], v225, s[8:11], s72 offen offset:512 sc1
    v_mfma_f32_16x16x32_bf16 v[84:87], v[132:135], v[160:163], v[84:87]
    v_lshlrev_b32 v223, 3, v0
    v_mfma_f32_16x16x32_bf16 v[88:91], v[136:139], v[160:163], v[88:91]
    s_add_u32 m0, s59, 159104
    v_lshlrev_b32 v224, 4, v7
    v_mfma_f32_16x16x32_bf16 v[92:95], v[140:143], v[160:163], v[92:95]
    ds_read_b128 v[160:163], v5 offset:4096
    buffer_load_dwordx4 v2, s[28:31], s57 offen offset:640 lds
    v_mfma_f32_16x16x32_bf16 v[96:99], v[128:131], v[164:167], v[96:99]
    v_add_u32 v225, s75, v224
    v_mfma_f32_16x16x32_bf16 v[100:103], v[132:135], v[164:167], v[100:103]
    s_cmp_eq_u32 s75, 0
    s_cselect_b32 s70, s55, 0
    v_mov_b32 v222, s70
    v_mfma_f32_16x16x32_bf16 v[104:107], v[136:139], v[164:167], v[104:107]
    s_add_u32 m0, s59, 40192
    v_mfma_f32_16x16x32_bf16 v[108:111], v[140:143], v[164:167], v[108:111]
    s_waitcnt lgkmcnt(3)
    ds_read_b128 v[164:167], v5 offset:16384
    v_add_u32 v5, 40960, v5
    v_mfma_f32_16x16x32_bf16 v[16:19], v[112:115], v[144:147], v[16:19]
    buffer_load_dwordx4 v1, s[4:7], 0 offen offset:768 lds
    v_mfma_f32_16x16x32_bf16 v[20:23], v[116:119], v[144:147], v[20:23]
    buffer_load_dwordx2 v[220:221], v223, s[8:11], s73 offen sc1
    v_mfma_f32_16x16x32_bf16 v[24:27], v[120:123], v[144:147], v[24:27]
    v_mfma_f32_16x16x32_bf16 v[28:31], v[124:127], v[144:147], v[28:31]
    s_add_u32 m0, s59, 56576
    ds_read_b128 v[144:147], v6 offset:0
    v_mfma_f32_16x16x32_bf16 v[32:35], v[112:115], v[148:151], v[32:35]
    ds_read_b128 v[128:131], v4 offset:0
    buffer_load_dwordx4 v2, s[24:27], 0 offen offset:768 lds
    v_mfma_f32_16x16x32_bf16 v[36:39], v[116:119], v[148:151], v[36:39]
    ds_read_b128 v[132:135], v4 offset:2048
    v_mfma_f32_16x16x32_bf16 v[40:43], v[120:123], v[148:151], v[40:43]
    s_add_u32 m0, s59, 68864
    v_mfma_f32_16x16x32_bf16 v[44:47], v[124:127], v[148:151], v[44:47]
    s_waitcnt lgkmcnt(3)
    ds_read_b128 v[148:151], v6 offset:12288
    v_mfma_f32_16x16x32_bf16 v[48:51], v[112:115], v[152:155], v[48:51]
    ds_read_b128 v[136:139], v4 offset:4096
    buffer_load_dwordx4 v2, s[28:31], 0 offen offset:768 lds
    v_mfma_f32_16x16x32_bf16 v[52:55], v[116:119], v[152:155], v[52:55]
    ds_read_b128 v[140:143], v4 offset:6144
    v_mfma_f32_16x16x32_bf16 v[56:59], v[120:123], v[152:155], v[56:59]
    buffer_load_dwordx4 v[208:211], v224, s[8:11], s74 offen offset:0 sc1
    v_mfma_f32_16x16x32_bf16 v[60:63], v[124:127], v[152:155], v[60:63]
    ds_read_b128 v[152:155], v6 offset:2048
    v_mfma_f32_16x16x32_bf16 v[64:67], v[112:115], v[156:159], v[64:67]
    s_add_u32 m0, s59, 44288
    v_mfma_f32_16x16x32_bf16 v[68:71], v[116:119], v[156:159], v[68:71]
    buffer_load_dwordx4 v1, s[4:7], s56 offen offset:768 lds
    v_add_u32 v4, 40960, v4
    v_mfma_f32_16x16x32_bf16 v[72:75], v[120:123], v[156:159], v[72:75]
    v_mfma_f32_16x16x32_bf16 v[76:79], v[124:127], v[156:159], v[76:79]
    ds_read_b128 v[156:159], v6 offset:14336
    v_mfma_f32_16x16x32_bf16 v[80:83], v[112:115], v[160:163], v[80:83]
    s_add_u32 m0, s59, 60672
    v_mfma_f32_16x16x32_bf16 v[84:87], v[116:119], v[160:163], v[84:87]
    buffer_load_dwordx4 v2, s[24:27], s76 offen offset:768 lds
    v_mfma_f32_16x16x32_bf16 v[88:91], v[120:123], v[160:163], v[88:91]
    buffer_load_dwordx4 v[212:215], v225, s[8:11], s74 offen offset:256 sc1
    v_mfma_f32_16x16x32_bf16 v[92:95], v[124:127], v[160:163], v[92:95]
    ds_read_b128 v[160:163], v6 offset:4096
    v_mfma_f32_16x16x32_bf16 v[96:99], v[112:115], v[164:167], v[96:99]
    s_add_u32 m0, s59, 48384
    v_mfma_f32_16x16x32_bf16 v[100:103], v[116:119], v[164:167], v[100:103]
    buffer_load_dwordx4 v1, s[4:7], s57 offen offset:768 lds
    v_mfma_f32_16x16x32_bf16 v[104:107], v[120:123], v[164:167], v[104:107]
    v_mfma_f32_16x16x32_bf16 v[108:111], v[124:127], v[164:167], v[108:111]
    s_waitcnt lgkmcnt(3)
    ds_read_b128 v[164:167], v6 offset:16384
    v_add_u32 v6, 40960, v6
    v_mfma_f32_16x16x32_bf16 v[16:19], v[128:131], v[144:147], v[16:19]
    v_mfma_f32_16x16x32_bf16 v[20:23], v[132:135], v[144:147], v[20:23]
    s_add_u32 m0, s59, 72960
    v_mfma_f32_16x16x32_bf16 v[24:27], v[136:139], v[144:147], v[24:27]
    buffer_load_dwordx4 v2, s[28:31], s76 offen offset:768 lds
    v_mfma_f32_16x16x32_bf16 v[28:31], v[140:143], v[144:147], v[28:31]
    s_waitcnt vmcnt(10) lgkmcnt(0)
    s_barrier
    ds_read_b128 v[144:147], v5 offset:0
    v_mfma_f32_16x16x32_bf16 v[32:35], v[128:131], v[148:151], v[32:35]
    ds_read_b128 v[112:115], v3 offset:0
    v_mfma_f32_16x16x32_bf16 v[36:39], v[132:135], v[148:151], v[36:39]
    s_add_u32 m0, s59, 64768
    ds_read_b128 v[116:119], v3 offset:2048
    v_mfma_f32_16x16x32_bf16 v[40:43], v[136:139], v[148:151], v[40:43]
    buffer_load_dwordx4 v2, s[24:27], s57 offen offset:768 lds
    v_mfma_f32_16x16x32_bf16 v[44:47], v[140:143], v[148:151], v[44:47]
    ds_read_b128 v[148:151], v5 offset:12288
    v_mfma_f32_16x16x32_bf16 v[48:51], v[128:131], v[152:155], v[48:51]
    ds_read_b128 v[120:123], v3 offset:4096
    v_mfma_f32_16x16x32_bf16 v[52:55], v[132:135], v[152:155], v[52:55]
    s_add_u32 m0, s59, 52480
    ds_read_b128 v[124:127], v3 offset:6144
    v_mfma_f32_16x16x32_bf16 v[56:59], v[136:139], v[152:155], v[56:59]
    buffer_load_dwordx4 v1, s[4:7], s58 offen offset:768 lds
    v_mfma_f32_16x16x32_bf16 v[60:63], v[140:143], v[152:155], v[60:63]
    ds_read_b128 v[152:155], v5 offset:2048
    v_mfma_f32_16x16x32_bf16 v[64:67], v[128:131], v[156:159], v[64:67]
    buffer_load_dwordx4 v[216:219], v225, s[8:11], s74 offen offset:512 sc1
    v_mfma_f32_16x16x32_bf16 v[68:71], v[132:135], v[156:159], v[68:71]
    v_subrev_u32 v3, 81920, v3
    v_mfma_f32_16x16x32_bf16 v[72:75], v[136:139], v[156:159], v[72:75]
    s_add_u32 m0, s59, 77056
    v_mfma_f32_16x16x32_bf16 v[76:79], v[140:143], v[156:159], v[76:79]
    ds_read_b128 v[156:159], v5 offset:14336
    buffer_load_dwordx4 v2, s[28:31], s57 offen offset:768 lds
    v_mfma_f32_16x16x32_bf16 v[80:83], v[128:131], v[160:163], v[80:83]
    v_mfma_f32_16x16x32_bf16 v[84:87], v[132:135], v[160:163], v[84:87]
    v_mfma_f32_16x16x32_bf16 v[88:91], v[136:139], v[160:163], v[88:91]
    s_add_u32 m0, s59, 81024
    v_mfma_f32_16x16x32_bf16 v[92:95], v[140:143], v[160:163], v[92:95]
    ds_read_b128 v[160:163], v5 offset:4096
    buffer_load_dwordx4 v1, s[4:7], 0 offen offset:896 lds
    v_mfma_f32_16x16x32_bf16 v[96:99], v[128:131], v[164:167], v[96:99]
    v_mfma_f32_16x16x32_bf16 v[100:103], v[132:135], v[164:167], v[100:103]
    v_mfma_f32_16x16x32_bf16 v[104:107], v[136:139], v[164:167], v[104:107]
    s_add_u32 m0, s59, 97408
    v_mfma_f32_16x16x32_bf16 v[108:111], v[140:143], v[164:167], v[108:111]
    s_waitcnt lgkmcnt(3)
    ds_read_b128 v[164:167], v5 offset:16384
    v_subrev_u32 v5, 81920, v5
    v_mfma_f32_16x16x32_bf16 v[16:19], v[112:115], v[144:147], v[16:19]
    buffer_load_dwordx4 v2, s[24:27], 0 offen offset:896 lds
    v_mfma_f32_16x16x32_bf16 v[20:23], v[116:119], v[144:147], v[20:23]
    v_mfma_f32_16x16x32_bf16 v[24:27], v[120:123], v[144:147], v[24:27]
    v_mfma_f32_16x16x32_bf16 v[28:31], v[124:127], v[144:147], v[28:31]
    s_add_u32 m0, s59, 109696
    ds_read_b128 v[144:147], v6 offset:0
    v_mfma_f32_16x16x32_bf16 v[32:35], v[112:115], v[148:151], v[32:35]
    ds_read_b128 v[128:131], v4 offset:0
    buffer_load_dwordx4 v2, s[28:31], 0 offen offset:896 lds
    v_mfma_f32_16x16x32_bf16 v[36:39], v[116:119], v[148:151], v[36:39]
    ds_read_b128 v[132:135], v4 offset:2048
    v_mfma_f32_16x16x32_bf16 v[40:43], v[120:123], v[148:151], v[40:43]
    s_add_u32 m0, s59, 85120
    v_mfma_f32_16x16x32_bf16 v[44:47], v[124:127], v[148:151], v[44:47]
    s_waitcnt lgkmcnt(3)
    ds_read_b128 v[148:151], v6 offset:12288
    v_mfma_f32_16x16x32_bf16 v[48:51], v[112:115], v[152:155], v[48:51]
    ds_read_b128 v[136:139], v4 offset:4096
    buffer_load_dwordx4 v1, s[4:7], s56 offen offset:896 lds
    v_mfma_f32_16x16x32_bf16 v[52:55], v[116:119], v[152:155], v[52:55]
    ds_read_b128 v[140:143], v4 offset:6144
    v_mfma_f32_16x16x32_bf16 v[56:59], v[120:123], v[152:155], v[56:59]
    v_mfma_f32_16x16x32_bf16 v[60:63], v[124:127], v[152:155], v[60:63]
    ds_read_b128 v[152:155], v6 offset:2048
    v_mfma_f32_16x16x32_bf16 v[64:67], v[112:115], v[156:159], v[64:67]
    s_add_u32 m0, s59, 101504
    v_mfma_f32_16x16x32_bf16 v[68:71], v[116:119], v[156:159], v[68:71]
    buffer_load_dwordx4 v2, s[24:27], s76 offen offset:896 lds
    v_subrev_u32 v4, 81920, v4
    v_mfma_f32_16x16x32_bf16 v[72:75], v[120:123], v[156:159], v[72:75]
    v_mfma_f32_16x16x32_bf16 v[76:79], v[124:127], v[156:159], v[76:79]
    ds_read_b128 v[156:159], v6 offset:14336
    v_mfma_f32_16x16x32_bf16 v[80:83], v[112:115], v[160:163], v[80:83]
    s_add_u32 m0, s59, 89216
    v_mfma_f32_16x16x32_bf16 v[84:87], v[116:119], v[160:163], v[84:87]
    buffer_load_dwordx4 v1, s[4:7], s57 offen offset:896 lds
    v_mfma_f32_16x16x32_bf16 v[88:91], v[120:123], v[160:163], v[88:91]
    v_mfma_f32_16x16x32_bf16 v[92:95], v[124:127], v[160:163], v[92:95]
    ds_read_b128 v[160:163], v6 offset:4096
    v_mfma_f32_16x16x32_bf16 v[96:99], v[112:115], v[164:167], v[96:99]
    s_add_u32 m0, s59, 113792
    v_mfma_f32_16x16x32_bf16 v[100:103], v[116:119], v[164:167], v[100:103]
    buffer_load_dwordx4 v2, s[28:31], s76 offen offset:896 lds
    v_mfma_f32_16x16x32_bf16 v[104:107], v[120:123], v[164:167], v[104:107]
    v_mfma_f32_16x16x32_bf16 v[108:111], v[124:127], v[164:167], v[108:111]
    s_waitcnt lgkmcnt(3)
    ds_read_b128 v[164:167], v6 offset:16384
    v_subrev_u32 v6, 81920, v6
    v_mfma_f32_16x16x32_bf16 v[16:19], v[128:131], v[144:147], v[16:19]
    v_mfma_f32_16x16x32_bf16 v[20:23], v[132:135], v[144:147], v[20:23]
    s_add_u32 m0, s59, 105600
    v_mfma_f32_16x16x32_bf16 v[24:27], v[136:139], v[144:147], v[24:27]
    buffer_load_dwordx4 v2, s[24:27], s57 offen offset:896 lds
    v_mfma_f32_16x16x32_bf16 v[28:31], v[140:143], v[144:147], v[28:31]
    s_waitcnt vmcnt(8) lgkmcnt(0)
    s_barrier
    ds_read_b128 v[144:147], v5 offset:0
    v_lshlrev_b32 v231, 12, v0
    v_mfma_f32_16x16x32_bf16 v[32:35], v[128:131], v[148:151], v[32:35]
    ds_read_b128 v[112:115], v3 offset:0
    s_cmp_eq_u32 s52, 0
    s_cselect_b32 s51, s51, 1073741824
    v_mfma_f32_16x16x32_bf16 v[36:39], v[132:135], v[148:151], v[36:39]
    s_add_u32 m0, s59, 93312
    ds_read_b128 v[116:119], v3 offset:2048
    v_mfma_f32_16x16x32_bf16 v[40:43], v[136:139], v[148:151], v[40:43]
    buffer_load_dwordx4 v1, s[4:7], s58 offen offset:896 lds
    v_mfma_f32_16x16x32_bf16 v[44:47], v[140:143], v[148:151], v[44:47]
    ds_read_b128 v[148:151], v5 offset:12288
    v_mfma_f32_16x16x32_bf16 v[48:51], v[128:131], v[152:155], v[48:51]
    ds_read_b128 v[120:123], v3 offset:4096
    v_mfma_f32_16x16x32_bf16 v[52:55], v[132:135], v[152:155], v[52:55]
    s_add_u32 m0, s59, 117888
    ds_read_b128 v[124:127], v3 offset:6144
    v_mfma_f32_16x16x32_bf16 v[56:59], v[136:139], v[152:155], v[56:59]
    buffer_load_dwordx4 v2, s[28:31], s57 offen offset:896 lds
    v_mfma_f32_16x16x32_bf16 v[60:63], v[140:143], v[152:155], v[60:63]
    ds_read_b128 v[152:155], v5 offset:2048
    v_mfma_f32_16x16x32_bf16 v[64:67], v[128:131], v[156:159], v[64:67]
    s_mov_b64 exec, 0xffff
    buffer_store_dword v13, v231, s[8:11], s51 offen sc1
    s_mov_b64 exec, -1
    v_mfma_f32_16x16x32_bf16 v[68:71], v[132:135], v[156:159], v[68:71]
    v_add_u32 v3, 40960, v3
    v_mfma_f32_16x16x32_bf16 v[72:75], v[136:139], v[156:159], v[72:75]
    s_add_u32 m0, s59, 121856
    v_mfma_f32_16x16x32_bf16 v[76:79], v[140:143], v[156:159], v[76:79]
    ds_read_b128 v[156:159], v5 offset:14336
    buffer_load_dwordx4 v1, s[4:7], 0 offen offset:1024 lds
    v_mfma_f32_16x16x32_bf16 v[80:83], v[128:131], v[160:163], v[80:83]
    v_xor_b32 v12, v13, v221
    v_mfma_f32_16x16x32_bf16 v[84:87], v[132:135], v[160:163], v[84:87]
    v_bitop3_b32 v12, v12, v209, v13 bitop3:0xf6
    v_mfma_f32_16x16x32_bf16 v[88:91], v[136:139], v[160:163], v[88:91]
    s_add_u32 m0, s59, 138240
    v_bitop3_b32 v12, v12, v211, v13 bitop3:0xf6
    v_mfma_f32_16x16x32_bf16 v[92:95], v[140:143], v[160:163], v[92:95]
    ds_read_b128 v[160:163], v5 offset:4096
    buffer_load_dwordx4 v2, s[24:27], 0 offen offset:1024 lds
    v_mfma_f32_16x16x32_bf16 v[96:99], v[128:131], v[164:167], v[96:99]
    v_bitop3_b32 v12, v12, v213, v222 bitop3:0xf6
    v_mfma_f32_16x16x32_bf16 v[100:103], v[132:135], v[164:167], v[100:103]
    v_bitop3_b32 v12, v12, v215, v222 bitop3:0xf6
    v_mfma_f32_16x16x32_bf16 v[104:107], v[136:139], v[164:167], v[104:107]
    s_add_u32 m0, s59, 150528
    v_bitop3_b32 v12, v12, v217, v222 bitop3:0xf6
    v_mfma_f32_16x16x32_bf16 v[108:111], v[140:143], v[164:167], v[108:111]
    s_waitcnt lgkmcnt(3)
    ds_read_b128 v[164:167], v5 offset:16384
    v_add_u32 v5, 40960, v5
    v_mfma_f32_16x16x32_bf16 v[16:19], v[112:115], v[144:147], v[16:19]
    buffer_load_dwordx4 v2, s[28:31], 0 offen offset:1024 lds
    v_mfma_f32_16x16x32_bf16 v[20:23], v[116:119], v[144:147], v[20:23]
    v_bitop3_b32 v12, v12, v219, v222 bitop3:0xf6
    v_mfma_f32_16x16x32_bf16 v[24:27], v[120:123], v[144:147], v[24:27]
    v_cmp_ne_u32 vcc, 0, v12
    s_nop 3
    s_cbranch_vccnz L_spin_ext5
L_ret_ext5:
    v_mfma_f32_16x16x32_bf16 v[28:31], v[124:127], v[144:147], v[28:31]
    s_add_u32 m0, s59, 125952
    ds_read_b128 v[144:147], v6 offset:0
    v_mfma_f32_16x16x32_bf16 v[32:35], v[112:115], v[148:151], v[32:35]
    ds_read_b128 v[128:131], v4 offset:0
    buffer_load_dwordx4 v1, s[4:7], s56 offen offset:1024 lds
    v_mfma_f32_16x16x32_bf16 v[36:39], v[116:119], v[148:151], v[36:39]
    ds_read_b128 v[132:135], v4 offset:2048
    v_mfma_f32_16x16x32_bf16 v[40:43], v[120:123], v[148:151], v[40:43]
    s_add_u32 m0, s59, 142336
    v_and_b32 v221, 0xffff0000, v220
    v_mfma_f32_16x16x32_bf16 v[44:47], v[124:127], v[148:151], v[44:47]
    s_waitcnt lgkmcnt(3)
    ds_read_b128 v[148:151], v6 offset:12288
    v_mfma_f32_16x16x32_bf16 v[48:51], v[112:115], v[152:155], v[48:51]
    ds_read_b128 v[136:139], v4 offset:4096
    buffer_load_dwordx4 v2, s[24:27], s76 offen offset:1024 lds
    v_mfma_f32_16x16x32_bf16 v[52:55], v[116:119], v[152:155], v[52:55]
    ds_read_b128 v[140:143], v4 offset:6144
    v_mfma_f32_16x16x32_bf16 v[56:59], v[120:123], v[152:155], v[56:59]
    v_rcp_f32 v221, v221
    v_mfma_f32_16x16x32_bf16 v[60:63], v[124:127], v[152:155], v[60:63]
    ds_read_b128 v[152:155], v6 offset:2048
    v_mfma_f32_16x16x32_bf16 v[64:67], v[112:115], v[156:159], v[64:67]
    s_add_u32 m0, s59, 130048
    v_lshlrev_b32 v220, 16, v220
    v_mfma_f32_16x16x32_bf16 v[68:71], v[116:119], v[156:159], v[68:71]
    buffer_load_dwordx4 v1, s[4:7], s57 offen offset:1024 lds
    v_add_u32 v4, 40960, v4
    v_mfma_f32_16x16x32_bf16 v[72:75], v[120:123], v[156:159], v[72:75]
    v_and_b32 v12, 7, v0
    v_mfma_f32_16x16x32_bf16 v[76:79], v[124:127], v[156:159], v[76:79]
    ds_read_b128 v[156:159], v6 offset:14336
    v_mfma_f32_16x16x32_bf16 v[80:83], v[112:115], v[160:163], v[80:83]
    s_add_u32 m0, s59, 154624
    v_bfe_u32 v11, v0, 3, 1
    v_mfma_f32_16x16x32_bf16 v[84:87], v[116:119], v[160:163], v[84:87]
    buffer_load_dwordx4 v2, s[28:31], s76 offen offset:1024 lds
    v_mfma_f32_16x16x32_bf16 v[88:91], v[120:123], v[160:163], v[88:91]
    v_lshl_add_u32 v11, v12, 1, v11
    v_mfma_f32_16x16x32_bf16 v[92:95], v[124:127], v[160:163], v[92:95]
    ds_read_b128 v[160:163], v6 offset:4096
    v_mfma_f32_16x16x32_bf16 v[96:99], v[112:115], v[164:167], v[96:99]
    s_add_u32 m0, s59, 146432
    v_lshl_add_u32 v11, v8, 4, v11
    v_mfma_f32_16x16x32_bf16 v[100:103], v[116:119], v[164:167], v[100:103]
    s_lshl_b32 s64, s52, 9
    buffer_load_dwordx4 v2, s[24:27], s57 offen offset:1024 lds
    v_mfma_f32_16x16x32_bf16 v[104:107], v[120:123], v[164:167], v[104:107]
    s_add_u32 s64, s64, 37376
    v_lshl_add_u32 v11, v11, 2, s64
    v_mfma_f32_16x16x32_bf16 v[108:111], v[124:127], v[164:167], v[108:111]
    s_waitcnt lgkmcnt(3)
    ds_read_b128 v[164:167], v6 offset:16384
    v_add_u32 v6, 40960, v6
    v_mfma_f32_16x16x32_bf16 v[16:19], v[128:131], v[144:147], v[16:19]
    ds_write_b32 v11, v220
    v_mfma_f32_16x16x32_bf16 v[20:23], v[132:135], v[144:147], v[20:23]
    s_add_u32 m0, s59, 134144
    ds_write_b32 v11, v221 offset:256
    v_mfma_f32_16x16x32_bf16 v[24:27], v[136:139], v[144:147], v[24:27]
    buffer_load_dwordx4 v1, s[4:7], s58 offen offset:1024 lds
    v_mfma_f32_16x16x32_bf16 v[28:31], v[140:143], v[144:147], v[28:31]
    s_waitcnt vmcnt(10) lgkmcnt(0)
    s_barrier
    ds_read_b128 v[144:147], v5 offset:0
    v_mfma_f32_16x16x32_bf16 v[32:35], v[128:131], v[148:151], v[32:35]
    ds_read_b128 v[112:115], v3 offset:0
    v_mfma_f32_16x16x32_bf16 v[36:39], v[132:135], v[148:151], v[36:39]
    s_add_u32 m0, s59, 158720
    ds_read_b128 v[116:119], v3 offset:2048
    v_mfma_f32_16x16x32_bf16 v[40:43], v[136:139], v[148:151], v[40:43]
    buffer_load_dwordx4 v2, s[28:31], s57 offen offset:1024 lds
    v_mfma_f32_16x16x32_bf16 v[44:47], v[140:143], v[148:151], v[44:47]
    ds_read_b128 v[148:151], v5 offset:12288
    v_mfma_f32_16x16x32_bf16 v[48:51], v[128:131], v[152:155], v[48:51]
    ds_read_b128 v[120:123], v3 offset:4096
    v_and_b32 v226, 7, v0
    v_mfma_f32_16x16x32_bf16 v[52:55], v[132:135], v[152:155], v[52:55]
    s_add_u32 m0, s59, 39808
    ds_read_b128 v[124:127], v3 offset:6144
    v_min_u32 v226, 6, v226
    v_mfma_f32_16x16x32_bf16 v[56:59], v[136:139], v[152:155], v[56:59]
    buffer_load_dwordx4 v1, s[4:7], 0 offen offset:1152 lds
    v_and_b32 v227, 8, v0
    v_mfma_f32_16x16x32_bf16 v[60:63], v[140:143], v[152:155], v[60:63]
    ds_read_b128 v[152:155], v5 offset:2048
    v_lshl_or_b32 v226, v227, 3, v226
    v_mfma_f32_16x16x32_bf16 v[64:67], v[128:131], v[156:159], v[64:67]
    v_lshlrev_b32 v226, 2, v226
    v_mfma_f32_16x16x32_bf16 v[68:71], v[132:135], v[156:159], v[68:71]
    buffer_load_dword v226, v226, s[8:11], s49 offen sc1
    v_add_u32 v3, 40960, v3
    v_mfma_f32_16x16x32_bf16 v[72:75], v[136:139], v[156:159], v[72:75]
    s_add_u32 m0, s59, 56192
    v_lshl_add_u32 v206, v8, 6, s64
    v_mfma_f32_16x16x32_bf16 v[76:79], v[140:143], v[156:159], v[76:79]
    s_mul_i32 s64, s62, 384
    ds_read_b128 v[156:159], v5 offset:14336
    buffer_load_dwordx4 v2, s[24:27], 0 offen offset:1152 lds
    v_mfma_f32_16x16x32_bf16 v[80:83], v[128:131], v[160:163], v[80:83]
    s_add_u32 s64, s64, 8192
    v_lshl_add_u32 v11, v7, 3, s64
    v_mfma_f32_16x16x32_bf16 v[84:87], v[132:135], v[160:163], v[84:87]
    v_mul_u32_u24 v12, 768, v9
    v_mfma_f32_16x16x32_bf16 v[88:91], v[136:139], v[160:163], v[88:91]
    s_add_u32 m0, s59, 68480
    v_add_u32 v12, v12, v11
    v_mfma_f32_16x16x32_bf16 v[92:95], v[140:143], v[160:163], v[92:95]
    ds_read_b128 v[160:163], v5 offset:4096
    buffer_load_dwordx4 v2, s[28:31], 0 offen offset:1152 lds
    v_mfma_f32_16x16x32_bf16 v[96:99], v[128:131], v[164:167], v[96:99]
    v_lshl_add_u32 v10, v8, 7, v11
    v_mfma_f32_16x16x32_bf16 v[100:103], v[132:135], v[164:167], v[100:103]
    s_mul_i32 s64, s53, 6144
    s_mul_i32 s65, s77, 768
    v_mfma_f32_16x16x32_bf16 v[104:107], v[136:139], v[164:167], v[104:107]
    s_add_u32 m0, s59, 43904
    s_add_u32 s65, s65, 17039360
    v_mfma_f32_16x16x32_bf16 v[108:111], v[140:143], v[164:167], v[108:111]
    s_waitcnt lgkmcnt(3)
    ds_read_b128 v[164:167], v5 offset:16384
    v_add_u32 v5, 40960, v5
    v_mfma_f32_16x16x32_bf16 v[16:19], v[112:115], v[144:147], v[16:19]
    s_add_u32 s65, s65, s64
    buffer_load_dwordx4 v1, s[4:7], s56 offen offset:1152 lds
    v_mfma_f32_16x16x32_bf16 v[20:23], v[116:119], v[144:147], v[20:23]
    s_mul_i32 s64, s62, 384
    s_add_u32 s64, s64, s65
    v_mfma_f32_16x16x32_bf16 v[24:27], v[120:123], v[144:147], v[24:27]
    s_cmp_eq_u32 s61, 0
    s_cselect_b32 s64, s64, 1073741824
    v_mfma_f32_16x16x32_bf16 v[28:31], v[124:127], v[144:147], v[28:31]
    s_add_u32 m0, s59, 60288
    ds_read_b128 v[144:147], v6 offset:0
    v_mfma_f32_16x16x32_bf16 v[32:35], v[112:115], v[148:151], v[32:35]
    s_add_u32 s72, s52, 1
    ds_read_b128 v[128:131], v4 offset:0
    buffer_load_dwordx4 v2, s[24:27], s76 offen offset:1152 lds
    v_mfma_f32_16x16x32_bf16 v[36:39], v[116:119], v[148:151], v[36:39]
    s_mul_i32 s73, s72, 6144
    ds_read_b128 v[132:135], v4 offset:2048
    v_mfma_f32_16x16x32_bf16 v[40:43], v[120:123], v[148:151], v[40:43]
    s_add_u32 m0, s59, 48000
    s_sub_u32 s65, s65, s73
    v_mfma_f32_16x16x32_bf16 v[44:47], v[124:127], v[148:151], v[44:47]
    s_waitcnt lgkmcnt(3)
    ds_read_b128 v[148:151], v6 offset:12288
    v_mfma_f32_16x16x32_bf16 v[48:51], v[112:115], v[152:155], v[48:51]
    s_sub_u32 s72, s53, s72
    ds_read_b128 v[136:139], v4 offset:4096
    buffer_load_dwordx4 v1, s[4:7], s57 offen offset:1152 lds
    v_mfma_f32_16x16x32_bf16 v[52:55], v[116:119], v[152:155], v[52:55]
    s_mul_i32 s73, s52, 768
    ds_read_b128 v[140:143], v4 offset:6144
    v_mfma_f32_16x16x32_bf16 v[56:59], v[120:123], v[152:155], v[56:59]
    s_add_u32 s73, s73, 65536
    v_add_u32 v207, s73, v14
    v_mfma_f32_16x16x32_bf16 v[60:63], v[124:127], v[152:155], v[60:63]
    ds_read_b128 v[152:155], v6 offset:2048
    v_mfma_f32_16x16x32_bf16 v[64:67], v[112:115], v[156:159], v[64:67]
    s_add_u32 m0, s59, 72576
    v_lshlrev_b32 v223, 3, v0
    v_mfma_f32_16x16x32_bf16 v[68:71], v[116:119], v[156:159], v[68:71]
    buffer_load_dwordx4 v2, s[28:31], s76 offen offset:1152 lds
    v_add_u32 v4, 40960, v4
    v_mfma_f32_16x16x32_bf16 v[72:75], v[120:123], v[156:159], v[72:75]
    v_lshrrev_b32 v224, 8, v13
    v_mfma_f32_16x16x32_bf16 v[76:79], v[124:127], v[156:159], v[76:79]
    ds_read_b128 v[156:159], v6 offset:14336
    v_mfma_f32_16x16x32_bf16 v[80:83], v[112:115], v[160:163], v[80:83]
    s_add_u32 m0, s59, 64384
    v_mul_u32_u24 v225, 768, v8
    v_mfma_f32_16x16x32_bf16 v[84:87], v[116:119], v[160:163], v[84:87]
    buffer_load_dwordx4 v2, s[24:27], s57 offen offset:1152 lds
    v_mfma_f32_16x16x32_bf16 v[88:91], v[120:123], v[160:163], v[88:91]
    v_add_u32 v225, 57344, v225
    v_mfma_f32_16x16x32_bf16 v[92:95], v[124:127], v[160:163], v[92:95]
    ds_read_b128 v[160:163], v6 offset:4096
    v_mfma_f32_16x16x32_bf16 v[96:99], v[112:115], v[164:167], v[96:99]
    s_add_u32 m0, s59, 52096
    v_add_u32 v225, v225, v11
    v_mfma_f32_16x16x32_bf16 v[100:103], v[116:119], v[164:167], v[100:103]
    buffer_load_dwordx4 v1, s[4:7], s58 offen offset:1152 lds
    v_mfma_f32_16x16x32_bf16 v[104:107], v[120:123], v[164:167], v[104:107]
    v_mfma_f32_16x16x32_bf16 v[108:111], v[124:127], v[164:167], v[108:111]
    s_waitcnt vmcnt(8) lgkmcnt(3)
    ds_read_b128 v[164:167], v6 offset:16384
    v_add_u32 v6, 40960, v6
    v_cmp_ne_u32 vcc, s55, v226
    v_mfma_f32_16x16x32_bf16 v[16:19], v[128:131], v[144:147], v[16:19]
    v_mfma_f32_16x16x32_bf16 v[20:23], v[132:135], v[144:147], v[20:23]
    s_add_u32 m0, s59, 76672
    v_mfma_f32_16x16x32_bf16 v[24:27], v[136:139], v[144:147], v[24:27]
    buffer_load_dwordx4 v2, s[28:31], s57 offen offset:1152 lds
    v_mfma_f32_16x16x32_bf16 v[28:31], v[140:143], v[144:147], v[28:31]
    s_waitcnt lgkmcnt(0)
    s_barrier
    ds_read_b128 v[144:147], v5 offset:0
    v_mfma_f32_16x16x32_bf16 v[32:35], v[128:131], v[148:151], v[32:35]
    ds_read_b128 v[112:115], v3 offset:0
    s_cbranch_vccnz L_spin_pf_sf
L_ret_pf_sf:
    v_mfma_f32_16x16x32_bf16 v[36:39], v[132:135], v[148:151], v[36:39]
    ds_read_b128 v[116:119], v3 offset:2048
    buffer_load_dwordx4 a[0:3], v14, s[8:11], s63 offen offset:0 sc1
    v_mfma_f32_16x16x32_bf16 v[40:43], v[136:139], v[148:151], v[40:43]
    v_min_u32 v250, 4, v0
    v_lshlrev_b32 v250, 2, v250
    v_mfma_f32_16x16x32_bf16 v[44:47], v[140:143], v[148:151], v[44:47]
    ds_read_b128 v[148:151], v5 offset:12288
    buffer_load_dword v250, v250, s[8:11], s50 offen sc1
    v_mfma_f32_16x16x32_bf16 v[48:51], v[128:131], v[152:155], v[48:51]
    ds_read_b128 v[120:123], v3 offset:4096
    v_mfma_f32_16x16x32_bf16 v[52:55], v[132:135], v[152:155], v[52:55]
    ds_read_b128 v[124:127], v3 offset:6144
    buffer_load_dwordx4 a[4:7], v14, s[8:11], s63 offen offset:1024 sc1
    v_mfma_f32_16x16x32_bf16 v[56:59], v[136:139], v[152:155], v[56:59]
    v_mfma_f32_16x16x32_bf16 v[60:63], v[140:143], v[152:155], v[60:63]
    ds_read_b128 v[152:155], v5 offset:2048
    v_mfma_f32_16x16x32_bf16 v[64:67], v[128:131], v[156:159], v[64:67]
    v_mfma_f32_16x16x32_bf16 v[68:71], v[132:135], v[156:159], v[68:71]
    buffer_load_dwordx4 a[8:11], v14, s[8:11], s63 offen offset:2048 sc1
    v_subrev_u32 v3, 81920, v3
    v_mfma_f32_16x16x32_bf16 v[72:75], v[136:139], v[156:159], v[72:75]
    v_mfma_f32_16x16x32_bf16 v[76:79], v[140:143], v[156:159], v[76:79]
    ds_read_b128 v[156:159], v5 offset:14336
    v_mfma_f32_16x16x32_bf16 v[80:83], v[128:131], v[160:163], v[80:83]
    v_mfma_f32_16x16x32_bf16 v[84:87], v[132:135], v[160:163], v[84:87]
    buffer_load_dwordx4 a[12:15], v14, s[8:11], s63 offen offset:3072 sc1
    v_mfma_f32_16x16x32_bf16 v[88:91], v[136:139], v[160:163], v[88:91]
    v_mfma_f32_16x16x32_bf16 v[92:95], v[140:143], v[160:163], v[92:95]
    ds_read_b128 v[160:163], v5 offset:4096
    v_mfma_f32_16x16x32_bf16 v[96:99], v[128:131], v[164:167], v[96:99]
    v_mfma_f32_16x16x32_bf16 v[100:103], v[132:135], v[164:167], v[100:103]
    buffer_load_dwordx4 a[16:19], v15, s[8:11], s63 offen sc1
    v_mfma_f32_16x16x32_bf16 v[104:107], v[136:139], v[164:167], v[104:107]
    v_mfma_f32_16x16x32_bf16 v[108:111], v[140:143], v[164:167], v[108:111]
    s_waitcnt lgkmcnt(3)
    ds_read_b128 v[164:167], v5 offset:16384
    v_subrev_u32 v5, 81920, v5
    v_mfma_f32_16x16x32_bf16 v[16:19], v[112:115], v[144:147], v[16:19]
    v_mfma_f32_16x16x32_bf16 v[20:23], v[116:119], v[144:147], v[20:23]
    s_add_u32 s63, s63, 5120
    buffer_load_dwordx4 a[20:23], v14, s[8:11], s63 offen offset:0 sc1
    v_mfma_f32_16x16x32_bf16 v[24:27], v[120:123], v[144:147], v[24:27]
    v_mfma_f32_16x16x32_bf16 v[28:31], v[124:127], v[144:147], v[28:31]
    ds_read_b128 v[144:147], v6 offset:0
    v_mfma_f32_16x16x32_bf16 v[32:35], v[112:115], v[148:151], v[32:35]
    ds_read_b128 v[128:131], v4 offset:0
    v_mfma_f32_16x16x32_bf16 v[36:39], v[116:119], v[148:151], v[36:39]
    ds_read_b128 v[132:135], v4 offset:2048
    buffer_load_dwordx4 a[24:27], v14, s[8:11], s63 offen offset:1024 sc1
    v_mfma_f32_16x16x32_bf16 v[40:43], v[120:123], v[148:151], v[40:43]
    v_mfma_f32_16x16x32_bf16 v[44:47], v[124:127], v[148:151], v[44:47]
    s_waitcnt lgkmcnt(3)
    ds_read_b128 v[148:151], v6 offset:12288
    v_mfma_f32_16x16x32_bf16 v[48:51], v[112:115], v[152:155], v[48:51]
    ds_read_b128 v[136:139], v4 offset:4096
    v_mfma_f32_16x16x32_bf16 v[52:55], v[116:119], v[152:155], v[52:55]
    ds_read_b128 v[140:143], v4 offset:6144
    buffer_load_dwordx4 a[28:31], v14, s[8:11], s63 offen offset:2048 sc1
    v_mfma_f32_16x16x32_bf16 v[56:59], v[120:123], v[152:155], v[56:59]
    v_mfma_f32_16x16x32_bf16 v[60:63], v[124:127], v[152:155], v[60:63]
    ds_read_b128 v[152:155], v6 offset:2048
    v_mfma_f32_16x16x32_bf16 v[64:67], v[112:115], v[156:159], v[64:67]
    v_mfma_f32_16x16x32_bf16 v[68:71], v[116:119], v[156:159], v[68:71]
    buffer_load_dwordx4 a[32:35], v14, s[8:11], s63 offen offset:3072 sc1
    v_subrev_u32 v4, 81920, v4
    v_mfma_f32_16x16x32_bf16 v[72:75], v[120:123], v[156:159], v[72:75]
    v_mfma_f32_16x16x32_bf16 v[76:79], v[124:127], v[156:159], v[76:79]
    ds_read_b128 v[156:159], v6 offset:14336
    v_mfma_f32_16x16x32_bf16 v[80:83], v[112:115], v[160:163], v[80:83]
    v_mfma_f32_16x16x32_bf16 v[84:87], v[116:119], v[160:163], v[84:87]
    buffer_load_dwordx4 a[36:39], v15, s[8:11], s63 offen sc1
    v_mfma_f32_16x16x32_bf16 v[88:91], v[120:123], v[160:163], v[88:91]
    v_mfma_f32_16x16x32_bf16 v[92:95], v[124:127], v[160:163], v[92:95]
    ds_read_b128 v[160:163], v6 offset:4096
    v_mfma_f32_16x16x32_bf16 v[96:99], v[112:115], v[164:167], v[96:99]
    v_mfma_f32_16x16x32_bf16 v[100:103], v[116:119], v[164:167], v[100:103]
    s_waitcnt vmcnt(9)
    v_cmp_ne_u32 vcc, s55, v250
    v_mfma_f32_16x16x32_bf16 v[104:107], v[120:123], v[164:167], v[104:107]
    s_add_u32 s63, s63, 5120
    buffer_load_dwordx4 a[40:43], v14, s[8:11], s63 offen offset:0 sc1
    v_mfma_f32_16x16x32_bf16 v[108:111], v[124:127], v[164:167], v[108:111]
    s_waitcnt lgkmcnt(3)
    ds_read_b128 v[164:167], v6 offset:16384
    v_subrev_u32 v6, 81920, v6
    v_mfma_f32_16x16x32_bf16 v[16:19], v[128:131], v[144:147], v[16:19]
    v_mfma_f32_16x16x32_bf16 v[20:23], v[132:135], v[144:147], v[20:23]
    v_mfma_f32_16x16x32_bf16 v[24:27], v[136:139], v[144:147], v[24:27]
    buffer_load_dwordx4 a[44:47], v14, s[8:11], s63 offen offset:1024 sc1
    s_cbranch_vccnz L_spin_pf_sy
L_ret_pf_sy:
    v_mfma_f32_16x16x32_bf16 v[28:31], v[140:143], v[144:147], v[28:31]
    s_waitcnt lgkmcnt(0)
    s_barrier
    ds_read_b128 v[144:147], v5 offset:0
    v_mfma_f32_16x16x32_bf16 v[32:35], v[128:131], v[148:151], v[32:35]
    ds_read_b128 v[112:115], v3 offset:0
    v_mfma_f32_16x16x32_bf16 v[36:39], v[132:135], v[148:151], v[36:39]
    ds_read_b128 v[116:119], v3 offset:2048
    v_mfma_f32_16x16x32_bf16 v[40:43], v[136:139], v[148:151], v[40:43]
    buffer_load_dwordx4 a[48:51], v14, s[8:11], s63 offen offset:2048 sc1
    v_mfma_f32_16x16x32_bf16 v[44:47], v[140:143], v[148:151], v[44:47]
    ds_read_b128 v[148:151], v5 offset:12288
    v_mfma_f32_16x16x32_bf16 v[48:51], v[128:131], v[152:155], v[48:51]
    ds_read_b128 v[120:123], v3 offset:4096
    v_mfma_f32_16x16x32_bf16 v[52:55], v[132:135], v[152:155], v[52:55]
    ds_read_b128 v[124:127], v3 offset:6144
    v_mfma_f32_16x16x32_bf16 v[56:59], v[136:139], v[152:155], v[56:59]
    buffer_load_dwordx4 a[52:55], v14, s[8:11], s63 offen offset:3072 sc1
    v_mfma_f32_16x16x32_bf16 v[60:63], v[140:143], v[152:155], v[60:63]
    ds_read_b128 v[152:155], v5 offset:2048
    v_mfma_f32_16x16x32_bf16 v[64:67], v[128:131], v[156:159], v[64:67]
    v_mfma_f32_16x16x32_bf16 v[68:71], v[132:135], v[156:159], v[68:71]
    v_mfma_f32_16x16x32_bf16 v[72:75], v[136:139], v[156:159], v[72:75]
    buffer_load_dwordx4 a[56:59], v15, s[8:11], s63 offen sc1
    v_mfma_f32_16x16x32_bf16 v[76:79], v[140:143], v[156:159], v[76:79]
    ds_read_b128 v[156:159], v5 offset:14336
    v_mfma_f32_16x16x32_bf16 v[80:83], v[128:131], v[160:163], v[80:83]
    v_mfma_f32_16x16x32_bf16 v[84:87], v[132:135], v[160:163], v[84:87]
    v_mfma_f32_16x16x32_bf16 v[88:91], v[136:139], v[160:163], v[88:91]
    s_add_u32 s63, s63, 5120
    buffer_load_dwordx4 a[60:63], v14, s[8:11], s63 offen offset:0 sc1
    v_mfma_f32_16x16x32_bf16 v[92:95], v[140:143], v[160:163], v[92:95]
    ds_read_b128 v[160:163], v5 offset:4096
    v_mfma_f32_16x16x32_bf16 v[96:99], v[128:131], v[164:167], v[96:99]
    v_mfma_f32_16x16x32_bf16 v[100:103], v[132:135], v[164:167], v[100:103]
    v_mfma_f32_16x16x32_bf16 v[104:107], v[136:139], v[164:167], v[104:107]
    buffer_load_dwordx4 a[64:67], v14, s[8:11], s63 offen offset:1024 sc1
    v_mfma_f32_16x16x32_bf16 v[108:111], v[140:143], v[164:167], v[108:111]
    s_waitcnt lgkmcnt(3)
    ds_read_b128 v[164:167], v5 offset:16384
    v_mfma_f32_16x16x32_bf16 v[16:19], v[112:115], v[144:147], v[16:19]
    v_mfma_f32_16x16x32_bf16 v[20:23], v[116:119], v[144:147], v[20:23]
    v_mfma_f32_16x16x32_bf16 v[24:27], v[120:123], v[144:147], v[24:27]
    buffer_load_dwordx4 a[68:71], v14, s[8:11], s63 offen offset:2048 sc1
    v_mfma_f32_16x16x32_bf16 v[28:31], v[124:127], v[144:147], v[28:31]
    ds_read_b128 v[144:147], v6 offset:0
    v_mfma_f32_16x16x32_bf16 v[32:35], v[112:115], v[148:151], v[32:35]
    ds_read_b128 v[128:131], v4 offset:0
    v_mfma_f32_16x16x32_bf16 v[36:39], v[116:119], v[148:151], v[36:39]
    ds_read_b128 v[132:135], v4 offset:2048
    v_mfma_f32_16x16x32_bf16 v[40:43], v[120:123], v[148:151], v[40:43]
    buffer_load_dwordx4 a[72:75], v14, s[8:11], s63 offen offset:3072 sc1
    v_mfma_f32_16x16x32_bf16 v[44:47], v[124:127], v[148:151], v[44:47]
    s_waitcnt lgkmcnt(3)
    ds_read_b128 v[148:151], v6 offset:12288
    v_mfma_f32_16x16x32_bf16 v[48:51], v[112:115], v[152:155], v[48:51]
    ds_read_b128 v[136:139], v4 offset:4096
    v_mfma_f32_16x16x32_bf16 v[52:55], v[116:119], v[152:155], v[52:55]
    ds_read_b128 v[140:143], v4 offset:6144
    v_mfma_f32_16x16x32_bf16 v[56:59], v[120:123], v[152:155], v[56:59]
    buffer_load_dwordx4 a[76:79], v15, s[8:11], s63 offen sc1
    v_mfma_f32_16x16x32_bf16 v[60:63], v[124:127], v[152:155], v[60:63]
    ds_read_b128 v[152:155], v6 offset:2048
    v_mfma_f32_16x16x32_bf16 v[64:67], v[112:115], v[156:159], v[64:67]
    v_mfma_f32_16x16x32_bf16 v[68:71], v[116:119], v[156:159], v[68:71]
    v_mfma_f32_16x16x32_bf16 v[72:75], v[120:123], v[156:159], v[72:75]
    s_add_u32 s63, s63, 5120
    buffer_load_dwordx4 a[80:83], v14, s[8:11], s63 offen offset:0 sc1
    v_mfma_f32_16x16x32_bf16 v[76:79], v[124:127], v[156:159], v[76:79]
    ds_read_b128 v[156:159], v6 offset:14336
    v_mfma_f32_16x16x32_bf16 v[80:83], v[112:115], v[160:163], v[80:83]
    v_mfma_f32_16x16x32_bf16 v[84:87], v[116:119], v[160:163], v[84:87]
    v_mfma_f32_16x16x32_bf16 v[88:91], v[120:123], v[160:163], v[88:91]
    buffer_load_dwordx4 a[84:87], v14, s[8:11], s63 offen offset:1024 sc1
    v_mfma_f32_16x16x32_bf16 v[92:95], v[124:127], v[160:163], v[92:95]
    ds_read_b128 v[160:163], v6 offset:4096
    v_mfma_f32_16x16x32_bf16 v[96:99], v[112:115], v[164:167], v[96:99]
    v_mfma_f32_16x16x32_bf16 v[100:103], v[116:119], v[164:167], v[100:103]
    v_mfma_f32_16x16x32_bf16 v[104:107], v[120:123], v[164:167], v[104:107]
    buffer_load_dwordx4 a[88:91], v14, s[8:11], s63 offen offset:2048 sc1
    v_mfma_f32_16x16x32_bf16 v[108:111], v[124:127], v[164:167], v[108:111]
    s_waitcnt lgkmcnt(3)
    ds_read_b128 v[164:167], v6 offset:16384
    v_mfma_f32_16x16x32_bf16 v[16:19], v[128:131], v[144:147], v[16:19]
    v_mfma_f32_16x16x32_bf16 v[20:23], v[132:135], v[144:147], v[20:23]
    v_add_u32 v1, s59, v14
    v_add_u32 v2, 1024, v1
    v_mfma_f32_16x16x32_bf16 v[24:27], v[136:139], v[144:147], v[24:27]
    buffer_load_dwordx4 a[92:95], v14, s[8:11], s63 offen offset:3072 sc1
    v_and_b32 v2, 0xfff, v2
    v_mfma_f32_16x16x32_bf16 v[28:31], v[140:143], v[144:147], v[28:31]
    v_add_u32 v3, 2048, v1
    v_and_b32 v3, 0xfff, v3
    v_mfma_f32_16x16x32_bf16 v[32:35], v[128:131], v[148:151], v[32:35]
    v_add_u32 v4, 3072, v1
    v_and_b32 v4, 0xfff, v4
    v_mfma_f32_16x16x32_bf16 v[36:39], v[132:135], v[148:151], v[36:39]
    ds_read_b128 v[112:115], v206 offset:0
    ds_read_b128 v[116:119], v206 offset:16
    v_mfma_f32_16x16x32_bf16 v[40:43], v[136:139], v[148:151], v[40:43]
    buffer_load_dwordx4 a[96:99], v15, s[8:11], s63 offen sc1
    ds_read_b128 v[120:123], v206 offset:32
    v_mfma_f32_16x16x32_bf16 v[44:47], v[140:143], v[148:151], v[44:47]
    s_waitcnt lgkmcnt(3)
    ds_read_b128 v[124:127], v206 offset:48
    v_mfma_f32_16x16x32_bf16 v[48:51], v[128:131], v[152:155], v[48:51]
    v_mfma_f32_16x16x32_bf16 v[52:55], v[132:135], v[152:155], v[52:55]
    v_mfma_f32_16x16x32_bf16 v[56:59], v[136:139], v[152:155], v[56:59]
    s_add_u32 s63, s63, 5120
    buffer_load_dwordx4 a[100:103], v14, s[8:11], s63 offen offset:0 sc1
    v_mfma_f32_16x16x32_bf16 v[60:63], v[140:143], v[152:155], v[60:63]
    v_mfma_f32_16x16x32_bf16 v[64:67], v[128:131], v[156:159], v[64:67]
    v_mfma_f32_16x16x32_bf16 v[68:71], v[132:135], v[156:159], v[68:71]
    v_mfma_f32_16x16x32_bf16 v[72:75], v[136:139], v[156:159], v[72:75]
    buffer_load_dwordx4 a[104:107], v14, s[8:11], s63 offen offset:1024 sc1
    v_mfma_f32_16x16x32_bf16 v[76:79], v[140:143], v[156:159], v[76:79]
    v_mfma_f32_16x16x32_bf16 v[80:83], v[128:131], v[160:163], v[80:83]
    v_mfma_f32_16x16x32_bf16 v[84:87], v[132:135], v[160:163], v[84:87]
    v_mfma_f32_16x16x32_bf16 v[88:91], v[136:139], v[160:163], v[88:91]
    buffer_load_dwordx4 a[108:111], v14, s[8:11], s63 offen offset:2048 sc1
    v_mfma_f32_16x16x32_bf16 v[92:95], v[140:143], v[160:163], v[92:95]
    v_mfma_f32_16x16x32_bf16 v[96:99], v[128:131], v[164:167], v[96:99]
    v_mfma_f32_16x16x32_bf16 v[100:103], v[132:135], v[164:167], v[100:103]
    v_mfma_f32_16x16x32_bf16 v[104:107], v[136:139], v[164:167], v[104:107]
    buffer_load_dwordx4 a[112:115], v14, s[8:11], s63 offen offset:3072 sc1
    v_mfma_f32_16x16x32_bf16 v[108:111], v[140:143], v[164:167], v[108:111]
    ds_read_b128 v[128:131], v206 offset:256
    ds_read_b128 v[132:135], v206 offset:272
    ds_read_b128 v[136:139], v206 offset:288
    ds_read_b128 v[140:143], v206 offset:304
    s_waitcnt lgkmcnt(7)
    v_pk_fma_f32 v[16:17], v[208:209], v[112:113], v[16:17] op_sel:[0,0,0] op_sel_hi:[0,1,1]
    v_pk_fma_f32 v[18:19], v[208:209], v[114:115], v[18:19] op_sel:[0,0,0] op_sel_hi:[0,1,1]
    s_waitcnt lgkmcnt(6)
    v_pk_fma_f32 v[20:21], v[208:209], v[116:117], v[20:21] op_sel:[0,0,0] op_sel_hi:[0,1,1]
    v_pk_fma_f32 v[22:23], v[208:209], v[118:119], v[22:23] op_sel:[0,0,0] op_sel_hi:[0,1,1]
    s_waitcnt lgkmcnt(5)
    v_pk_fma_f32 v[24:25], v[208:209], v[120:121], v[24:25] op_sel:[0,0,0] op_sel_hi:[0,1,1]
    v_pk_fma_f32 v[26:27], v[208:209], v[122:123], v[26:27] op_sel:[0,0,0] op_sel_hi:[0,1,1]
    s_waitcnt lgkmcnt(4)
    v_pk_fma_f32 v[28:29], v[208:209], v[124:125], v[28:29] op_sel:[0,0,0] op_sel_hi:[0,1,1]
    v_pk_fma_f32 v[30:31], v[208:209], v[126:127], v[30:31] op_sel:[0,0,0] op_sel_hi:[0,1,1]
    s_waitcnt lgkmcnt(3)
    v_pk_mul_f32 v[16:17], v[16:17], v[128:129]
    v_pk_mul_f32 v[18:19], v[18:19], v[130:131]
    s_waitcnt lgkmcnt(2)
    v_pk_mul_f32 v[20:21], v[20:21], v[132:133]
    v_pk_mul_f32 v[22:23], v[22:23], v[134:135]
    s_waitcnt lgkmcnt(1)
    v_pk_mul_f32 v[24:25], v[24:25], v[136:137]
    v_pk_mul_f32 v[26:27], v[26:27], v[138:139]
    s_waitcnt lgkmcnt(0)
    s_nop 0
    v_pk_mul_f32 v[28:29], v[28:29], v[140:141]
    v_pk_mul_f32 v[30:31], v[30:31], v[142:143]
    buffer_load_dwordx4 a[116:119], v15, s[8:11], s63 offen sc1
    v_pk_fma_f32 v[32:33], v[210:211], v[112:113], v[32:33] op_sel:[0,0,0] op_sel_hi:[0,1,1]
    v_pk_fma_f32 v[34:35], v[210:211], v[114:115], v[34:35] op_sel:[0,0,0] op_sel_hi:[0,1,1]
    v_pk_fma_f32 v[36:37], v[210:211], v[116:117], v[36:37] op_sel:[0,0,0] op_sel_hi:[0,1,1]
    v_pk_fma_f32 v[38:39], v[210:211], v[118:119], v[38:39] op_sel:[0,0,0] op_sel_hi:[0,1,1]
    v_pk_fma_f32 v[40:41], v[210:211], v[120:121], v[40:41] op_sel:[0,0,0] op_sel_hi:[0,1,1]
    v_pk_fma_f32 v[42:43], v[210:211], v[122:123], v[42:43] op_sel:[0,0,0] op_sel_hi:[0,1,1]
    v_pk_fma_f32 v[44:45], v[210:211], v[124:125], v[44:45] op_sel:[0,0,0] op_sel_hi:[0,1,1]
    v_pk_fma_f32 v[46:47], v[210:211], v[126:127], v[46:47] op_sel:[0,0,0] op_sel_hi:[0,1,1]
    v_pk_mul_f32 v[32:33], v[32:33], v[128:129]
    v_pk_mul_f32 v[34:35], v[34:35], v[130:131]
    v_pk_mul_f32 v[36:37], v[36:37], v[132:133]
    v_pk_mul_f32 v[38:39], v[38:39], v[134:135]
    v_pk_mul_f32 v[40:41], v[40:41], v[136:137]
    v_pk_mul_f32 v[42:43], v[42:43], v[138:139]
    v_pk_mul_f32 v[44:45], v[44:45], v[140:141]
    v_pk_mul_f32 v[46:47], v[46:47], v[142:143]
    v_pk_fma_f32 v[156:157], v[168:169], v[16:17], v[18:19] op_sel:[0,0,0] op_sel_hi:[0,1,1]
    v_pk_fma_f32 v[158:159], v[168:169], v[32:33], v[34:35] op_sel:[0,0,0] op_sel_hi:[0,1,1]
    v_pk_fma_f32 v[156:157], v[168:169], v[32:33], v[156:157] op_sel:[1,0,0] op_sel_hi:[1,1,1] neg_lo:[1,0,0] neg_hi:[1,0,0]
    v_pk_fma_f32 v[158:159], v[168:169], v[16:17], v[158:159] op_sel:[1,0,0] op_sel_hi:[1,1,1]
    s_add_u32 s63, s63, 5120
    s_or_b32 s66, s63, s3
    s_nop 0
    buffer_load_dwordx4 a[120:123], v14, s[8:11], s66 offen offset:0 sc1
    v_pk_fma_f32 v[144:145], v[168:169], v[156:157], v[20:21] op_sel:[0,0,0] op_sel_hi:[0,1,1]
    v_pk_fma_f32 v[146:147], v[168:169], v[158:159], v[36:37] op_sel:[0,0,0] op_sel_hi:[0,1,1]
    v_pk_fma_f32 v[144:145], v[168:169], v[158:159], v[144:145] op_sel:[1,0,0] op_sel_hi:[1,1,1] neg_lo:[1,0,0] neg_hi:[1,0,0]
    v_pk_fma_f32 v[146:147], v[168:169], v[156:157], v[146:147] op_sel:[1,0,0] op_sel_hi:[1,1,1]
    v_pk_fma_f32 v[156:157], v[168:169], v[144:145], v[22:23] op_sel:[0,0,0] op_sel_hi:[0,1,1]
    v_pk_fma_f32 v[158:159], v[168:169], v[146:147], v[38:39] op_sel:[0,0,0] op_sel_hi:[0,1,1]
    v_pk_fma_f32 v[156:157], v[168:169], v[146:147], v[156:157] op_sel:[1,0,0] op_sel_hi:[1,1,1] neg_lo:[1,0,0] neg_hi:[1,0,0]
    v_pk_fma_f32 v[158:159], v[168:169], v[144:145], v[158:159] op_sel:[1,0,0] op_sel_hi:[1,1,1]
    v_pk_fma_f32 v[144:145], v[168:169], v[156:157], v[24:25] op_sel:[0,0,0] op_sel_hi:[0,1,1]
    v_pk_fma_f32 v[146:147], v[168:169], v[158:159], v[40:41] op_sel:[0,0,0] op_sel_hi:[0,1,1]
    v_pk_fma_f32 v[144:145], v[168:169], v[158:159], v[144:145] op_sel:[1,0,0] op_sel_hi:[1,1,1] neg_lo:[1,0,0] neg_hi:[1,0,0]
    v_pk_fma_f32 v[146:147], v[168:169], v[156:157], v[146:147] op_sel:[1,0,0] op_sel_hi:[1,1,1]
    v_pk_fma_f32 v[156:157], v[168:169], v[144:145], v[26:27] op_sel:[0,0,0] op_sel_hi:[0,1,1]
    v_pk_fma_f32 v[158:159], v[168:169], v[146:147], v[42:43] op_sel:[0,0,0] op_sel_hi:[0,1,1]
    v_pk_fma_f32 v[156:157], v[168:169], v[146:147], v[156:157] op_sel:[1,0,0] op_sel_hi:[1,1,1] neg_lo:[1,0,0] neg_hi:[1,0,0]
    v_pk_fma_f32 v[158:159], v[168:169], v[144:145], v[158:159] op_sel:[1,0,0] op_sel_hi:[1,1,1]
    v_pk_fma_f32 v[144:145], v[168:169], v[156:157], v[28:29] op_sel:[0,0,0] op_sel_hi:[0,1,1]
    v_pk_fma_f32 v[146:147], v[168:169], v[158:159], v[44:45] op_sel:[0,0,0] op_sel_hi:[0,1,1]
    v_pk_fma_f32 v[144:145], v[168:169], v[158:159], v[144:145] op_sel:[1,0,0] op_sel_hi:[1,1,1] neg_lo:[1,0,0] neg_hi:[1,0,0]
    v_pk_fma_f32 v[146:147], v[168:169], v[156:157], v[146:147] op_sel:[1,0,0] op_sel_hi:[1,1,1]
    buffer_load_dwordx4 a[124:127], v14, s[8:11], s66 offen offset:1024 sc1
    v_pk_fma_f32 v[156:157], v[168:169], v[144:145], v[30:31] op_sel:[0,0,0] op_sel_hi:[0,1,1]
    v_pk_fma_f32 v[158:159], v[168:169], v[146:147], v[46:47] op_sel:[0,0,0] op_sel_hi:[0,1,1]
    v_pk_fma_f32 v[156:157], v[168:169], v[146:147], v[156:157] op_sel:[1,0,0] op_sel_hi:[1,1,1] neg_lo:[1,0,0] neg_hi:[1,0,0]
    v_pk_fma_f32 v[158:159], v[168:169], v[144:145], v[158:159] op_sel:[1,0,0] op_sel_hi:[1,1,1]
    v_fma_f32 v144, v170, v156, v157
    v_fma_f32 v145, v170, v158, v159
    v_fma_f32 v144, -v171, v158, v144
    v_fma_f32 v145, v171, v156, v145
    ds_write_b64 v12, v[144:145] offset:0
    v_pk_fma_f32 v[48:49], v[212:213], v[112:113], v[48:49] op_sel:[0,0,0] op_sel_hi:[0,1,1]
    v_pk_fma_f32 v[50:51], v[212:213], v[114:115], v[50:51] op_sel:[0,0,0] op_sel_hi:[0,1,1]
    v_pk_fma_f32 v[52:53], v[212:213], v[116:117], v[52:53] op_sel:[0,0,0] op_sel_hi:[0,1,1]
    v_pk_fma_f32 v[54:55], v[212:213], v[118:119], v[54:55] op_sel:[0,0,0] op_sel_hi:[0,1,1]
    v_pk_fma_f32 v[56:57], v[212:213], v[120:121], v[56:57] op_sel:[0,0,0] op_sel_hi:[0,1,1]
    v_pk_fma_f32 v[58:59], v[212:213], v[122:123], v[58:59] op_sel:[0,0,0] op_sel_hi:[0,1,1]
    v_pk_fma_f32 v[60:61], v[212:213], v[124:125], v[60:61] op_sel:[0,0,0] op_sel_hi:[0,1,1]
    v_pk_fma_f32 v[62:63], v[212:213], v[126:127], v[62:63] op_sel:[0,0,0] op_sel_hi:[0,1,1]
    v_pk_mul_f32 v[48:49], v[48:49], v[128:129]
    v_pk_mul_f32 v[50:51], v[50:51], v[130:131]
    v_pk_mul_f32 v[52:53], v[52:53], v[132:133]
    buffer_load_dwordx4 a[128:131], v14, s[8:11], s66 offen offset:2048 sc1
    v_pk_mul_f32 v[54:55], v[54:55], v[134:135]
    v_pk_mul_f32 v[56:57], v[56:57], v[136:137]
    v_pk_mul_f32 v[58:59], v[58:59], v[138:139]
    v_pk_mul_f32 v[60:61], v[60:61], v[140:141]
    v_pk_mul_f32 v[62:63], v[62:63], v[142:143]
    v_pk_fma_f32 v[64:65], v[214:215], v[112:113], v[64:65] op_sel:[0,0,0] op_sel_hi:[0,1,1]
    v_pk_fma_f32 v[66:67], v[214:215], v[114:115], v[66:67] op_sel:[0,0,0] op_sel_hi:[0,1,1]
    v_pk_fma_f32 v[68:69], v[214:215], v[116:117], v[68:69] op_sel:[0,0,0] op_sel_hi:[0,1,1]
    v_pk_fma_f32 v[70:71], v[214:215], v[118:119], v[70:71] op_sel:[0,0,0] op_sel_hi:[0,1,1]
    v_pk_fma_f32 v[72:73], v[214:215], v[120:121], v[72:73] op_sel:[0,0,0] op_sel_hi:[0,1,1]
    v_pk_fma_f32 v[74:75], v[214:215], v[122:123], v[74:75] op_sel:[0,0,0] op_sel_hi:[0,1,1]
    v_pk_fma_f32 v[76:77], v[214:215], v[124:125], v[76:77] op_sel:[0,0,0] op_sel_hi:[0,1,1]
    v_pk_fma_f32 v[78:79], v[214:215], v[126:127], v[78:79] op_sel:[0,0,0] op_sel_hi:[0,1,1]
    v_pk_mul_f32 v[64:65], v[64:65], v[128:129]
    v_pk_mul_f32 v[66:67], v[66:67], v[130:131]
    v_pk_mul_f32 v[68:69], v[68:69], v[132:133]
    v_pk_mul_f32 v[70:71], v[70:71], v[134:135]
    v_pk_mul_f32 v[72:73], v[72:73], v[136:137]
    v_pk_mul_f32 v[74:75], v[74:75], v[138:139]
    v_pk_mul_f32 v[76:77], v[76:77], v[140:141]
    buffer_load_dwordx4 a[132:135], v14, s[8:11], s66 offen offset:3072 sc1
    v_pk_mul_f32 v[78:79], v[78:79], v[142:143]
    v_pk_fma_f32 v[160:161], v[180:181], v[48:49], v[50:51] op_sel:[0,0,0] op_sel_hi:[0,1,1]
    v_pk_fma_f32 v[162:163], v[180:181], v[64:65], v[66:67] op_sel:[0,0,0] op_sel_hi:[0,1,1]
    v_pk_fma_f32 v[160:161], v[180:181], v[64:65], v[160:161] op_sel:[1,0,0] op_sel_hi:[1,1,1] neg_lo:[1,0,0] neg_hi:[1,0,0]
    v_pk_fma_f32 v[162:163], v[180:181], v[48:49], v[162:163] op_sel:[1,0,0] op_sel_hi:[1,1,1]
    v_pk_fma_f32 v[148:149], v[180:181], v[160:161], v[52:53] op_sel:[0,0,0] op_sel_hi:[0,1,1]
    v_pk_fma_f32 v[150:151], v[180:181], v[162:163], v[68:69] op_sel:[0,0,0] op_sel_hi:[0,1,1]
    v_pk_fma_f32 v[148:149], v[180:181], v[162:163], v[148:149] op_sel:[1,0,0] op_sel_hi:[1,1,1] neg_lo:[1,0,0] neg_hi:[1,0,0]
    v_pk_fma_f32 v[150:151], v[180:181], v[160:161], v[150:151] op_sel:[1,0,0] op_sel_hi:[1,1,1]
    v_pk_fma_f32 v[160:161], v[180:181], v[148:149], v[54:55] op_sel:[0,0,0] op_sel_hi:[0,1,1]
    v_pk_fma_f32 v[162:163], v[180:181], v[150:151], v[70:71] op_sel:[0,0,0] op_sel_hi:[0,1,1]
    v_pk_fma_f32 v[160:161], v[180:181], v[150:151], v[160:161] op_sel:[1,0,0] op_sel_hi:[1,1,1] neg_lo:[1,0,0] neg_hi:[1,0,0]
    v_pk_fma_f32 v[162:163], v[180:181], v[148:149], v[162:163] op_sel:[1,0,0] op_sel_hi:[1,1,1]
    v_pk_fma_f32 v[148:149], v[180:181], v[160:161], v[56:57] op_sel:[0,0,0] op_sel_hi:[0,1,1]
    v_pk_fma_f32 v[150:151], v[180:181], v[162:163], v[72:73] op_sel:[0,0,0] op_sel_hi:[0,1,1]
    v_pk_fma_f32 v[148:149], v[180:181], v[162:163], v[148:149] op_sel:[1,0,0] op_sel_hi:[1,1,1] neg_lo:[1,0,0] neg_hi:[1,0,0]
    v_pk_fma_f32 v[150:151], v[180:181], v[160:161], v[150:151] op_sel:[1,0,0] op_sel_hi:[1,1,1]
    v_pk_fma_f32 v[160:161], v[180:181], v[148:149], v[58:59] op_sel:[0,0,0] op_sel_hi:[0,1,1]
    v_pk_fma_f32 v[162:163], v[180:181], v[150:151], v[74:75] op_sel:[0,0,0] op_sel_hi:[0,1,1]
    v_pk_fma_f32 v[160:161], v[180:181], v[150:151], v[160:161] op_sel:[1,0,0] op_sel_hi:[1,1,1] neg_lo:[1,0,0] neg_hi:[1,0,0]
    buffer_load_dwordx4 a[136:139], v15, s[8:11], s66 offen sc1
    v_pk_fma_f32 v[162:163], v[180:181], v[148:149], v[162:163] op_sel:[1,0,0] op_sel_hi:[1,1,1]
    v_pk_fma_f32 v[148:149], v[180:181], v[160:161], v[60:61] op_sel:[0,0,0] op_sel_hi:[0,1,1]
    v_pk_fma_f32 v[150:151], v[180:181], v[162:163], v[76:77] op_sel:[0,0,0] op_sel_hi:[0,1,1]
    v_pk_fma_f32 v[148:149], v[180:181], v[162:163], v[148:149] op_sel:[1,0,0] op_sel_hi:[1,1,1] neg_lo:[1,0,0] neg_hi:[1,0,0]
    v_pk_fma_f32 v[150:151], v[180:181], v[160:161], v[150:151] op_sel:[1,0,0] op_sel_hi:[1,1,1]
    v_pk_fma_f32 v[160:161], v[180:181], v[148:149], v[62:63] op_sel:[0,0,0] op_sel_hi:[0,1,1]
    v_pk_fma_f32 v[162:163], v[180:181], v[150:151], v[78:79] op_sel:[0,0,0] op_sel_hi:[0,1,1]
    v_pk_fma_f32 v[160:161], v[180:181], v[150:151], v[160:161] op_sel:[1,0,0] op_sel_hi:[1,1,1] neg_lo:[1,0,0] neg_hi:[1,0,0]
    v_pk_fma_f32 v[162:163], v[180:181], v[148:149], v[162:163] op_sel:[1,0,0] op_sel_hi:[1,1,1]
    v_fma_f32 v148, v182, v160, v161
    v_fma_f32 v149, v182, v162, v163
    v_fma_f32 v148, -v183, v162, v148
    v_fma_f32 v149, v183, v160, v149
    ds_write_b64 v12, v[148:149] offset:128
    v_pk_fma_f32 v[80:81], v[216:217], v[112:113], v[80:81] op_sel:[0,0,0] op_sel_hi:[0,1,1]
    v_pk_fma_f32 v[82:83], v[216:217], v[114:115], v[82:83] op_sel:[0,0,0] op_sel_hi:[0,1,1]
    v_pk_fma_f32 v[84:85], v[216:217], v[116:117], v[84:85] op_sel:[0,0,0] op_sel_hi:[0,1,1]
    v_pk_fma_f32 v[86:87], v[216:217], v[118:119], v[86:87] op_sel:[0,0,0] op_sel_hi:[0,1,1]
    v_pk_fma_f32 v[88:89], v[216:217], v[120:121], v[88:89] op_sel:[0,0,0] op_sel_hi:[0,1,1]
    v_pk_fma_f32 v[90:91], v[216:217], v[122:123], v[90:91] op_sel:[0,0,0] op_sel_hi:[0,1,1]
    v_pk_fma_f32 v[92:93], v[216:217], v[124:125], v[92:93] op_sel:[0,0,0] op_sel_hi:[0,1,1]
    v_pk_fma_f32 v[94:95], v[216:217], v[126:127], v[94:95] op_sel:[0,0,0] op_sel_hi:[0,1,1]
    v_pk_mul_f32 v[80:81], v[80:81], v[128:129]
    v_pk_mul_f32 v[82:83], v[82:83], v[130:131]
    v_pk_mul_f32 v[84:85], v[84:85], v[132:133]
    v_pk_mul_f32 v[86:87], v[86:87], v[134:135]
    v_pk_mul_f32 v[88:89], v[88:89], v[136:137]
    v_pk_mul_f32 v[90:91], v[90:91], v[138:139]
    v_pk_mul_f32 v[92:93], v[92:93], v[140:141]
    v_pk_mul_f32 v[94:95], v[94:95], v[142:143]
    v_pk_fma_f32 v[96:97], v[218:219], v[112:113], v[96:97] op_sel:[0,0,0] op_sel_hi:[0,1,1]
    v_pk_fma_f32 v[98:99], v[218:219], v[114:115], v[98:99] op_sel:[0,0,0] op_sel_hi:[0,1,1]
    v_pk_fma_f32 v[100:101], v[218:219], v[116:117], v[100:101] op_sel:[0,0,0] op_sel_hi:[0,1,1]
    v_pk_fma_f32 v[102:103], v[218:219], v[118:119], v[102:103] op_sel:[0,0,0] op_sel_hi:[0,1,1]
    v_pk_fma_f32 v[104:105], v[218:219], v[120:121], v[104:105] op_sel:[0,0,0] op_sel_hi:[0,1,1]
    v_pk_fma_f32 v[106:107], v[218:219], v[122:123], v[106:107] op_sel:[0,0,0] op_sel_hi:[0,1,1]
    v_pk_fma_f32 v[108:109], v[218:219], v[124:125], v[108:109] op_sel:[0,0,0] op_sel_hi:[0,1,1]
    v_pk_fma_f32 v[110:111], v[218:219], v[126:127], v[110:111] op_sel:[0,0,0] op_sel_hi:[0,1,1]
    v_pk_mul_f32 v[96:97], v[96:97], v[128:129]
    v_pk_mul_f32 v[98:99], v[98:99], v[130:131]
    v_pk_mul_f32 v[100:101], v[100:101], v[132:133]
    v_pk_mul_f32 v[102:103], v[102:103], v[134:135]
    v_pk_mul_f32 v[104:105], v[104:105], v[136:137]
    v_pk_mul_f32 v[106:107], v[106:107], v[138:139]
    v_pk_mul_f32 v[108:109], v[108:109], v[140:141]
    v_pk_mul_f32 v[110:111], v[110:111], v[142:143]
    v_pk_fma_f32 v[164:165], v[192:193], v[80:81], v[82:83] op_sel:[0,0,0] op_sel_hi:[0,1,1]
    v_pk_fma_f32 v[166:167], v[192:193], v[96:97], v[98:99] op_sel:[0,0,0] op_sel_hi:[0,1,1]
    v_pk_fma_f32 v[164:165], v[192:193], v[96:97], v[164:165] op_sel:[1,0,0] op_sel_hi:[1,1,1] neg_lo:[1,0,0] neg_hi:[1,0,0]
    v_pk_fma_f32 v[166:167], v[192:193], v[80:81], v[166:167] op_sel:[1,0,0] op_sel_hi:[1,1,1]
    v_pk_fma_f32 v[152:153], v[192:193], v[164:165], v[84:85] op_sel:[0,0,0] op_sel_hi:[0,1,1]
    v_pk_fma_f32 v[154:155], v[192:193], v[166:167], v[100:101] op_sel:[0,0,0] op_sel_hi:[0,1,1]
    v_pk_fma_f32 v[152:153], v[192:193], v[166:167], v[152:153] op_sel:[1,0,0] op_sel_hi:[1,1,1] neg_lo:[1,0,0] neg_hi:[1,0,0]
    v_pk_fma_f32 v[154:155], v[192:193], v[164:165], v[154:155] op_sel:[1,0,0] op_sel_hi:[1,1,1]
    v_pk_fma_f32 v[164:165], v[192:193], v[152:153], v[86:87] op_sel:[0,0,0] op_sel_hi:[0,1,1]
    v_pk_fma_f32 v[166:167], v[192:193], v[154:155], v[102:103] op_sel:[0,0,0] op_sel_hi:[0,1,1]
    v_pk_fma_f32 v[164:165], v[192:193], v[154:155], v[164:165] op_sel:[1,0,0] op_sel_hi:[1,1,1] neg_lo:[1,0,0] neg_hi:[1,0,0]
    v_pk_fma_f32 v[166:167], v[192:193], v[152:153], v[166:167] op_sel:[1,0,0] op_sel_hi:[1,1,1]
    v_pk_fma_f32 v[152:153], v[192:193], v[164:165], v[88:89] op_sel:[0,0,0] op_sel_hi:[0,1,1]
    v_pk_fma_f32 v[154:155], v[192:193], v[166:167], v[104:105] op_sel:[0,0,0] op_sel_hi:[0,1,1]
    v_pk_fma_f32 v[152:153], v[192:193], v[166:167], v[152:153] op_sel:[1,0,0] op_sel_hi:[1,1,1] neg_lo:[1,0,0] neg_hi:[1,0,0]
    v_pk_fma_f32 v[154:155], v[192:193], v[164:165], v[154:155] op_sel:[1,0,0] op_sel_hi:[1,1,1]
    v_pk_fma_f32 v[164:165], v[192:193], v[152:153], v[90:91] op_sel:[0,0,0] op_sel_hi:[0,1,1]
    v_pk_fma_f32 v[166:167], v[192:193], v[154:155], v[106:107] op_sel:[0,0,0] op_sel_hi:[0,1,1]
    v_pk_fma_f32 v[164:165], v[192:193], v[154:155], v[164:165] op_sel:[1,0,0] op_sel_hi:[1,1,1] neg_lo:[1,0,0] neg_hi:[1,0,0]
    v_pk_fma_f32 v[166:167], v[192:193], v[152:153], v[166:167] op_sel:[1,0,0] op_sel_hi:[1,1,1]
    v_pk_fma_f32 v[152:153], v[192:193], v[164:165], v[92:93] op_sel:[0,0,0] op_sel_hi:[0,1,1]
    v_pk_fma_f32 v[154:155], v[192:193], v[166:167], v[108:109] op_sel:[0,0,0] op_sel_hi:[0,1,1]
    v_pk_fma_f32 v[152:153], v[192:193], v[166:167], v[152:153] op_sel:[1,0,0] op_sel_hi:[1,1,1] neg_lo:[1,0,0] neg_hi:[1,0,0]
    v_pk_fma_f32 v[154:155], v[192:193], v[164:165], v[154:155] op_sel:[1,0,0] op_sel_hi:[1,1,1]
    v_pk_fma_f32 v[164:165], v[192:193], v[152:153], v[94:95] op_sel:[0,0,0] op_sel_hi:[0,1,1]
    v_pk_fma_f32 v[166:167], v[192:193], v[154:155], v[110:111] op_sel:[0,0,0] op_sel_hi:[0,1,1]
    v_pk_fma_f32 v[164:165], v[192:193], v[154:155], v[164:165] op_sel:[1,0,0] op_sel_hi:[1,1,1] neg_lo:[1,0,0] neg_hi:[1,0,0]
    v_pk_fma_f32 v[166:167], v[192:193], v[152:153], v[166:167] op_sel:[1,0,0] op_sel_hi:[1,1,1]
    v_fma_f32 v152, v194, v164, v165
    v_fma_f32 v153, v194, v166, v167
    v_fma_f32 v152, -v195, v166, v152
    v_fma_f32 v153, v195, v164, v153
    ds_write_b64 v12, v[152:153] offset:256
    s_waitcnt lgkmcnt(0)
    s_barrier
    ds_read_b64 v[112:113], v10 offset:0
    ds_read_b64 v[114:115], v10 offset:768
    ds_read_b64 v[116:117], v10 offset:1536
    ds_read_b64 v[118:119], v10 offset:2304
    ds_read_b64 v[120:121], v10 offset:3072
    ds_read_b64 v[122:123], v10 offset:3840
    ds_read_b64 v[124:125], v10 offset:4608
    ds_read_b64 v[126:127], v10 offset:5376
    s_sub_u32 s32, s65, 0
    s_cmp_ge_i32 s72, 0
    s_cselect_b32 s32, s32, 1073741824
    s_cselect_b32 s36, 0xff, 0
    s_sub_u32 s33, s65, 24576
    s_cmp_ge_i32 s72, 4
    s_cselect_b32 s33, s33, 1073741824
    s_cselect_b32 s37, 0xff, 0
    s_sub_u32 s34, s65, 49152
    s_cmp_ge_i32 s72, 8
    s_cselect_b32 s34, s34, 1073741824
    s_cselect_b32 s38, 0xff, 0
    s_sub_u32 s35, s65, 73728
    s_cmp_ge_i32 s72, 12
    s_cselect_b32 s35, s35, 1073741824
    s_cselect_b32 s39, 0xff, 0
    s_mov_b32 s69, 0xff
    s_waitcnt lgkmcnt(6)
    v_pk_fma_f32 v[114:115], v[204:205], v[112:113], v[114:115] op_sel:[0,0,0] op_sel_hi:[0,1,1]
    v_pk_fma_f32 v[114:115], v[204:205], v[112:113], v[114:115] op_sel:[1,1,0] op_sel_hi:[1,0,1] neg_lo:[1,0,0]
    s_waitcnt lgkmcnt(5)
    v_pk_fma_f32 v[116:117], v[204:205], v[114:115], v[116:117] op_sel:[0,0,0] op_sel_hi:[0,1,1]
    v_pk_fma_f32 v[116:117], v[204:205], v[114:115], v[116:117] op_sel:[1,1,0] op_sel_hi:[1,0,1] neg_lo:[1,0,0]
    s_waitcnt lgkmcnt(4)
    v_pk_fma_f32 v[118:119], v[204:205], v[116:117], v[118:119] op_sel:[0,0,0] op_sel_hi:[0,1,1]
    v_pk_fma_f32 v[118:119], v[204:205], v[116:117], v[118:119] op_sel:[1,1,0] op_sel_hi:[1,0,1] neg_lo:[1,0,0]
    s_waitcnt lgkmcnt(3)
    v_pk_fma_f32 v[120:121], v[204:205], v[118:119], v[120:121] op_sel:[0,0,0] op_sel_hi:[0,1,1]
    v_pk_fma_f32 v[120:121], v[204:205], v[118:119], v[120:121] op_sel:[1,1,0] op_sel_hi:[1,0,1] neg_lo:[1,0,0]
    s_waitcnt lgkmcnt(2)
    v_pk_fma_f32 v[122:123], v[204:205], v[120:121], v[122:123] op_sel:[0,0,0] op_sel_hi:[0,1,1]
    v_pk_fma_f32 v[122:123], v[204:205], v[120:121], v[122:123] op_sel:[1,1,0] op_sel_hi:[1,0,1] neg_lo:[1,0,0]
    s_waitcnt lgkmcnt(1)
    v_pk_fma_f32 v[124:125], v[204:205], v[122:123], v[124:125] op_sel:[0,0,0] op_sel_hi:[0,1,1]
    v_pk_fma_f32 v[124:125], v[204:205], v[122:123], v[124:125] op_sel:[1,1,0] op_sel_hi:[1,0,1] neg_lo:[1,0,0]
    s_waitcnt lgkmcnt(0)
    v_pk_fma_f32 v[126:127], v[204:205], v[124:125], v[126:127] op_sel:[0,0,0] op_sel_hi:[0,1,1]
    v_pk_fma_f32 v[128:129], v[204:205], v[124:125], v[126:127] op_sel:[1,1,0] op_sel_hi:[1,0,1] neg_lo:[1,0,0]
    v_bfi_b32 v128, s69, v13, v128
    v_bfi_b32 v129, s69, v224, v129
    s_mov_b32 exec_hi, 0xffff
    buffer_store_dwordx2 v[128:129], v223, s[8:11], s64 offen sc1
    s_mov_b32 exec_hi, -1
    s_mul_i32 s70, s52, 3072
    s_add_u32 s70, s70, 122880
    v_add_u32 v141, 0, v0
    v_mul_u32_u24 v140, 6554, v141
    v_lshrrev_b32 v140, 16, v140
    v_mul_u32_u24 v140, 1120, v140
    s_add_u32 m0, s70, 0
    v_lshl_add_u32 v140, v141, 4, v140
    buffer_load_dwordx4 v140, s[4:7], s46 offen lds
    v_add_u32 v141, 64, v0
    v_mul_u32_u24 v140, 6554, v141
    v_lshrrev_b32 v140, 16, v140
    v_mul_u32_u24 v140, 1120, v140
    s_add_u32 m0, s70, 1024
    v_lshl_add_u32 v140, v141, 4, v140
    buffer_load_dwordx4 v140, s[4:7], s46 offen lds
    v_add_u32 v141, 128, v0
    v_mul_u32_u24 v140, 6554, v141
    v_lshrrev_b32 v140, 16, v140
    v_mul_u32_u24 v140, 1120, v140
    s_add_u32 m0, s70, 2048
    v_lshl_add_u32 v140, v141, 4, v140
    s_mov_b32 exec_hi, 0
    buffer_load_dwordx4 v140, s[4:7], s46 offen lds
    s_mov_b32 exec_hi, -1
    v_add_u32 v140, s47, v14
    s_add_u32 m0, s70, 2560
    s_mov_b64 exec, 0x3ff
    global_load_lds_dwordx4 v140, s[14:15]
    s_mov_b64 exec, -1
    s_add_u32 m0, s70, 2720
    s_mov_b64 exec, 0x3ff
    global_load_lds_dwordx4 v140, s[16:17]
    s_mov_b64 exec, -1
    s_add_u32 m0, s70, 2880
    s_mov_b64 exec, 0xff
    buffer_load_dwordx4 v14, s[8:11], s48 offen sc1 lds
    s_mov_b64 exec, -1
    s_nop 0
    ds_read_b64 v[112:113], v11 offset:0
    ds_read_b64 v[114:115], v11 offset:128
    ds_read_b64 v[116:117], v11 offset:256
    ds_read_b64 v[118:119], v11 offset:768
    ds_read_b64 v[120:121], v11 offset:896
    ds_read_b64 v[122:123], v11 offset:1024
    ds_read_b64 v[124:125], v11 offset:1536
    ds_read_b64 v[126:127], v11 offset:1664
    ds_read_b64 v[128:129], v11 offset:1792
    v_mov_b32 v146, 0
    v_mov_b32 v147, 0
    v_mov_b32 v150, 0
    v_mov_b32 v151, 0
    v_mov_b32 v154, 0
    s_add_u32 s63, s63, 5120
    buffer_load_dwordx4 a[140:143], v14, s[8:11], s63 offen offset:0 sc1
    v_mov_b32 v155, 0
    s_cmp_eq_u32 s61, 1
    s_cselect_b32 exec_lo, -1, 0xffff0000
    s_cselect_b32 exec_hi, -1, -1
    s_waitcnt lgkmcnt(8)
    v_pk_fma_f32 v[112:113], v[172:173], v[146:147], v[112:113] op_sel:[0,0,0] op_sel_hi:[0,1,1]
    s_waitcnt lgkmcnt(7)
    v_pk_fma_f32 v[114:115], v[184:185], v[150:151], v[114:115] op_sel:[0,0,0] op_sel_hi:[0,1,1]
    s_waitcnt lgkmcnt(6)
    v_pk_fma_f32 v[116:117], v[196:197], v[154:155], v[116:117] op_sel:[0,0,0] op_sel_hi:[0,1,1]
    v_pk_fma_f32 v[146:147], v[172:173], v[146:147], v[112:113] op_sel:[1,1,0] op_sel_hi:[1,0,1] neg_lo:[1,0,0]
    v_pk_fma_f32 v[150:151], v[184:185], v[150:151], v[114:115] op_sel:[1,1,0] op_sel_hi:[1,0,1] neg_lo:[1,0,0]
    v_pk_fma_f32 v[154:155], v[196:197], v[154:155], v[116:117] op_sel:[1,1,0] op_sel_hi:[1,0,1] neg_lo:[1,0,0]
    s_mov_b64 exec, -1
    ds_read_b64 v[112:113], v11 offset:2304
    ds_read_b64 v[114:115], v11 offset:2432
    ds_read_b64 v[116:117], v11 offset:2560
    buffer_load_dwordx4 a[144:147], v14, s[8:11], s63 offen offset:1024 sc1
    s_cmp_eq_u32 s61, 1
    s_cselect_b32 exec_lo, -1, 0
    s_cselect_b32 exec_hi, -1, -1
    s_waitcnt lgkmcnt(8)
    v_pk_fma_f32 v[118:119], v[172:173], v[146:147], v[118:119] op_sel:[0,0,0] op_sel_hi:[0,1,1]
    s_waitcnt lgkmcnt(7)
    v_pk_fma_f32 v[120:121], v[184:185], v[150:151], v[120:121] op_sel:[0,0,0] op_sel_hi:[0,1,1]
    s_waitcnt lgkmcnt(6)
    v_pk_fma_f32 v[122:123], v[196:197], v[154:155], v[122:123] op_sel:[0,0,0] op_sel_hi:[0,1,1]
    v_pk_fma_f32 v[146:147], v[172:173], v[146:147], v[118:119] op_sel:[1,1,0] op_sel_hi:[1,0,1] neg_lo:[1,0,0]
    v_pk_fma_f32 v[150:151], v[184:185], v[150:151], v[120:121] op_sel:[1,1,0] op_sel_hi:[1,0,1] neg_lo:[1,0,0]
    v_pk_fma_f32 v[154:155], v[196:197], v[154:155], v[122:123] op_sel:[1,1,0] op_sel_hi:[1,0,1] neg_lo:[1,0,0]
    s_mov_b64 exec, -1
    ds_read_b64 v[118:119], v11 offset:3072
    ds_read_b64 v[120:121], v11 offset:3200
    ds_read_b64 v[122:123], v11 offset:3328
    s_cmp_eq_u32 s61, 1
    s_cselect_b32 exec_lo, -1, 0
    s_cselect_b32 exec_hi, -1, 0xffff0000
    s_waitcnt lgkmcnt(8)
    v_pk_fma_f32 v[124:125], v[172:173], v[146:147], v[124:125] op_sel:[0,0,0] op_sel_hi:[0,1,1]
    s_waitcnt lgkmcnt(7)
    v_pk_fma_f32 v[126:127], v[184:185], v[150:151], v[126:127] op_sel:[0,0,0] op_sel_hi:[0,1,1]
    s_waitcnt lgkmcnt(6)
    v_pk_fma_f32 v[128:129], v[196:197], v[154:155], v[128:129] op_sel:[0,0,0] op_sel_hi:[0,1,1]
    v_pk_fma_f32 v[146:147], v[172:173], v[146:147], v[124:125] op_sel:[1,1,0] op_sel_hi:[1,0,1] neg_lo:[1,0,0]
    v_pk_fma_f32 v[150:151], v[184:185], v[150:151], v[126:127] op_sel:[1,1,0] op_sel_hi:[1,0,1] neg_lo:[1,0,0]
    v_pk_fma_f32 v[154:155], v[196:197], v[154:155], v[128:129] op_sel:[1,1,0] op_sel_hi:[1,0,1] neg_lo:[1,0,0]
    s_mov_b64 exec, -1
    buffer_load_dwordx4 a[148:151], v14, s[8:11], s63 offen offset:2048 sc1
    ds_read_b64 v[124:125], v11 offset:3840
    ds_read_b64 v[126:127], v11 offset:3968
    ds_read_b64 v[128:129], v11 offset:4096
    s_cmp_eq_u32 s61, 1
    s_cselect_b32 exec_lo, -1, 0
    s_cselect_b32 exec_hi, -1, 0
    s_waitcnt lgkmcnt(8)
    v_pk_fma_f32 v[112:113], v[172:173], v[146:147], v[112:113] op_sel:[0,0,0] op_sel_hi:[0,1,1]
    s_waitcnt lgkmcnt(7)
    v_pk_fma_f32 v[114:115], v[184:185], v[150:151], v[114:115] op_sel:[0,0,0] op_sel_hi:[0,1,1]
    s_waitcnt lgkmcnt(6)
    v_pk_fma_f32 v[116:117], v[196:197], v[154:155], v[116:117] op_sel:[0,0,0] op_sel_hi:[0,1,1]
    v_pk_fma_f32 v[146:147], v[172:173], v[146:147], v[112:113] op_sel:[1,1,0] op_sel_hi:[1,0,1] neg_lo:[1,0,0]
    v_pk_fma_f32 v[150:151], v[184:185], v[150:151], v[114:115] op_sel:[1,1,0] op_sel_hi:[1,0,1] neg_lo:[1,0,0]
    v_pk_fma_f32 v[154:155], v[196:197], v[154:155], v[116:117] op_sel:[1,1,0] op_sel_hi:[1,0,1] neg_lo:[1,0,0]
    s_mov_b64 exec, -1
    buffer_load_dwordx4 a[152:155], v14, s[8:11], s63 offen offset:3072 sc1
    ds_read_b64 v[112:113], v11 offset:4608
    ds_read_b64 v[114:115], v11 offset:4736
    ds_read_b64 v[116:117], v11 offset:4864
    s_cmp_eq_u32 s61, 1
    s_cselect_b32 exec_lo, 0xffff0000, 0
    s_cselect_b32 exec_hi, -1, 0
    s_waitcnt lgkmcnt(8)
    v_pk_fma_f32 v[118:119], v[172:173], v[146:147], v[118:119] op_sel:[0,0,0] op_sel_hi:[0,1,1]
    s_waitcnt lgkmcnt(7)
    v_pk_fma_f32 v[120:121], v[184:185], v[150:151], v[120:121] op_sel:[0,0,0] op_sel_hi:[0,1,1]
    s_waitcnt lgkmcnt(6)
    v_pk_fma_f32 v[122:123], v[196:197], v[154:155], v[122:123] op_sel:[0,0,0] op_sel_hi:[0,1,1]
    v_pk_fma_f32 v[146:147], v[172:173], v[146:147], v[118:119] op_sel:[1,1,0] op_sel_hi:[1,0,1] neg_lo:[1,0,0]
    v_pk_fma_f32 v[150:151], v[184:185], v[150:151], v[120:121] op_sel:[1,1,0] op_sel_hi:[1,0,1] neg_lo:[1,0,0]
    v_pk_fma_f32 v[154:155], v[196:197], v[154:155], v[122:123] op_sel:[1,1,0] op_sel_hi:[1,0,1] neg_lo:[1,0,0]
    s_mov_b64 exec, -1
    buffer_load_dwordx4 a[156:159], v15, s[8:11], s63 offen sc1
    s_cmp_eq_u32 s61, 1
    s_cselect_b32 exec_lo, 0, 0
    s_cselect_b32 exec_hi, -1, 0
    s_waitcnt lgkmcnt(5)
    v_pk_fma_f32 v[124:125], v[172:173], v[146:147], v[124:125] op_sel:[0,0,0] op_sel_hi:[0,1,1]
    s_waitcnt lgkmcnt(4)
    v_pk_fma_f32 v[126:127], v[184:185], v[150:151], v[126:127] op_sel:[0,0,0] op_sel_hi:[0,1,1]
    s_waitcnt lgkmcnt(3)
    v_pk_fma_f32 v[128:129], v[196:197], v[154:155], v[128:129] op_sel:[0,0,0] op_sel_hi:[0,1,1]
    v_pk_fma_f32 v[146:147], v[172:173], v[146:147], v[124:125] op_sel:[1,1,0] op_sel_hi:[1,0,1] neg_lo:[1,0,0]
    v_pk_fma_f32 v[150:151], v[184:185], v[150:151], v[126:127] op_sel:[1,1,0] op_sel_hi:[1,0,1] neg_lo:[1,0,0]
    v_pk_fma_f32 v[154:155], v[196:197], v[154:155], v[128:129] op_sel:[1,1,0] op_sel_hi:[1,0,1] neg_lo:[1,0,0]
    s_mov_b64 exec, -1
    s_add_u32 s63, s63, 5120
    buffer_load_dwordx4 a[160:163], v14, s[8:11], s63 offen offset:0 sc1
    s_cmp_eq_u32 s61, 1
    s_cselect_b32 exec_lo, 0, 0
    s_cselect_b32 exec_hi, 0xffff0000, 0
    s_waitcnt lgkmcnt(2)
    v_pk_fma_f32 v[112:113], v[172:173], v[146:147], v[112:113] op_sel:[0,0,0] op_sel_hi:[0,1,1]
    s_waitcnt lgkmcnt(1)
    v_pk_fma_f32 v[114:115], v[184:185], v[150:151], v[114:115] op_sel:[0,0,0] op_sel_hi:[0,1,1]
    s_waitcnt lgkmcnt(0)
    v_pk_fma_f32 v[116:117], v[196:197], v[154:155], v[116:117] op_sel:[0,0,0] op_sel_hi:[0,1,1]
    v_pk_fma_f32 v[146:147], v[172:173], v[146:147], v[112:113] op_sel:[1,1,0] op_sel_hi:[1,0,1] neg_lo:[1,0,0]
    v_pk_fma_f32 v[150:151], v[184:185], v[150:151], v[114:115] op_sel:[1,1,0] op_sel_hi:[1,0,1] neg_lo:[1,0,0]
    v_pk_fma_f32 v[154:155], v[196:197], v[154:155], v[116:117] op_sel:[1,1,0] op_sel_hi:[1,0,1] neg_lo:[1,0,0]
    s_mov_b64 exec, -1
    v_lshlrev_b32 v142, 4, v9
    v_cvt_f32_u32 v142, v142
    v_lshlrev_b32 v143, 7, v8
    v_cvt_f32_u32 v143, v143
    v_mul_f32 v140, v142, v176
    v_mul_f32 v141, v142, v177
    v_exp_f32 v140, v140
    v_fract_f32 v141, v141
    v_cos_f32 v178, v141
    v_sin_f32 v179, v141
    v_mul_f32 v178, v140, v178
    buffer_load_dwordx4 a[164:167], v14, s[8:11], s63 offen offset:1024 sc1
    v_mul_f32 v179, v140, v179
    v_mul_f32 v140, v143, v176
    v_mul_f32 v141, v143, v177
    v_exp_f32 v140, v140
    v_fract_f32 v141, v141
    v_cos_f32 v176, v141
    v_sin_f32 v177, v141
    v_mul_f32 v176, v140, v176
    v_mul_f32 v177, v140, v177
    v_mul_f32 v140, v142, v188
    v_mul_f32 v141, v142, v189
    buffer_load_dwordx4 a[168:171], v14, s[8:11], s63 offen offset:2048 sc1
    v_exp_f32 v140, v140
    v_fract_f32 v141, v141
    v_cos_f32 v190, v141
    v_sin_f32 v191, v141
    v_mul_f32 v190, v140, v190
    v_mul_f32 v191, v140, v191
    v_mul_f32 v140, v143, v188
    v_mul_f32 v141, v143, v189
    v_exp_f32 v140, v140
    v_fract_f32 v141, v141
    buffer_load_dwordx4 a[172:175], v14, s[8:11], s63 offen offset:3072 sc1
    v_cos_f32 v188, v141
    v_sin_f32 v189, v141
    v_mul_f32 v188, v140, v188
    v_mul_f32 v189, v140, v189
    v_mul_f32 v140, v142, v200
    v_mul_f32 v141, v142, v201
    v_exp_f32 v140, v140
    v_fract_f32 v141, v141
    v_cos_f32 v202, v141
    v_sin_f32 v203, v141
    buffer_load_dwordx4 a[176:179], v15, s[8:11], s63 offen sc1
    v_mul_f32 v202, v140, v202
    v_mul_f32 v203, v140, v203
    v_mul_f32 v140, v143, v200
    v_mul_f32 v141, v143, v201
    v_exp_f32 v140, v140
    v_fract_f32 v141, v141
    v_cos_f32 v200, v141
    v_sin_f32 v201, v141
    v_mul_f32 v200, v140, v200
    v_mul_f32 v201, v140, v201
    s_mul_i32 s70, s52, 15360
    v_mul_u32_u24 v10, 144, v7
    v_lshl_add_u32 v10, v8, 5, v10
    v_add_u32 v10, s70, v10
    v_bfe_u32 v12, v0, 2, 2
    v_lshl_add_u32 v11, v8, 3, v12
    v_mul_u32_u24 v11, 144, v11
    v_and_b32 v12, 3, v0
    v_lshl_add_u32 v11, v12, 3, v11
    v_add_u32 v11, s70, v11
    s_mov_b32 exec_hi, 0xffff
    buffer_load_dwordx4 v[228:231], v14, s[8:11], s32 offen sc1
    buffer_load_dwordx4 v[232:235], v14, s[8:11], s33 offen sc1
    buffer_load_dwordx4 v[236:239], v14, s[8:11], s34 offen sc1
    buffer_load_dwordx4 v[240:243], v14, s[8:11], s35 offen sc1
    s_mov_b32 exec_hi, -1
    s_buffer_load_dwordx8 s[24:31], s[8:11], s42 offset:0 glc
    s_waitcnt vmcnt(3)
    v_xor_b32 v130, v13, v228
    v_bitop3_b32 v130, v130, v229, v224 bitop3:0xf6
    v_bitop3_b32 v130, v130, v230, v13 bitop3:0xf6
    v_bitop3_b32 v130, v130, v231, v224 bitop3:0xf6
    v_and_b32 v131, s36, v130
    s_waitcnt vmcnt(2)
    v_xor_b32 v130, v13, v232
    v_bitop3_b32 v130, v130, v233, v224 bitop3:0xf6
    v_bitop3_b32 v130, v130, v234, v13 bitop3:0xf6
    v_bitop3_b32 v130, v130, v235, v224 bitop3:0xf6
    v_and_or_b32 v131, v130, s37, v131
    s_waitcnt vmcnt(1)
    v_xor_b32 v130, v13, v236
    v_bitop3_b32 v130, v130, v237, v224 bitop3:0xf6
    v_bitop3_b32 v130, v130, v238, v13 bitop3:0xf6
    v_bitop3_b32 v130, v130, v239, v224 bitop3:0xf6
    v_and_or_b32 v131, v130, s38, v131
    s_waitcnt vmcnt(0)
    v_xor_b32 v130, v13, v240
    v_bitop3_b32 v130, v130, v241, v224 bitop3:0xf6
    v_bitop3_b32 v130, v130, v242, v13 bitop3:0xf6
    v_bitop3_b32 v130, v130, v243, v224 bitop3:0xf6
    v_and_or_b32 v131, v130, s39, v131
    v_cmp_ne_u32 vcc, 0, v131
    s_nop 0
    s_and_b32 vcc_hi, vcc_hi, 0xffff
    s_cmp_eq_u64 vcc, 0
    s_cbranch_scc0 L_spin_est
L_ret_est:
    s_mov_b32 exec_hi, 0xffff
    ds_write_b128 v207, v[228:231] offset:0
    ds_write_b128 v207, v[232:235] offset:3072
    ds_write_b128 v207, v[236:239] offset:6144
    ds_write_b128 v207, v[240:243] offset:9216
    s_mov_b32 exec_hi, -1
    s_waitcnt lgkmcnt(0)
    s_barrier
    s_nop 0
    ds_read_b64 v[138:139], v225 offset:9216
    ds_read_b64 v[140:141], v225 offset:9344
    ds_read_b64 v[142:143], v225 offset:9472
    ds_read_b64 v[132:133], v225 offset:6144
    ds_read_b64 v[134:135], v225 offset:6272
    ds_read_b64 v[136:137], v225 offset:6400
    ds_read_b64 v[214:215], v225 offset:3072
    ds_read_b64 v[216:217], v225 offset:3200
    ds_read_b64 v[218:219], v225 offset:3328
    ds_read_b64 v[208:209], v225 offset:0
    ds_read_b64 v[210:211], v225 offset:128
    ds_read_b64 v[212:213], v225 offset:256
    s_waitcnt lgkmcnt(8)
    v_pk_fma_f32 v[132:133], v[174:175], v[138:139], v[132:133] op_sel:[0,0,0] op_sel_hi:[0,1,1]
    s_waitcnt lgkmcnt(7)
    v_pk_fma_f32 v[134:135], v[186:187], v[140:141], v[134:135] op_sel:[0,0,0] op_sel_hi:[0,1,1]
    s_waitcnt lgkmcnt(6)
    v_pk_fma_f32 v[136:137], v[198:199], v[142:143], v[136:137] op_sel:[0,0,0] op_sel_hi:[0,1,1]
    v_pk_fma_f32 v[132:133], v[174:175], v[138:139], v[132:133] op_sel:[1,1,0] op_sel_hi:[1,0,1] neg_lo:[1,0,0]
    v_pk_fma_f32 v[134:135], v[186:187], v[140:141], v[134:135] op_sel:[1,1,0] op_sel_hi:[1,0,1] neg_lo:[1,0,0]
    v_pk_fma_f32 v[136:137], v[198:199], v[142:143], v[136:137] op_sel:[1,1,0] op_sel_hi:[1,0,1] neg_lo:[1,0,0]
    s_waitcnt lgkmcnt(5)
    v_pk_fma_f32 v[214:215], v[174:175], v[132:133], v[214:215] op_sel:[0,0,0] op_sel_hi:[0,1,1]
    s_waitcnt lgkmcnt(4)
    v_pk_fma_f32 v[216:217], v[186:187], v[134:135], v[216:217] op_sel:[0,0,0] op_sel_hi:[0,1,1]
    s_waitcnt lgkmcnt(3)
    v_pk_fma_f32 v[218:219], v[198:199], v[136:137], v[218:219] op_sel:[0,0,0] op_sel_hi:[0,1,1]
    v_pk_fma_f32 v[214:215], v[174:175], v[132:133], v[214:215] op_sel:[1,1,0] op_sel_hi:[1,0,1] neg_lo:[1,0,0]
    v_pk_fma_f32 v[216:217], v[186:187], v[134:135], v[216:217] op_sel:[1,1,0] op_sel_hi:[1,0,1] neg_lo:[1,0,0]
    v_pk_fma_f32 v[218:219], v[198:199], v[136:137], v[218:219] op_sel:[1,1,0] op_sel_hi:[1,0,1] neg_lo:[1,0,0]
    s_waitcnt lgkmcnt(2)
    v_pk_fma_f32 v[208:209], v[174:175], v[214:215], v[208:209] op_sel:[0,0,0] op_sel_hi:[0,1,1]
    s_waitcnt lgkmcnt(1)
    v_pk_fma_f32 v[210:211], v[186:187], v[216:217], v[210:211] op_sel:[0,0,0] op_sel_hi:[0,1,1]
    s_waitcnt lgkmcnt(0)
    s_nop 0
    v_pk_fma_f32 v[212:213], v[198:199], v[218:219], v[212:213] op_sel:[0,0,0] op_sel_hi:[0,1,1]
    v_pk_fma_f32 v[208:209], v[174:175], v[214:215], v[208:209] op_sel:[1,1,0] op_sel_hi:[1,0,1] neg_lo:[1,0,0]
    v_pk_fma_f32 v[210:211], v[186:187], v[216:217], v[210:211] op_sel:[1,1,0] op_sel_hi:[1,0,1] neg_lo:[1,0,0]
    v_pk_fma_f32 v[212:213], v[198:199], v[218:219], v[212:213] op_sel:[1,1,0] op_sel_hi:[1,0,1] neg_lo:[1,0,0]
    v_pk_mul_f32 v[112:113], v[176:177], v[208:209] op_sel:[0,0] op_sel_hi:[0,1]
    v_pk_mul_f32 v[114:115], v[188:189], v[210:211] op_sel:[0,0] op_sel_hi:[0,1]
    v_pk_mul_f32 v[116:117], v[200:201], v[212:213] op_sel:[0,0] op_sel_hi:[0,1]
    v_pk_fma_f32 v[112:113], v[176:177], v[208:209], v[112:113] op_sel:[1,1,0] op_sel_hi:[1,0,1] neg_lo:[1,0,0]
    v_pk_fma_f32 v[114:115], v[188:189], v[210:211], v[114:115] op_sel:[1,1,0] op_sel_hi:[1,0,1] neg_lo:[1,0,0]
    v_pk_fma_f32 v[116:117], v[200:201], v[212:213], v[116:117] op_sel:[1,1,0] op_sel_hi:[1,0,1] neg_lo:[1,0,0]
    v_mov_b64 v[118:119], v[112:113]
    v_mov_b64 v[120:121], v[114:115]
    v_mov_b64 v[122:123], v[116:117]
    v_permlane16_swap_b32 v112, v118
    v_permlane16_swap_b32 v113, v119
    v_permlane16_swap_b32 v114, v120
    v_permlane16_swap_b32 v115, v121
    v_permlane16_swap_b32 v116, v122
    v_permlane16_swap_b32 v117, v123
    v_pk_add_f32 v[112:113], v[112:113], v[118:119]
    v_pk_add_f32 v[114:115], v[114:115], v[120:121]
    v_pk_add_f32 v[116:117], v[116:117], v[122:123]
    v_mov_b64 v[118:119], v[112:113]
    v_mov_b64 v[120:121], v[114:115]
    v_mov_b64 v[122:123], v[116:117]
    v_permlane32_swap_b32 v112, v118
    v_permlane32_swap_b32 v113, v119
    v_permlane32_swap_b32 v114, v120
    v_permlane32_swap_b32 v115, v121
    v_permlane32_swap_b32 v116, v122
    v_permlane32_swap_b32 v117, v123
    v_pk_add_f32 v[112:113], v[112:113], v[118:119]
    v_pk_add_f32 v[114:115], v[114:115], v[120:121]
    v_pk_add_f32 v[116:117], v[116:117], v[122:123]
    v_pk_fma_f32 v[146:147], v[178:179], v[112:113], v[146:147] op_sel:[0,0,0] op_sel_hi:[0,1,1]
    v_pk_fma_f32 v[146:147], v[178:179], v[112:113], v[146:147] op_sel:[1,1,0] op_sel_hi:[1,0,1] neg_lo:[1,0,0]
    v_fma_f32 v157, v170, v146, v156
    v_fma_f32 v159, v170, v147, v158
    v_fma_f32 v157, -v171, v147, v157
    v_fma_f32 v159, v171, v146, v159
    v_mov_b32 v156, v146
    v_mov_b32 v158, v147
    v_pk_fma_f32 v[150:151], v[190:191], v[114:115], v[150:151] op_sel:[0,0,0] op_sel_hi:[0,1,1]
    v_pk_fma_f32 v[150:151], v[190:191], v[114:115], v[150:151] op_sel:[1,1,0] op_sel_hi:[1,0,1] neg_lo:[1,0,0]
    v_fma_f32 v161, v182, v150, v160
    v_fma_f32 v163, v182, v151, v162
    v_fma_f32 v161, -v183, v151, v161
    v_fma_f32 v163, v183, v150, v163
    v_mov_b32 v160, v150
    v_mov_b32 v162, v151
    v_pk_fma_f32 v[154:155], v[202:203], v[116:117], v[154:155] op_sel:[0,0,0] op_sel_hi:[0,1,1]
    v_pk_fma_f32 v[154:155], v[202:203], v[116:117], v[154:155] op_sel:[1,1,0] op_sel_hi:[1,0,1] neg_lo:[1,0,0]
    v_fma_f32 v165, v194, v154, v164
    v_fma_f32 v167, v194, v155, v166
    v_fma_f32 v165, -v195, v155, v165
    v_fma_f32 v167, v195, v154, v167
    v_mov_b32 v164, v154
    v_mov_b32 v166, v155
    v_mov_b64 v[140:141], v[180:181]
    v_mov_b64 v[142:143], v[192:193]
    s_cmp_eq_u32 s24, s55
    s_cselect_b32 s24, s25, s24
    s_cmp_eq_u32 s24, s55
    s_cselect_b32 s24, s26, s24
    s_cmp_eq_u32 s24, s55
    s_cselect_b32 s24, s27, s24
    s_cmp_eq_u32 s24, s55
    s_cbranch_scc0 L_spin_sy_a01
L_ret_sy_a01:
    v_pk_fma_f32 v[16:17], v[168:169], v[156:157], v[16:17] op_sel:[0,0,0] op_sel_hi:[0,1,1]
    v_pk_fma_f32 v[32:33], v[168:169], v[158:159], v[32:33] op_sel:[0,0,0] op_sel_hi:[0,1,1]
    v_pk_fma_f32 v[16:17], v[168:169], v[158:159], v[16:17] op_sel:[1,0,0] op_sel_hi:[1,1,1] neg_lo:[1,0,0] neg_hi:[1,0,0]
    v_pk_fma_f32 v[32:33], v[168:169], v[156:157], v[32:33] op_sel:[1,0,0] op_sel_hi:[1,1,1]
    v_pk_fma_f32 v[18:19], v[168:169], v[16:17], v[18:19] op_sel:[0,0,0] op_sel_hi:[0,1,1]
    v_pk_fma_f32 v[34:35], v[168:169], v[32:33], v[34:35] op_sel:[0,0,0] op_sel_hi:[0,1,1]
    v_pk_fma_f32 v[18:19], v[168:169], v[32:33], v[18:19] op_sel:[1,0,0] op_sel_hi:[1,1,1] neg_lo:[1,0,0] neg_hi:[1,0,0]
    v_pk_fma_f32 v[34:35], v[168:169], v[16:17], v[34:35] op_sel:[1,0,0] op_sel_hi:[1,1,1]
    s_add_u32 s67, s40, 0
    s_nop 0
    buffer_load_dwordx4 v[176:179], v1, s[8:11], s67 offen sc1
    v_cvt_pk_bf16_f32 v124, v16, v18
    v_cvt_pk_bf16_f32 v128, v17, v19
    v_cvt_pk_bf16_f32 v132, v32, v34
    v_cvt_pk_bf16_f32 v136, v33, v35
    v_pk_fma_f32 v[20:21], v[168:169], v[18:19], v[20:21] op_sel:[0,0,0] op_sel_hi:[0,1,1]
    v_pk_fma_f32 v[36:37], v[168:169], v[34:35], v[36:37] op_sel:[0,0,0] op_sel_hi:[0,1,1]
    v_pk_fma_f32 v[20:21], v[168:169], v[34:35], v[20:21] op_sel:[1,0,0] op_sel_hi:[1,1,1] neg_lo:[1,0,0] neg_hi:[1,0,0]
    v_pk_fma_f32 v[36:37], v[168:169], v[18:19], v[36:37] op_sel:[1,0,0] op_sel_hi:[1,1,1]
    buffer_load_dwordx4 v[180:183], v2, s[8:11], s67 offen sc1
    v_pk_fma_f32 v[22:23], v[168:169], v[20:21], v[22:23] op_sel:[0,0,0] op_sel_hi:[0,1,1]
    v_pk_fma_f32 v[38:39], v[168:169], v[36:37], v[38:39] op_sel:[0,0,0] op_sel_hi:[0,1,1]
    v_pk_fma_f32 v[22:23], v[168:169], v[36:37], v[22:23] op_sel:[1,0,0] op_sel_hi:[1,1,1] neg_lo:[1,0,0] neg_hi:[1,0,0]
    v_pk_fma_f32 v[38:39], v[168:169], v[20:21], v[38:39] op_sel:[1,0,0] op_sel_hi:[1,1,1]
    v_cvt_pk_bf16_f32 v125, v20, v22
    v_cvt_pk_bf16_f32 v129, v21, v23
    v_cvt_pk_bf16_f32 v133, v36, v38
    v_cvt_pk_bf16_f32 v137, v37, v39
    buffer_load_dwordx4 v[184:187], v3, s[8:11], s67 offen sc1
    v_pk_fma_f32 v[24:25], v[168:169], v[22:23], v[24:25] op_sel:[0,0,0] op_sel_hi:[0,1,1]
    v_pk_fma_f32 v[40:41], v[168:169], v[38:39], v[40:41] op_sel:[0,0,0] op_sel_hi:[0,1,1]
    v_pk_fma_f32 v[24:25], v[168:169], v[38:39], v[24:25] op_sel:[1,0,0] op_sel_hi:[1,1,1] neg_lo:[1,0,0] neg_hi:[1,0,0]
    v_pk_fma_f32 v[40:41], v[168:169], v[22:23], v[40:41] op_sel:[1,0,0] op_sel_hi:[1,1,1]
    v_pk_fma_f32 v[26:27], v[168:169], v[24:25], v[26:27] op_sel:[0,0,0] op_sel_hi:[0,1,1]
    v_pk_fma_f32 v[42:43], v[168:169], v[40:41], v[42:43] op_sel:[0,0,0] op_sel_hi:[0,1,1]
    v_pk_fma_f32 v[26:27], v[168:169], v[40:41], v[26:27] op_sel:[1,0,0] op_sel_hi:[1,1,1] neg_lo:[1,0,0] neg_hi:[1,0,0]
    v_pk_fma_f32 v[42:43], v[168:169], v[24:25], v[42:43] op_sel:[1,0,0] op_sel_hi:[1,1,1]
    buffer_load_dwordx4 v[188:191], v4, s[8:11], s67 offen sc1
    v_cvt_pk_bf16_f32 v126, v24, v26
    v_cvt_pk_bf16_f32 v130, v25, v27
    v_cvt_pk_bf16_f32 v134, v40, v42
    v_cvt_pk_bf16_f32 v138, v41, v43
    v_pk_fma_f32 v[28:29], v[168:169], v[26:27], v[28:29] op_sel:[0,0,0] op_sel_hi:[0,1,1]
    v_pk_fma_f32 v[44:45], v[168:169], v[42:43], v[44:45] op_sel:[0,0,0] op_sel_hi:[0,1,1]
    v_pk_fma_f32 v[28:29], v[168:169], v[42:43], v[28:29] op_sel:[1,0,0] op_sel_hi:[1,1,1] neg_lo:[1,0,0] neg_hi:[1,0,0]
    v_pk_fma_f32 v[44:45], v[168:169], v[26:27], v[44:45] op_sel:[1,0,0] op_sel_hi:[1,1,1]
    s_add_u32 s67, s40, 4096
    buffer_load_dwordx4 v[192:195], v1, s[8:11], s67 offen sc1
    v_pk_fma_f32 v[30:31], v[168:169], v[28:29], v[30:31] op_sel:[0,0,0] op_sel_hi:[0,1,1]
    v_pk_fma_f32 v[46:47], v[168:169], v[44:45], v[46:47] op_sel:[0,0,0] op_sel_hi:[0,1,1]
    v_pk_fma_f32 v[30:31], v[168:169], v[44:45], v[30:31] op_sel:[1,0,0] op_sel_hi:[1,1,1] neg_lo:[1,0,0] neg_hi:[1,0,0]
    v_pk_fma_f32 v[46:47], v[168:169], v[28:29], v[46:47] op_sel:[1,0,0] op_sel_hi:[1,1,1]
    v_cvt_pk_bf16_f32 v127, v28, v30
    v_cvt_pk_bf16_f32 v131, v29, v31
    v_cvt_pk_bf16_f32 v135, v44, v46
    v_cvt_pk_bf16_f32 v139, v45, v47
    buffer_load_dwordx4 v[196:199], v2, s[8:11], s67 offen sc1
    ds_write_b128 v10, v[124:127] offset:0
    ds_write_b128 v10, v[128:131] offset:16
    ds_write_b128 v10, v[132:135] offset:2304
    ds_write_b128 v10, v[136:139] offset:2320
    ds_read_b64_tr_b16 v[208:209], v11 offset:0
    ds_read_b64_tr_b16 v[210:211], v11 offset:576
    ds_read_b64_tr_b16 v[212:213], v11 offset:32
    ds_read_b64_tr_b16 v[214:215], v11 offset:608
    buffer_load_dwordx4 v[200:203], v3, s[8:11], s67 offen sc1
    ds_read_b64_tr_b16 v[216:217], v11 offset:64
    ds_read_b64_tr_b16 v[218:219], v11 offset:640
    ds_read_b64_tr_b16 v[220:221], v11 offset:96
    ds_read_b64_tr_b16 v[222:223], v11 offset:672
    v_pk_fma_f32 v[48:49], v[140:141], v[160:161], v[48:49] op_sel:[0,0,0] op_sel_hi:[0,1,1]
    v_pk_fma_f32 v[64:65], v[140:141], v[162:163], v[64:65] op_sel:[0,0,0] op_sel_hi:[0,1,1]
    v_pk_fma_f32 v[48:49], v[140:141], v[162:163], v[48:49] op_sel:[1,0,0] op_sel_hi:[1,1,1] neg_lo:[1,0,0] neg_hi:[1,0,0]
    v_pk_fma_f32 v[64:65], v[140:141], v[160:161], v[64:65] op_sel:[1,0,0] op_sel_hi:[1,1,1]
    buffer_load_dwordx4 v[204:207], v4, s[8:11], s67 offen sc1
    v_pk_fma_f32 v[50:51], v[140:141], v[48:49], v[50:51] op_sel:[0,0,0] op_sel_hi:[0,1,1]
    v_pk_fma_f32 v[66:67], v[140:141], v[64:65], v[66:67] op_sel:[0,0,0] op_sel_hi:[0,1,1]
    v_pk_fma_f32 v[50:51], v[140:141], v[64:65], v[50:51] op_sel:[1,0,0] op_sel_hi:[1,1,1] neg_lo:[1,0,0] neg_hi:[1,0,0]
    v_pk_fma_f32 v[66:67], v[140:141], v[48:49], v[66:67] op_sel:[1,0,0] op_sel_hi:[1,1,1]
    v_cvt_pk_bf16_f32 v124, v48, v50
    v_cvt_pk_bf16_f32 v128, v49, v51
    v_cvt_pk_bf16_f32 v132, v64, v66
    v_cvt_pk_bf16_f32 v136, v65, v67
    s_add_u32 s67, s40, 8192
    buffer_load_dwordx4 a[240:243], v1, s[8:11], s67 offen sc1
    v_pk_fma_f32 v[52:53], v[140:141], v[50:51], v[52:53] op_sel:[0,0,0] op_sel_hi:[0,1,1]
    v_pk_fma_f32 v[68:69], v[140:141], v[66:67], v[68:69] op_sel:[0,0,0] op_sel_hi:[0,1,1]
    v_pk_fma_f32 v[52:53], v[140:141], v[66:67], v[52:53] op_sel:[1,0,0] op_sel_hi:[1,1,1] neg_lo:[1,0,0] neg_hi:[1,0,0]
    v_pk_fma_f32 v[68:69], v[140:141], v[50:51], v[68:69] op_sel:[1,0,0] op_sel_hi:[1,1,1]
    v_pk_fma_f32 v[54:55], v[140:141], v[52:53], v[54:55] op_sel:[0,0,0] op_sel_hi:[0,1,1]
    v_pk_fma_f32 v[70:71], v[140:141], v[68:69], v[70:71] op_sel:[0,0,0] op_sel_hi:[0,1,1]
    v_pk_fma_f32 v[54:55], v[140:141], v[68:69], v[54:55] op_sel:[1,0,0] op_sel_hi:[1,1,1] neg_lo:[1,0,0] neg_hi:[1,0,0]
    v_pk_fma_f32 v[70:71], v[140:141], v[52:53], v[70:71] op_sel:[1,0,0] op_sel_hi:[1,1,1]
    buffer_load_dwordx4 a[244:247], v2, s[8:11], s67 offen sc1
    v_cvt_pk_bf16_f32 v125, v52, v54
    v_cvt_pk_bf16_f32 v129, v53, v55
    v_cvt_pk_bf16_f32 v133, v68, v70
    v_cvt_pk_bf16_f32 v137, v69, v71
    buffer_load_dwordx4 a[248:251], v3, s[8:11], s67 offen sc1
    buffer_load_dwordx4 a[252:255], v4, s[8:11], s67 offen sc1
    s_waitcnt lgkmcnt(6)
    buffer_store_dwordx4 v[208:211], v14, s[8:11], s18 offen offset:0 sc1
    s_waitcnt lgkmcnt(4)
    buffer_store_dwordx4 v[212:215], v14, s[8:11], s18 offen offset:1024 sc1
    s_waitcnt lgkmcnt(2)
    buffer_store_dwordx4 v[216:219], v14, s[8:11], s18 offen offset:2048 sc1
    s_waitcnt lgkmcnt(0)
    buffer_store_dwordx4 v[220:223], v14, s[8:11], s18 offen offset:3072 sc1
    v_pk_fma_f32 v[56:57], v[140:141], v[54:55], v[56:57] op_sel:[0,0,0] op_sel_hi:[0,1,1]
    v_pk_fma_f32 v[72:73], v[140:141], v[70:71], v[72:73] op_sel:[0,0,0] op_sel_hi:[0,1,1]
    v_pk_fma_f32 v[56:57], v[140:141], v[70:71], v[56:57] op_sel:[1,0,0] op_sel_hi:[1,1,1] neg_lo:[1,0,0] neg_hi:[1,0,0]
    v_pk_fma_f32 v[72:73], v[140:141], v[54:55], v[72:73] op_sel:[1,0,0] op_sel_hi:[1,1,1]
    v_pk_fma_f32 v[58:59], v[140:141], v[56:57], v[58:59] op_sel:[0,0,0] op_sel_hi:[0,1,1]
    v_pk_fma_f32 v[74:75], v[140:141], v[72:73], v[74:75] op_sel:[0,0,0] op_sel_hi:[0,1,1]
    v_pk_fma_f32 v[58:59], v[140:141], v[72:73], v[58:59] op_sel:[1,0,0] op_sel_hi:[1,1,1] neg_lo:[1,0,0] neg_hi:[1,0,0]
    v_pk_fma_f32 v[74:75], v[140:141], v[56:57], v[74:75] op_sel:[1,0,0] op_sel_hi:[1,1,1]
    v_cvt_pk_bf16_f32 v126, v56, v58
    v_cvt_pk_bf16_f32 v130, v57, v59
    v_cvt_pk_bf16_f32 v134, v72, v74
    v_cvt_pk_bf16_f32 v138, v73, v75
    v_pk_fma_f32 v[60:61], v[140:141], v[58:59], v[60:61] op_sel:[0,0,0] op_sel_hi:[0,1,1]
    v_pk_fma_f32 v[76:77], v[140:141], v[74:75], v[76:77] op_sel:[0,0,0] op_sel_hi:[0,1,1]
    v_pk_fma_f32 v[60:61], v[140:141], v[74:75], v[60:61] op_sel:[1,0,0] op_sel_hi:[1,1,1] neg_lo:[1,0,0] neg_hi:[1,0,0]
    v_pk_fma_f32 v[76:77], v[140:141], v[58:59], v[76:77] op_sel:[1,0,0] op_sel_hi:[1,1,1]
    v_pk_fma_f32 v[62:63], v[140:141], v[60:61], v[62:63] op_sel:[0,0,0] op_sel_hi:[0,1,1]
    v_pk_fma_f32 v[78:79], v[140:141], v[76:77], v[78:79] op_sel:[0,0,0] op_sel_hi:[0,1,1]
    v_pk_fma_f32 v[62:63], v[140:141], v[76:77], v[62:63] op_sel:[1,0,0] op_sel_hi:[1,1,1] neg_lo:[1,0,0] neg_hi:[1,0,0]
    v_pk_fma_f32 v[78:79], v[140:141], v[60:61], v[78:79] op_sel:[1,0,0] op_sel_hi:[1,1,1]
    v_cvt_pk_bf16_f32 v127, v60, v62
    v_cvt_pk_bf16_f32 v131, v61, v63
    v_cvt_pk_bf16_f32 v135, v76, v78
    v_cvt_pk_bf16_f32 v139, v77, v79
    ds_write_b128 v10, v[124:127] offset:0
    ds_write_b128 v10, v[128:131] offset:16
    ds_write_b128 v10, v[132:135] offset:2304
    ds_write_b128 v10, v[136:139] offset:2320
    ds_read_b64_tr_b16 v[224:225], v11 offset:0
    ds_read_b64_tr_b16 v[226:227], v11 offset:576
    ds_read_b64_tr_b16 v[228:229], v11 offset:32
    ds_read_b64_tr_b16 v[230:231], v11 offset:608
    ds_read_b64_tr_b16 v[232:233], v11 offset:64
    ds_read_b64_tr_b16 v[234:235], v11 offset:640
    ds_read_b64_tr_b16 v[236:237], v11 offset:96
    ds_read_b64_tr_b16 v[238:239], v11 offset:672
    v_pk_fma_f32 v[80:81], v[142:143], v[164:165], v[80:81] op_sel:[0,0,0] op_sel_hi:[0,1,1]
    v_pk_fma_f32 v[96:97], v[142:143], v[166:167], v[96:97] op_sel:[0,0,0] op_sel_hi:[0,1,1]
    v_pk_fma_f32 v[80:81], v[142:143], v[166:167], v[80:81] op_sel:[1,0,0] op_sel_hi:[1,1,1] neg_lo:[1,0,0] neg_hi:[1,0,0]
    v_pk_fma_f32 v[96:97], v[142:143], v[164:165], v[96:97] op_sel:[1,0,0] op_sel_hi:[1,1,1]
    v_pk_fma_f32 v[82:83], v[142:143], v[80:81], v[82:83] op_sel:[0,0,0] op_sel_hi:[0,1,1]
    v_pk_fma_f32 v[98:99], v[142:143], v[96:97], v[98:99] op_sel:[0,0,0] op_sel_hi:[0,1,1]
    v_pk_fma_f32 v[82:83], v[142:143], v[96:97], v[82:83] op_sel:[1,0,0] op_sel_hi:[1,1,1] neg_lo:[1,0,0] neg_hi:[1,0,0]
    v_pk_fma_f32 v[98:99], v[142:143], v[80:81], v[98:99] op_sel:[1,0,0] op_sel_hi:[1,1,1]
    v_cvt_pk_bf16_f32 v124, v80, v82
    v_cvt_pk_bf16_f32 v128, v81, v83
    v_cvt_pk_bf16_f32 v132, v96, v98
    v_cvt_pk_bf16_f32 v136, v97, v99
    v_pk_fma_f32 v[84:85], v[142:143], v[82:83], v[84:85] op_sel:[0,0,0] op_sel_hi:[0,1,1]
    v_pk_fma_f32 v[100:101], v[142:143], v[98:99], v[100:101] op_sel:[0,0,0] op_sel_hi:[0,1,1]
    v_pk_fma_f32 v[84:85], v[142:143], v[98:99], v[84:85] op_sel:[1,0,0] op_sel_hi:[1,1,1] neg_lo:[1,0,0] neg_hi:[1,0,0]
    v_pk_fma_f32 v[100:101], v[142:143], v[82:83], v[100:101] op_sel:[1,0,0] op_sel_hi:[1,1,1]
    v_pk_fma_f32 v[86:87], v[142:143], v[84:85], v[86:87] op_sel:[0,0,0] op_sel_hi:[0,1,1]
    v_pk_fma_f32 v[102:103], v[142:143], v[100:101], v[102:103] op_sel:[0,0,0] op_sel_hi:[0,1,1]
    v_pk_fma_f32 v[86:87], v[142:143], v[100:101], v[86:87] op_sel:[1,0,0] op_sel_hi:[1,1,1] neg_lo:[1,0,0] neg_hi:[1,0,0]
    v_pk_fma_f32 v[102:103], v[142:143], v[84:85], v[102:103] op_sel:[1,0,0] op_sel_hi:[1,1,1]
    v_cvt_pk_bf16_f32 v125, v84, v86
    v_cvt_pk_bf16_f32 v129, v85, v87
    v_cvt_pk_bf16_f32 v133, v100, v102
    v_cvt_pk_bf16_f32 v137, v101, v103
    s_waitcnt lgkmcnt(6)
    buffer_store_dwordx4 v[224:227], v14, s[8:11], s19 offen offset:0 sc1
    s_waitcnt lgkmcnt(4)
    buffer_store_dwordx4 v[228:231], v14, s[8:11], s19 offen offset:1024 sc1
    s_waitcnt lgkmcnt(2)
    buffer_store_dwordx4 v[232:235], v14, s[8:11], s19 offen offset:2048 sc1
    s_waitcnt lgkmcnt(0)
    buffer_store_dwordx4 v[236:239], v14, s[8:11], s19 offen offset:3072 sc1
    v_pk_fma_f32 v[88:89], v[142:143], v[86:87], v[88:89] op_sel:[0,0,0] op_sel_hi:[0,1,1]
    v_pk_fma_f32 v[104:105], v[142:143], v[102:103], v[104:105] op_sel:[0,0,0] op_sel_hi:[0,1,1]
    v_pk_fma_f32 v[88:89], v[142:143], v[102:103], v[88:89] op_sel:[1,0,0] op_sel_hi:[1,1,1] neg_lo:[1,0,0] neg_hi:[1,0,0]
    v_pk_fma_f32 v[104:105], v[142:143], v[86:87], v[104:105] op_sel:[1,0,0] op_sel_hi:[1,1,1]
    v_pk_fma_f32 v[90:91], v[142:143], v[88:89], v[90:91] op_sel:[0,0,0] op_sel_hi:[0,1,1]
    v_pk_fma_f32 v[106:107], v[142:143], v[104:105], v[106:107] op_sel:[0,0,0] op_sel_hi:[0,1,1]
    v_pk_fma_f32 v[90:91], v[142:143], v[104:105], v[90:91] op_sel:[1,0,0] op_sel_hi:[1,1,1] neg_lo:[1,0,0] neg_hi:[1,0,0]
    v_pk_fma_f32 v[106:107], v[142:143], v[88:89], v[106:107] op_sel:[1,0,0] op_sel_hi:[1,1,1]
    v_cvt_pk_bf16_f32 v126, v88, v90
    v_cvt_pk_bf16_f32 v130, v89, v91
    v_cvt_pk_bf16_f32 v134, v104, v106
    v_cvt_pk_bf16_f32 v138, v105, v107
    v_pk_fma_f32 v[92:93], v[142:143], v[90:91], v[92:93] op_sel:[0,0,0] op_sel_hi:[0,1,1]
    v_pk_fma_f32 v[108:109], v[142:143], v[106:107], v[108:109] op_sel:[0,0,0] op_sel_hi:[0,1,1]
    v_pk_fma_f32 v[92:93], v[142:143], v[106:107], v[92:93] op_sel:[1,0,0] op_sel_hi:[1,1,1] neg_lo:[1,0,0] neg_hi:[1,0,0]
    v_pk_fma_f32 v[108:109], v[142:143], v[90:91], v[108:109] op_sel:[1,0,0] op_sel_hi:[1,1,1]
    v_pk_fma_f32 v[94:95], v[142:143], v[92:93], v[94:95] op_sel:[0,0,0] op_sel_hi:[0,1,1]
    v_pk_fma_f32 v[110:111], v[142:143], v[108:109], v[110:111] op_sel:[0,0,0] op_sel_hi:[0,1,1]
    v_pk_fma_f32 v[94:95], v[142:143], v[108:109], v[94:95] op_sel:[1,0,0] op_sel_hi:[1,1,1] neg_lo:[1,0,0] neg_hi:[1,0,0]
    v_pk_fma_f32 v[110:111], v[142:143], v[92:93], v[110:111] op_sel:[1,0,0] op_sel_hi:[1,1,1]
    v_cvt_pk_bf16_f32 v127, v92, v94
    v_cvt_pk_bf16_f32 v131, v93, v95
    v_cvt_pk_bf16_f32 v135, v108, v110
    v_cvt_pk_bf16_f32 v139, v109, v111
    ds_write_b128 v10, v[124:127] offset:0
    ds_write_b128 v10, v[128:131] offset:16
    ds_write_b128 v10, v[132:135] offset:2304
    ds_write_b128 v10, v[136:139] offset:2320
    ds_read_b64_tr_b16 v[208:209], v11 offset:0
    ds_read_b64_tr_b16 v[210:211], v11 offset:576
    ds_read_b64_tr_b16 v[212:213], v11 offset:32
    ds_read_b64_tr_b16 v[214:215], v11 offset:608
    ds_read_b64_tr_b16 v[216:217], v11 offset:64
    ds_read_b64_tr_b16 v[218:219], v11 offset:640
    ds_read_b64_tr_b16 v[220:221], v11 offset:96
    ds_read_b64_tr_b16 v[222:223], v11 offset:672
    s_waitcnt lgkmcnt(6)
    buffer_store_dwordx4 v[208:211], v14, s[8:11], s20 offen offset:0 sc1
    s_waitcnt lgkmcnt(4)
    buffer_store_dwordx4 v[212:215], v14, s[8:11], s20 offen offset:1024 sc1
    s_waitcnt lgkmcnt(2)
    buffer_store_dwordx4 v[216:219], v14, s[8:11], s20 offen offset:2048 sc1
    s_waitcnt lgkmcnt(0)
    buffer_store_dwordx4 v[220:223], v14, s[8:11], s20 offen offset:3072 sc1
    s_buffer_load_dwordx8 s[24:31], s[8:11], s42 offset:16 glc
    s_waitcnt vmcnt(8)
    s_mov_b64 exec, 1
    buffer_store_dword v13, v14, s[8:11], s21 offen sc1
    s_mov_b64 exec, -1
    v_and_b32 v12, 15, v0
    v_lshrrev_b32 v11, 4, v0
    v_lshlrev_b32 v11, 3, v11
    s_mul_i32 s64, s52, 3072
    s_add_u32 s64, s64, 122880
    v_add_u32 v8, s64, v11
    v_mul_u32_u24 v6, 160, v12
    v_add_u32 v5, v6, v8
    s_sub_u32 s65, s52, 1
    s_and_b32 s65, s65, 3
    s_mul_i32 s64, s65, 3072
    s_add_u32 s64, s64, 122880
    v_add3_u32 v6, v6, v11, s64
    v_lshlrev_b32 v12, 3, v12
    v_add_u32 v254, s64, v12
    ds_read_b64 v[254:255], v254 offset:2880
    ds_read_b64 v[226:227], v6 offset:0
    ds_read_b64 v[230:231], v6 offset:32
    ds_read_b64 v[234:235], v6 offset:64
    ds_read_b64 v[238:239], v6 offset:96
    ds_read_b64 v[242:243], v6 offset:128
    ds_read_b64 v[98:99], v8 offset:2720
    ds_read_b64 v[102:103], v8 offset:2752
    ds_read_b64 v[106:107], v8 offset:2784
    ds_read_b64 v[110:111], v8 offset:2816
    ds_read_b64 v[114:115], v8 offset:2848
    ds_read_b64 v[244:245], v8 offset:2560
    ds_read_b64 v[246:247], v8 offset:2592
    ds_read_b64 v[248:249], v8 offset:2624
    ds_read_b64 v[250:251], v8 offset:2656
    ds_read_b64 v[252:253], v8 offset:2688
    v_mfma_f32_16x16x32_bf16 v[16:19], a[0:3], v[176:179], 0
    s_lshl_b32 s64, s65, 7
    s_andn2_b32 s48, s48, 0x180
    v_mfma_f32_16x16x32_bf16 v[20:23], a[4:7], v[176:179], 0
    s_add_u32 s48, s48, s64
    v_mul_u32_u24 v10, 160, v12
    v_add3_u32 v10, v10, v11, s46
    v_mfma_f32_16x16x32_bf16 v[24:27], a[8:11], v[176:179], 0
    v_lshlrev_b32 v10, 1, v10
    s_mul_i32 s64, s65, 5120
    v_mfma_f32_16x16x32_bf16 v[28:31], a[12:15], v[176:179], 0
    v_add_u32 v7, s64, v14
    v_lshl_add_u32 v6, v0, 2, s64
    v_mfma_f32_16x16x32_bf16 v[32:35], a[16:19], v[176:179], 0
    s_mul_i32 m0, s52, 5120
    v_add_u32 v11, m0, v14
    v_mfma_f32_16x16x32_bf16 v[36:39], a[0:3], v[180:183], 0
    v_and_b32 v9, 7, v0
    v_min_u32 v9, 4, v9
    v_mfma_f32_16x16x32_bf16 v[40:43], a[4:7], v[180:183], 0
    v_lshl_add_u32 v9, v9, 2, s42
    v_and_b32 v8, 8, v0
    v_mfma_f32_16x16x32_bf16 v[44:47], a[8:11], v[180:183], 0
    v_lshlrev_b32 v8, 6, v8
    v_xor_b32 v9, v9, v8
    v_mfma_f32_16x16x32_bf16 v[48:51], a[12:15], v[180:183], 0
    s_mul_i32 s64, s52, 15360
    v_add_u32 v8, s64, v14
    s_mov_b32 s72, 0x07060100
    v_mfma_f32_16x16x32_bf16 v[52:55], a[16:19], v[180:183], 0
    s_add_u32 s65, s45, 3072
    s_add_u32 s74, s44, 3072
    v_mfma_f32_16x16x32_bf16 v[56:59], a[0:3], v[184:187], 0
    s_mov_b32 s68, 0xbfb8aa3b
    s_mov_b32 s69, 0xbfb8aa3b
    v_mfma_f32_16x16x32_bf16 v[60:63], a[4:7], v[184:187], 0
    v_mfma_f32_16x16x32_bf16 v[64:67], a[8:11], v[184:187], 0
    v_mfma_f32_16x16x32_bf16 v[68:71], a[12:15], v[184:187], 0
    s_add_u32 s67, s40, 12288
    v_mfma_f32_16x16x32_bf16 v[72:75], a[16:19], v[184:187], 0
    buffer_load_dwordx4 v[208:211], v1, s[8:11], s67 offen sc1
    v_mfma_f32_16x16x32_bf16 v[76:79], a[0:3], v[188:191], 0
    v_mfma_f32_16x16x32_bf16 v[80:83], a[4:7], v[188:191], 0
    v_mfma_f32_16x16x32_bf16 v[84:87], a[8:11], v[188:191], 0
    v_mfma_f32_16x16x32_bf16 v[88:91], a[12:15], v[188:191], 0
    buffer_load_dwordx4 v[212:215], v2, s[8:11], s67 offen sc1
    v_mfma_f32_16x16x32_bf16 v[92:95], a[16:19], v[188:191], 0
    v_mfma_f32_16x16x32_bf16 v[16:19], a[20:23], v[192:195], v[16:19]
    v_mfma_f32_16x16x32_bf16 v[20:23], a[24:27], v[192:195], v[20:23]
    s_cmp_lg_u32 s3, 0
    s_waitcnt lgkmcnt(0)
    s_cselect_b32 s26, s55, s26
    v_mfma_f32_16x16x32_bf16 v[24:27], a[28:31], v[192:195], v[24:27]
    buffer_load_dwordx4 v[216:219], v3, s[8:11], s67 offen sc1
    v_mfma_f32_16x16x32_bf16 v[28:31], a[32:35], v[192:195], v[28:31]
    s_cmp_eq_u32 s24, s55
    s_cselect_b32 s24, s25, s24
    v_mfma_f32_16x16x32_bf16 v[32:35], a[36:39], v[192:195], v[32:35]
    s_cmp_eq_u32 s24, s55
    s_cselect_b32 s24, s26, s24
    v_mfma_f32_16x16x32_bf16 v[36:39], a[20:23], v[196:199], v[36:39]
    s_cmp_eq_u32 s24, s55
    s_cbranch_scc0 L_spin_sy_a2
L_ret_sy_a2:
    v_mfma_f32_16x16x32_bf16 v[40:43], a[24:27], v[196:199], v[40:43]
    buffer_load_dwordx4 v[220:223], v4, s[8:11], s67 offen sc1
    v_lshlrev_b32 v96, 16, v98
    v_mfma_f32_16x16x32_bf16 v[44:47], a[28:31], v[196:199], v[44:47]
    s_add_u32 s63, s63, 5120
    buffer_load_dwordx4 a[180:183], v14, s[8:11], s63 offen offset:0 sc1
    v_and_b32 v97, 0xffff0000, v98
    v_mfma_f32_16x16x32_bf16 v[48:51], a[32:35], v[196:199], v[48:51]
    s_add_u32 s67, s40, 16384
    v_lshlrev_b32 v98, 16, v99
    v_and_b32 v99, 0xffff0000, v99
    v_mfma_f32_16x16x32_bf16 v[52:55], a[36:39], v[196:199], v[52:55]
    v_lshlrev_b32 v100, 16, v102
    v_and_b32 v101, 0xffff0000, v102
    v_mfma_f32_16x16x32_bf16 v[56:59], a[20:23], v[200:203], v[56:59]
    buffer_load_dwordx4 v[136:139], v2, s[8:11], s67 offen sc1
    v_lshlrev_b32 v102, 16, v103
    v_mfma_f32_16x16x32_bf16 v[60:63], a[24:27], v[200:203], v[60:63]
    s_waitcnt vmcnt(11)
    s_mov_b64 exec, 1
    buffer_store_dword v13, v14, s[8:11], s22 offen sc1
    s_mov_b64 exec, -1
    v_mfma_f32_16x16x32_bf16 v[64:67], a[28:31], v[200:203], v[64:67]
    v_and_b32 v103, 0xffff0000, v103
    v_lshlrev_b32 v104, 16, v106
    v_mfma_f32_16x16x32_bf16 v[68:71], a[32:35], v[200:203], v[68:71]
    s_add_u32 s67, s40, 20480
    v_and_b32 v105, 0xffff0000, v106
    v_lshlrev_b32 v106, 16, v107
    v_mfma_f32_16x16x32_bf16 v[72:75], a[36:39], v[200:203], v[72:75]
    buffer_load_dwordx4 v[140:143], v2, s[8:11], s67 offen sc1
    v_and_b32 v107, 0xffff0000, v107
    v_mfma_f32_16x16x32_bf16 v[76:79], a[20:23], v[204:207], v[76:79]
    v_lshlrev_b32 v108, 16, v110
    v_and_b32 v109, 0xffff0000, v110
    v_mfma_f32_16x16x32_bf16 v[80:83], a[24:27], v[204:207], v[80:83]
    v_lshlrev_b32 v110, 16, v111
    v_and_b32 v111, 0xffff0000, v111
    v_mfma_f32_16x16x32_bf16 v[84:87], a[28:31], v[204:207], v[84:87]
    s_buffer_load_dwordx8 s[32:39], s[8:11], s43 offset:0 glc
    s_add_u32 s67, s40, 24576
    s_or_b32 s67, s67, s3
    v_mfma_f32_16x16x32_bf16 v[88:91], a[32:35], v[204:207], v[88:91]
    buffer_load_dwordx4 v[144:147], v2, s[8:11], s67 offen sc1
    v_lshlrev_b32 v112, 16, v114
    v_mfma_f32_16x16x32_bf16 v[92:95], a[36:39], v[204:207], v[92:95]
    v_and_b32 v113, 0xffff0000, v114
    v_lshlrev_b32 v114, 16, v115
    v_mfma_f32_16x16x32_bf16 v[16:19], a[40:43], a[240:243], v[16:19]
    buffer_load_dwordx4 a[184:187], v14, s[8:11], s63 offen offset:1024 sc1
    v_and_b32 v115, 0xffff0000, v115
    v_mfma_f32_16x16x32_bf16 v[20:23], a[44:47], a[240:243], v[20:23]
    s_add_u32 s67, s40, 16384
    v_cmp_ne_u32 vcc, s55, v255
    s_nop 3
    s_cbranch_vccnz L_spin_sy_st
L_ret_sy_st:
    v_mfma_f32_16x16x32_bf16 v[24:27], a[48:51], a[240:243], v[24:27]
    buffer_load_dwordx4 v[148:151], v3, s[8:11], s67 offen sc1
    v_and_b32 v255, 0xffff0000, v254
    v_mfma_f32_16x16x32_bf16 v[28:31], a[52:55], a[240:243], v[28:31]
    v_rcp_f32 v255, v255
    v_mfma_f32_16x16x32_bf16 v[32:35], a[56:59], a[240:243], v[32:35]
    v_lshlrev_b32 v254, 16, v254
    v_mul_f32 v254, v254, v255
    v_mfma_f32_16x16x32_bf16 v[36:39], a[40:43], a[244:247], v[36:39]
    s_add_u32 s67, s40, 20480
    v_lshlrev_b32 v224, 16, v226
    v_and_b32 v225, 0xffff0000, v226
    v_mfma_f32_16x16x32_bf16 v[40:43], a[44:47], a[244:247], v[40:43]
    buffer_load_dwordx4 v[152:155], v3, s[8:11], s67 offen sc1
    v_lshlrev_b32 v226, 16, v227
    v_mfma_f32_16x16x32_bf16 v[44:47], a[48:51], a[244:247], v[44:47]
    v_and_b32 v227, 0xffff0000, v227
    v_fma_f32 v224, v224, v255, v254
    v_mfma_f32_16x16x32_bf16 v[48:51], a[52:55], a[244:247], v[48:51]
    v_fma_f32 v225, v225, v255, v254
    v_fma_f32 v226, v226, v255, v254
    v_mfma_f32_16x16x32_bf16 v[52:55], a[56:59], a[244:247], v[52:55]
    s_add_u32 s67, s40, 24576
    s_or_b32 s67, s67, s3
    v_mfma_f32_16x16x32_bf16 v[56:59], a[40:43], a[248:251], v[56:59]
    buffer_load_dwordx4 v[156:159], v3, s[8:11], s67 offen sc1
    v_fma_f32 v227, v227, v255, v254
    v_mfma_f32_16x16x32_bf16 v[60:63], a[44:47], a[248:251], v[60:63]
    v_lshlrev_b32 v228, 16, v230
    v_and_b32 v229, 0xffff0000, v230
    v_mfma_f32_16x16x32_bf16 v[64:67], a[48:51], a[248:251], v[64:67]
    v_lshlrev_b32 v230, 16, v231
    v_and_b32 v231, 0xffff0000, v231
    v_mfma_f32_16x16x32_bf16 v[68:71], a[52:55], a[248:251], v[68:71]
    s_add_u32 s67, s40, 16384
    buffer_load_dwordx4 a[188:191], v14, s[8:11], s63 offen offset:2048 sc1
    v_fma_f32 v228, v228, v255, v254
    v_mfma_f32_16x16x32_bf16 v[72:75], a[56:59], a[248:251], v[72:75]
    buffer_load_dwordx4 v[160:163], v4, s[8:11], s67 offen sc1
    v_fma_f32 v229, v229, v255, v254
    v_mfma_f32_16x16x32_bf16 v[76:79], a[40:43], a[252:255], v[76:79]
    v_fma_f32 v230, v230, v255, v254
    v_fma_f32 v231, v231, v255, v254
    v_mfma_f32_16x16x32_bf16 v[80:83], a[44:47], a[252:255], v[80:83]
    v_lshlrev_b32 v232, 16, v234
    v_and_b32 v233, 0xffff0000, v234
    v_mfma_f32_16x16x32_bf16 v[84:87], a[48:51], a[252:255], v[84:87]
    s_add_u32 s67, s40, 20480
    v_lshlrev_b32 v234, 16, v235
    v_and_b32 v235, 0xffff0000, v235
    v_mfma_f32_16x16x32_bf16 v[88:91], a[52:55], a[252:255], v[88:91]
    buffer_load_dwordx4 v[164:167], v4, s[8:11], s67 offen sc1
    v_fma_f32 v232, v232, v255, v254
    v_mfma_f32_16x16x32_bf16 v[92:95], a[56:59], a[252:255], v[92:95]
    s_waitcnt vmcnt(15)
    v_fma_f32 v233, v233, v255, v254
    v_fma_f32 v234, v234, v255, v254
    v_mfma_f32_16x16x32_bf16 v[16:19], a[60:63], v[208:211], v[16:19]
    s_mov_b64 exec, 1
    buffer_store_dword v13, v14, s[8:11], s23 offen sc1
    s_mov_b64 exec, -1
    v_mfma_f32_16x16x32_bf16 v[20:23], a[64:67], v[208:211], v[20:23]
    s_add_u32 s67, s40, 24576
    s_or_b32 s67, s67, s3
    v_mfma_f32_16x16x32_bf16 v[24:27], a[68:71], v[208:211], v[24:27]
    buffer_load_dwordx4 v[168:171], v4, s[8:11], s67 offen sc1
    v_fma_f32 v235, v235, v255, v254
    v_mfma_f32_16x16x32_bf16 v[28:31], a[72:75], v[208:211], v[28:31]
    v_lshlrev_b32 v236, 16, v238
    v_and_b32 v237, 0xffff0000, v238
    v_mfma_f32_16x16x32_bf16 v[32:35], a[76:79], v[208:211], v[32:35]
    s_waitcnt vmcnt(16)
    v_lshlrev_b32 v238, 16, v239
    v_and_b32 v239, 0xffff0000, v239
    v_mfma_f32_16x16x32_bf16 v[36:39], a[60:63], v[212:215], v[36:39]
    s_add_u32 s67, s40, 16384
    s_cmp_lg_u32 s3, 0
    s_waitcnt lgkmcnt(0)
    s_cselect_b32 s38, s55, s38
    v_mfma_f32_16x16x32_bf16 v[40:43], a[64:67], v[212:215], v[40:43]
    buffer_load_dwordx4 v[172:175], v1, s[8:11], s67 offen sc1
    buffer_load_dwordx4 a[192:195], v14, s[8:11], s63 offen offset:3072 sc1
    v_mfma_f32_16x16x32_bf16 v[44:47], a[68:71], v[212:215], v[44:47]
    s_cmp_eq_u32 s32, s55
    s_cselect_b32 s32, s33, s32
    v_fma_f32 v236, v236, v255, v254
    v_mfma_f32_16x16x32_bf16 v[48:51], a[72:75], v[212:215], v[48:51]
    s_add_u32 s67, s40, 20480
    s_cmp_eq_u32 s32, s55
    s_cselect_b32 s32, s34, s32
    v_mfma_f32_16x16x32_bf16 v[52:55], a[76:79], v[212:215], v[52:55]
    s_waitcnt vmcnt(17)
    s_cmp_eq_u32 s32, s55
    s_cselect_b32 s32, s35, s32
    v_mfma_f32_16x16x32_bf16 v[56:59], a[60:63], v[216:219], v[56:59]
    buffer_load_dwordx4 v[176:179], v1, s[8:11], s67 offen sc1
    v_fma_f32 v237, v237, v255, v254
    v_mfma_f32_16x16x32_bf16 v[60:63], a[64:67], v[216:219], v[60:63]
    s_cmp_eq_u32 s32, s55
    s_cselect_b32 s32, s36, s32
    v_fma_f32 v238, v238, v255, v254
    v_mfma_f32_16x16x32_bf16 v[64:67], a[68:71], v[216:219], v[64:67]
    s_cmp_eq_u32 s32, s55
    s_cselect_b32 s32, s37, s32
    v_fma_f32 v239, v239, v255, v254
    v_mfma_f32_16x16x32_bf16 v[68:71], a[72:75], v[216:219], v[68:71]
    s_cmp_eq_u32 s32, s55
    s_cselect_b32 s32, s38, s32
    v_lshlrev_b32 v240, 16, v242
    v_mfma_f32_16x16x32_bf16 v[72:75], a[76:79], v[216:219], v[72:75]
    s_waitcnt vmcnt(17)
    s_add_u32 s67, s40, 24576
    s_or_b32 s67, s67, s3
    v_mfma_f32_16x16x32_bf16 v[76:79], a[60:63], v[220:223], v[76:79]
    buffer_load_dwordx4 v[180:183], v1, s[8:11], s67 offen sc1
    v_and_b32 v241, 0xffff0000, v242
    v_mfma_f32_16x16x32_bf16 v[80:83], a[64:67], v[220:223], v[80:83]
    s_cmp_eq_u32 s32, s55
    s_cbranch_scc0 L_spin_sy_a3
L_ret_sy_a3:
    v_lshlrev_b32 v242, 16, v243
    v_mfma_f32_16x16x32_bf16 v[84:87], a[68:71], v[220:223], v[84:87]
    v_and_b32 v243, 0xffff0000, v243
    v_fma_f32 v240, v240, v255, v254
    v_mfma_f32_16x16x32_bf16 v[88:91], a[72:75], v[220:223], v[88:91]
    s_add_u32 s67, s41, 0
    v_fma_f32 v241, v241, v255, v254
    v_fma_f32 v242, v242, v255, v254
    v_mfma_f32_16x16x32_bf16 v[92:95], a[76:79], v[220:223], v[92:95]
    s_waitcnt vmcnt(16)
    buffer_load_dwordx4 a[196:199], v15, s[8:11], s63 offen sc1
    v_fma_f32 v243, v243, v255, v254
    v_mfma_f32_16x16x32_bf16 v[36:39], a[80:83], v[136:139], v[36:39]
    buffer_load_dwordx4 v[184:187], v4, s[8:11], s67 offen sc1
    v_lshlrev_b32 v12, 16, v244
    v_mfma_f32_16x16x32_bf16 v[40:43], a[84:87], v[136:139], v[40:43]
    v_mul_f32 v224, v224, v12
    v_and_b32 v12, 0xffff0000, v244
    v_mfma_f32_16x16x32_bf16 v[44:47], a[88:91], v[136:139], v[44:47]
    v_mul_f32 v225, v225, v12
    v_lshlrev_b32 v12, 16, v245
    v_mfma_f32_16x16x32_bf16 v[48:51], a[92:95], v[136:139], v[48:51]
    s_add_u32 s67, s41, 4096
    v_mul_f32 v226, v226, v12
    v_and_b32 v12, 0xffff0000, v245
    v_mfma_f32_16x16x32_bf16 v[52:55], a[96:99], v[136:139], v[52:55]
    s_waitcnt vmcnt(16)
    buffer_load_dwordx4 v[188:191], v4, s[8:11], s67 offen sc1
    v_mul_f32 v227, v227, v12
    v_mfma_f32_16x16x32_bf16 v[36:39], a[100:103], v[140:143], v[36:39]
    v_lshlrev_b32 v12, 16, v246
    v_mul_f32 v228, v228, v12
    v_mfma_f32_16x16x32_bf16 v[40:43], a[104:107], v[140:143], v[40:43]
    s_barrier
    v_and_b32 v12, 0xffff0000, v246
    v_mfma_f32_16x16x32_bf16 v[44:47], a[108:111], v[140:143], v[44:47]
    s_add_u32 s67, s41, 8192
    v_mul_f32 v229, v229, v12
    v_lshlrev_b32 v12, 16, v247
    v_mfma_f32_16x16x32_bf16 v[48:51], a[112:115], v[140:143], v[48:51]
    buffer_load_dwordx4 v[192:195], v4, s[8:11], s67 offen sc1
    v_mul_f32 v230, v230, v12
    v_mfma_f32_16x16x32_bf16 v[52:55], a[116:119], v[140:143], v[52:55]
    s_waitcnt vmcnt(17)
    v_and_b32 v12, 0xffff0000, v247
    v_mul_f32 v231, v231, v12
    v_mfma_f32_16x16x32_bf16 v[36:39], a[120:123], v[144:147], v[36:39]
    v_lshlrev_b32 v12, 16, v248
    v_mul_f32 v232, v232, v12
    v_mfma_f32_16x16x32_bf16 v[40:43], a[124:127], v[144:147], v[40:43]
    s_add_u32 s67, s41, 12288
    v_and_b32 v12, 0xffff0000, v248
    v_mul_f32 v233, v233, v12
    v_mfma_f32_16x16x32_bf16 v[44:47], a[128:131], v[144:147], v[44:47]
    buffer_load_dwordx4 v[196:199], v4, s[8:11], s67 offen sc1
    v_lshlrev_b32 v12, 16, v249
    v_mfma_f32_16x16x32_bf16 v[48:51], a[132:135], v[144:147], v[48:51]
    s_add_u32 s63, s63, 5120
    buffer_load_dwordx4 a[200:203], v14, s[8:11], s63 offen offset:0 sc1
    v_mul_f32 v234, v234, v12
    v_mfma_f32_16x16x32_bf16 v[52:55], a[136:139], v[144:147], v[52:55]
    s_waitcnt vmcnt(17)
    v_and_b32 v12, 0xffff0000, v249
    v_mul_f32 v235, v235, v12
    v_mfma_f32_16x16x32_bf16 v[56:59], a[80:83], v[148:151], v[56:59]
    s_add_u32 s67, s41, 16384
    ds_write_b128 v8, v[36:39] offset:40960
    v_mfma_f32_16x16x32_bf16 v[60:63], a[84:87], v[148:151], v[60:63]
    buffer_load_dwordx4 v[200:203], v4, s[8:11], s67 offen sc1
    v_lshlrev_b32 v12, 16, v250
    v_mfma_f32_16x16x32_bf16 v[64:67], a[88:91], v[148:151], v[64:67]
    ds_write_b128 v8, v[40:43] offset:41984
    v_mfma_f32_16x16x32_bf16 v[68:71], a[92:95], v[148:151], v[68:71]
    s_add_u32 s67, s41, 20480
    v_mul_f32 v236, v236, v12
    v_and_b32 v12, 0xffff0000, v250
    v_mfma_f32_16x16x32_bf16 v[72:75], a[96:99], v[148:151], v[72:75]
    s_waitcnt vmcnt(17)
    ds_write_b128 v8, v[44:47] offset:43008
    v_mfma_f32_16x16x32_bf16 v[56:59], a[100:103], v[152:155], v[56:59]
    buffer_load_dwordx4 v[204:207], v4, s[8:11], s67 offen sc1
    v_mul_f32 v237, v237, v12
    v_mfma_f32_16x16x32_bf16 v[60:63], a[104:107], v[152:155], v[60:63]
    ds_write_b128 v8, v[48:51] offset:44032
    v_mfma_f32_16x16x32_bf16 v[64:67], a[108:111], v[152:155], v[64:67]
    v_lshlrev_b32 v12, 16, v251
    v_mul_f32 v238, v238, v12
    v_mfma_f32_16x16x32_bf16 v[68:71], a[112:115], v[152:155], v[68:71]
    s_add_u32 s67, s41, 24576
    s_or_b32 s67, s67, s3
    v_mfma_f32_16x16x32_bf16 v[72:75], a[116:119], v[152:155], v[72:75]
    s_waitcnt vmcnt(17)
    buffer_load_dwordx4 a[240:243], v4, s[8:11], s67 offen sc1
    v_and_b32 v12, 0xffff0000, v251
    v_mfma_f32_16x16x32_bf16 v[56:59], a[120:123], v[156:159], v[56:59]
    ds_write_b128 v8, v[52:55] offset:45056
    v_mfma_f32_16x16x32_bf16 v[60:63], a[124:127], v[156:159], v[60:63]
    buffer_load_dwordx4 a[204:207], v14, s[8:11], s63 offen offset:1024 sc1
    v_mul_f32 v239, v239, v12
    v_mfma_f32_16x16x32_bf16 v[64:67], a[128:131], v[156:159], v[64:67]
    v_lshlrev_b32 v12, 16, v252
    v_mul_f32 v240, v240, v12
    v_mfma_f32_16x16x32_bf16 v[68:71], a[132:135], v[156:159], v[68:71]
    v_and_b32 v12, 0xffff0000, v252
    v_mul_f32 v241, v241, v12
    v_mfma_f32_16x16x32_bf16 v[72:75], a[136:139], v[156:159], v[72:75]
    s_waitcnt vmcnt(17)
    v_lshlrev_b32 v12, 16, v253
    v_mul_f32 v242, v242, v12
    v_mfma_f32_16x16x32_bf16 v[76:79], a[80:83], v[160:163], v[76:79]
    ds_write_b128 v8, v[56:59] offset:46080
    v_mfma_f32_16x16x32_bf16 v[80:83], a[84:87], v[160:163], v[80:83]
    v_and_b32 v12, 0xffff0000, v253
    v_mul_f32 v243, v243, v12
    v_mfma_f32_16x16x32_bf16 v[84:87], a[88:91], v[160:163], v[84:87]
    s_sub_u32 s64, s52, 1
    ds_write_b128 v8, v[60:63] offset:47104
    v_mfma_f32_16x16x32_bf16 v[88:91], a[92:95], v[160:163], v[88:91]
    s_add_u32 s67, s41, 0
    s_and_b32 s64, s64, 3
    s_mul_i32 s64, s64, 15360
    v_mfma_f32_16x16x32_bf16 v[92:95], a[96:99], v[160:163], v[92:95]
    s_waitcnt vmcnt(16)
    ds_write_b128 v8, v[64:67] offset:48128
    v_mfma_f32_16x16x32_bf16 v[76:79], a[100:103], v[164:167], v[76:79]
    buffer_load_dwordx4 a[244:247], v3, s[8:11], s67 offen sc1
    v_add_u32 v253, s64, v14
    v_mfma_f32_16x16x32_bf16 v[80:83], a[104:107], v[164:167], v[80:83]
    s_sub_u32 s64, s52, 2
    ds_write_b128 v8, v[68:71] offset:49152
    v_mfma_f32_16x16x32_bf16 v[84:87], a[108:111], v[164:167], v[84:87]
    s_and_b32 s64, s64, 3
    s_mul_i32 s64, s64, 15360
    v_add_u32 v254, s64, v14
    v_mfma_f32_16x16x32_bf16 v[88:91], a[112:115], v[164:167], v[88:91]
    s_add_u32 s67, s41, 4096
    ds_write_b128 v8, v[72:75] offset:50176
    v_mfma_f32_16x16x32_bf16 v[92:95], a[116:119], v[164:167], v[92:95]
    s_waitcnt vmcnt(15)
    buffer_load_dwordx4 a[248:251], v3, s[8:11], s67 offen sc1
    buffer_load_dwordx4 a[208:211], v14, s[8:11], s63 offen offset:2048 sc1
    v_mfma_f32_16x16x32_bf16 v[76:79], a[120:123], v[168:171], v[76:79]
    s_sub_u32 s64, s52, 3
    s_and_b32 s64, s64, 3
    s_mul_i32 s64, s64, 15360
    v_mfma_f32_16x16x32_bf16 v[80:83], a[124:127], v[168:171], v[80:83]
    v_add_u32 v255, s64, v14
    v_mfma_f32_16x16x32_bf16 v[84:87], a[128:131], v[168:171], v[84:87]
    s_add_u32 s67, s41, 8192
    v_mfma_f32_16x16x32_bf16 v[88:91], a[132:135], v[168:171], v[88:91]
    buffer_load_dwordx4 a[252:255], v3, s[8:11], s67 offen sc1
    v_mfma_f32_16x16x32_bf16 v[92:95], a[136:139], v[168:171], v[92:95]
    s_waitcnt vmcnt(17) lgkmcnt(0)
    s_barrier
    v_mfma_f32_16x16x32_bf16 v[16:19], a[80:83], v[172:175], v[16:19]
    ds_write_b128 v8, v[76:79] offset:51200
    v_mfma_f32_16x16x32_bf16 v[20:23], a[84:87], v[172:175], v[20:23]
    s_add_u32 s67, s41, 12288
    ds_read_b128 v[36:39], v253 offset:40960
    ds_read_b128 v[40:43], v253 offset:41984
    v_mfma_f32_16x16x32_bf16 v[24:27], a[88:91], v[172:175], v[24:27]
    buffer_load_dwordx4 v[208:211], v3, s[8:11], s67 offen sc1
    ds_read_b128 v[44:47], v253 offset:43008
    v_mfma_f32_16x16x32_bf16 v[28:31], a[92:95], v[172:175], v[28:31]
    ds_write_b128 v8, v[80:83] offset:52224
    v_mfma_f32_16x16x32_bf16 v[32:35], a[96:99], v[172:175], v[32:35]
    s_waitcnt vmcnt(16)
    ds_read_b128 v[48:51], v253 offset:44032
    ds_read_b128 v[52:55], v253 offset:45056
    v_mfma_f32_16x16x32_bf16 v[16:19], a[100:103], v[176:179], v[16:19]
    s_add_u32 s67, s41, 16384
    ds_write_b128 v8, v[84:87] offset:53248
    v_mfma_f32_16x16x32_bf16 v[20:23], a[104:107], v[176:179], v[20:23]
    buffer_load_dwordx4 v[212:215], v3, s[8:11], s67 offen sc1
    ds_read_b128 v[56:59], v254 offset:46080
    v_mfma_f32_16x16x32_bf16 v[24:27], a[108:111], v[176:179], v[24:27]
    buffer_load_dwordx4 a[212:215], v14, s[8:11], s63 offen offset:3072 sc1
    ds_read_b128 v[60:63], v254 offset:47104
    v_mfma_f32_16x16x32_bf16 v[28:31], a[112:115], v[176:179], v[28:31]
    s_add_u32 s67, s41, 20480
    ds_write_b128 v8, v[88:91] offset:54272
    v_mfma_f32_16x16x32_bf16 v[32:35], a[116:119], v[176:179], v[32:35]
    s_waitcnt vmcnt(17)
    ds_read_b128 v[64:67], v254 offset:48128
    ds_read_b128 v[68:71], v254 offset:49152
    v_mfma_f32_16x16x32_bf16 v[16:19], a[120:123], v[180:183], v[16:19]
    buffer_load_dwordx4 v[216:219], v3, s[8:11], s67 offen sc1
    ds_read_b128 v[72:75], v254 offset:50176
    v_mfma_f32_16x16x32_bf16 v[20:23], a[124:127], v[180:183], v[20:23]
    ds_write_b128 v8, v[92:95] offset:55296
    v_mfma_f32_16x16x32_bf16 v[24:27], a[128:131], v[180:183], v[24:27]
    v_mfma_f32_16x16x32_bf16 v[28:31], a[132:135], v[180:183], v[28:31]
    s_add_u32 s67, s41, 24576
    s_or_b32 s67, s67, s3
    v_mfma_f32_16x16x32_bf16 v[32:35], a[136:139], v[180:183], v[32:35]
    s_waitcnt vmcnt(9)
    buffer_load_dwordx4 v[220:223], v3, s[8:11], s67 offen sc1
    v_mfma_f32_16x16x32_bf16 v[96:99], a[0:3], v[184:187], v[96:99]
    s_waitcnt lgkmcnt(1)
    v_add_f32 v36, v36, v56
    v_add_f32 v37, v37, v57
    v_mfma_f32_16x16x32_bf16 v[96:99], a[20:23], v[188:191], v[96:99]
    s_waitcnt lgkmcnt(0)
    s_barrier
    v_mfma_f32_16x16x32_bf16 v[96:99], a[40:43], v[192:195], v[96:99]
    ds_read_b128 v[76:79], v255 offset:51200
    ds_read_b128 v[80:83], v255 offset:52224
    v_mfma_f32_16x16x32_bf16 v[96:99], a[60:63], v[196:199], v[96:99]
    ds_read_b128 v[84:87], v255 offset:53248
    ds_read_b128 v[88:91], v255 offset:54272
    v_mfma_f32_16x16x32_bf16 v[96:99], a[80:83], v[200:203], v[96:99]
    ds_read_b128 v[92:95], v255 offset:55296
    v_add_f32 v38, v38, v58
    v_mfma_f32_16x16x32_bf16 v[96:99], a[100:103], v[204:207], v[96:99]
    buffer_load_dwordx4 a[216:219], v15, s[8:11], s63 offen sc1
    v_add_f32 v39, v39, v59
    v_mfma_f32_16x16x32_bf16 v[96:99], a[120:123], a[240:243], v[96:99]
    v_add_f32 v40, v40, v60
    v_add_f32 v41, v41, v61
    v_mfma_f32_16x16x32_bf16 v[100:103], a[4:7], v[184:187], v[100:103]
    v_add_f32 v42, v42, v62
    v_add_f32 v43, v43, v63
    v_mfma_f32_16x16x32_bf16 v[100:103], a[24:27], v[188:191], v[100:103]
    v_add_f32 v44, v44, v64
    v_add_f32 v45, v45, v65
    v_mfma_f32_16x16x32_bf16 v[100:103], a[44:47], v[192:195], v[100:103]
    s_add_u32 s67, s41, 0
    v_add_f32 v46, v46, v66
    v_add_f32 v47, v47, v67
    v_mfma_f32_16x16x32_bf16 v[100:103], a[64:67], v[196:199], v[100:103]
    buffer_load_dwordx4 v[136:139], v2, s[8:11], s67 offen sc1
    v_add_f32 v48, v48, v68
    v_mfma_f32_16x16x32_bf16 v[100:103], a[84:87], v[200:203], v[100:103]
    ds_write_b128 v11, v[96:99] offset:0
    v_mfma_f32_16x16x32_bf16 v[100:103], a[104:107], v[204:207], v[100:103]
    v_add_f32 v49, v49, v69
    v_add_f32 v50, v50, v70
    v_mfma_f32_16x16x32_bf16 v[100:103], a[124:127], a[240:243], v[100:103]
    s_add_u32 s67, s41, 4096
    v_add_f32 v51, v51, v71
    v_add_f32 v52, v52, v72
    v_mfma_f32_16x16x32_bf16 v[104:107], a[8:11], v[184:187], v[104:107]
    buffer_load_dwordx4 v[140:143], v2, s[8:11], s67 offen sc1
    v_add_f32 v53, v53, v73
    v_mfma_f32_16x16x32_bf16 v[104:107], a[28:31], v[188:191], v[104:107]
    s_waitcnt lgkmcnt(0)
    v_add_f32 v54, v54, v74
    v_add_f32 v55, v55, v75
    v_mfma_f32_16x16x32_bf16 v[104:107], a[48:51], v[192:195], v[104:107]
    s_barrier
    v_add_f32 v16, v16, v36
    v_mfma_f32_16x16x32_bf16 v[104:107], a[68:71], v[196:199], v[104:107]
    s_add_u32 s67, s41, 8192
    ds_read_b128 v[116:119], v7 offset:0
    v_add_f32 v17, v17, v37
    v_mfma_f32_16x16x32_bf16 v[104:107], a[88:91], v[200:203], v[104:107]
    buffer_load_dwordx4 v[144:147], v2, s[8:11], s67 offen sc1
    v_add_f32 v18, v18, v38
    v_mfma_f32_16x16x32_bf16 v[104:107], a[108:111], v[204:207], v[104:107]
    ds_write_b128 v11, v[100:103] offset:1024
    v_mfma_f32_16x16x32_bf16 v[104:107], a[128:131], a[240:243], v[104:107]
    s_add_u32 s63, s63, 5120
    buffer_load_dwordx4 a[220:223], v14, s[8:11], s63 offen offset:0 sc1
    v_add_f32 v19, v19, v39
    v_mfma_f32_16x16x32_bf16 v[108:111], a[12:15], v[184:187], v[108:111]
    s_add_u32 s67, s41, 12288
    v_add_f32 v20, v20, v40
    v_add_f32 v21, v21, v41
    v_mfma_f32_16x16x32_bf16 v[108:111], a[32:35], v[188:191], v[108:111]
    buffer_load_dwordx4 v[148:151], v2, s[8:11], s67 offen sc1
    v_add_f32 v22, v22, v42
    v_mfma_f32_16x16x32_bf16 v[108:111], a[52:55], v[192:195], v[108:111]
    s_waitcnt lgkmcnt(0)
    v_add_f32 v23, v23, v43
    v_add_f32 v24, v24, v44
    v_mfma_f32_16x16x32_bf16 v[108:111], a[72:75], v[196:199], v[108:111]
    s_barrier
    v_add_f32 v25, v25, v45
    v_mfma_f32_16x16x32_bf16 v[108:111], a[92:95], v[200:203], v[108:111]
    s_add_u32 s67, s41, 16384
    ds_read_b128 v[120:123], v7 offset:1024
    v_add_f32 v26, v26, v46
    v_mfma_f32_16x16x32_bf16 v[108:111], a[112:115], v[204:207], v[108:111]
    buffer_load_dwordx4 v[152:155], v2, s[8:11], s67 offen sc1
    v_add_f32 v27, v27, v47
    v_mfma_f32_16x16x32_bf16 v[108:111], a[132:135], a[240:243], v[108:111]
    ds_write_b128 v11, v[104:107] offset:2048
    v_mfma_f32_16x16x32_bf16 v[112:115], a[16:19], v[184:187], v[112:115]
    v_add_f32 v28, v28, v48
    v_add_f32 v29, v29, v49
    v_mfma_f32_16x16x32_bf16 v[112:115], a[36:39], v[188:191], v[112:115]
    s_add_u32 s67, s41, 20480
    v_add_f32 v30, v30, v50
    v_add_f32 v31, v31, v51
    v_mfma_f32_16x16x32_bf16 v[112:115], a[56:59], v[192:195], v[112:115]
    buffer_load_dwordx4 v[156:159], v2, s[8:11], s67 offen sc1
    v_add_f32 v32, v32, v52
    v_mfma_f32_16x16x32_bf16 v[112:115], a[76:79], v[196:199], v[112:115]
    s_waitcnt lgkmcnt(0)
    ds_write_b128 v11, v[108:111] offset:3072
    v_mfma_f32_16x16x32_bf16 v[112:115], a[96:99], v[200:203], v[112:115]
    s_barrier
    v_add_f32 v33, v33, v53
    v_mfma_f32_16x16x32_bf16 v[112:115], a[116:119], v[204:207], v[112:115]
    s_add_u32 s67, s41, 24576
    s_or_b32 s67, s67, s3
    v_mfma_f32_16x16x32_bf16 v[112:115], a[136:139], a[240:243], v[112:115]
    s_waitcnt vmcnt(8)
    buffer_load_dwordx4 v[160:163], v2, s[8:11], s67 offen sc1
    ds_read_b128 v[124:127], v7 offset:2048
    v_mfma_f32_16x16x32_bf16 v[116:119], a[0:3], a[244:247], v[116:119]
    s_waitcnt lgkmcnt(1)
    buffer_load_dwordx4 a[224:227], v14, s[8:11], s63 offen offset:1024 sc1
    v_add_f32 v34, v34, v54
    v_mfma_f32_16x16x32_bf16 v[116:119], a[20:23], a[248:251], v[116:119]
    s_barrier
    v_add_f32 v35, v35, v55
    v_mfma_f32_16x16x32_bf16 v[116:119], a[40:43], a[252:255], v[116:119]
    ds_read_b128 v[128:131], v7 offset:3072
    v_add_f32 v16, v16, v76
    v_mfma_f32_16x16x32_bf16 v[116:119], a[60:63], v[208:211], v[116:119]
    ds_write_b128 v11, v[112:115] offset:4096
    v_mfma_f32_16x16x32_bf16 v[116:119], a[80:83], v[212:215], v[116:119]
    v_add_f32 v17, v17, v77
    v_add_f32 v18, v18, v78
    v_mfma_f32_16x16x32_bf16 v[116:119], a[100:103], v[216:219], v[116:119]
    v_add_f32 v19, v19, v79
    v_add_f32 v20, v20, v80
    v_mfma_f32_16x16x32_bf16 v[116:119], a[120:123], v[220:223], v[116:119]
    v_add_f32 v21, v21, v81
    v_add_f32 v22, v22, v82
    v_mfma_f32_16x16x32_bf16 v[120:123], a[4:7], a[244:247], v[120:123]
    s_waitcnt lgkmcnt(0)
    buffer_load_dword v9, v9, s[8:11], 0 offen offset:28 sc1
    v_add_f32 v23, v23, v83
    v_mfma_f32_16x16x32_bf16 v[120:123], a[24:27], a[248:251], v[120:123]
    s_barrier
    v_add_f32 v24, v24, v84
    v_mfma_f32_16x16x32_bf16 v[120:123], a[44:47], a[252:255], v[120:123]
    s_add_u32 s67, s41, 0
    ds_read_b128 v[132:135], v7 offset:4096
    v_add_f32 v25, v25, v85
    v_mfma_f32_16x16x32_bf16 v[120:123], a[64:67], v[208:211], v[120:123]
    buffer_load_dwordx4 v[176:179], v1, s[8:11], s67 offen sc1
    v_add_f32 v26, v26, v86
    v_mfma_f32_16x16x32_bf16 v[120:123], a[84:87], v[212:215], v[120:123]
    ds_write_b128 v11, v[116:119] offset:20480
    v_mfma_f32_16x16x32_bf16 v[120:123], a[104:107], v[216:219], v[120:123]
    v_add_f32 v27, v27, v87
    v_add_f32 v28, v28, v88
    v_mfma_f32_16x16x32_bf16 v[120:123], a[124:127], v[220:223], v[120:123]
    s_add_u32 s67, s41, 4096
    buffer_load_dwordx4 a[228:231], v14, s[8:11], s63 offen offset:2048 sc1
    v_add_f32 v29, v29, v89
    v_mfma_f32_16x16x32_bf16 v[124:127], a[8:11], a[244:247], v[124:127]
    buffer_load_dwordx4 v[180:183], v1, s[8:11], s67 offen sc1
    v_add_f32 v30, v30, v90
    v_mfma_f32_16x16x32_bf16 v[124:127], a[28:31], a[248:251], v[124:127]
    s_waitcnt lgkmcnt(0)
    v_add_f32 v31, v31, v91
    v_add_f32 v32, v32, v92
    v_mfma_f32_16x16x32_bf16 v[124:127], a[48:51], a[252:255], v[124:127]
    s_barrier
    v_add_f32 v33, v33, v93
    v_mfma_f32_16x16x32_bf16 v[124:127], a[68:71], v[208:211], v[124:127]
    s_add_u32 s67, s41, 8192
    ds_read_b128 v[96:99], v7 offset:20480
    v_add_f32 v34, v34, v94
    v_mfma_f32_16x16x32_bf16 v[124:127], a[88:91], v[212:215], v[124:127]
    buffer_load_dwordx4 v[184:187], v1, s[8:11], s67 offen sc1
    v_add_f32 v35, v35, v95
    v_mfma_f32_16x16x32_bf16 v[124:127], a[108:111], v[216:219], v[124:127]
    ds_write_b128 v11, v[120:123] offset:21504
    v_mfma_f32_16x16x32_bf16 v[124:127], a[128:131], v[220:223], v[124:127]
    v_cvt_pk_bf16_f32 v16, v16, v17
    v_cvt_pk_bf16_f32 v17, v18, v19
    v_mfma_f32_16x16x32_bf16 v[128:131], a[12:15], a[244:247], v[128:131]
    s_add_u32 s67, s41, 12288
    v_cvt_pk_bf16_f32 v18, v20, v21
    v_cvt_pk_bf16_f32 v19, v22, v22
    v_mfma_f32_16x16x32_bf16 v[128:131], a[32:35], a[248:251], v[128:131]
    buffer_load_dwordx4 v[188:191], v1, s[8:11], s67 offen sc1
    v_perm_b32 v19, v19, v13, s72
    v_mfma_f32_16x16x32_bf16 v[128:131], a[52:55], a[252:255], v[128:131]
    s_waitcnt lgkmcnt(0)
    v_cvt_pk_bf16_f32 v20, v23, v24
    v_cvt_pk_bf16_f32 v21, v25, v26
    v_mfma_f32_16x16x32_bf16 v[128:131], a[72:75], v[208:211], v[128:131]
    s_barrier
    v_cvt_pk_bf16_f32 v22, v27, v28
    v_mfma_f32_16x16x32_bf16 v[128:131], a[92:95], v[212:215], v[128:131]
    s_add_u32 s67, s41, 16384
    ds_read_b128 v[100:103], v7 offset:21504
    v_cvt_pk_bf16_f32 v23, v29, v29
    v_mfma_f32_16x16x32_bf16 v[128:131], a[112:115], v[216:219], v[128:131]
    buffer_load_dwordx4 v[192:195], v1, s[8:11], s67 offen sc1
    buffer_load_dwordx4 a[232:235], v14, s[8:11], s63 offen offset:3072 sc1
    v_mfma_f32_16x16x32_bf16 v[128:131], a[132:135], v[220:223], v[128:131]
    ds_write_b128 v11, v[124:127] offset:22528
    v_mfma_f32_16x16x32_bf16 v[132:135], a[16:19], a[244:247], v[132:135]
    v_perm_b32 v23, v23, v13, s72
    v_cvt_pk_bf16_f32 v24, v30, v31
    v_mfma_f32_16x16x32_bf16 v[132:135], a[36:39], a[248:251], v[132:135]
    s_add_u32 s67, s41, 20480
    v_cvt_pk_bf16_f32 v25, v32, v33
    v_cvt_pk_bf16_f32 v26, v34, v35
    v_mfma_f32_16x16x32_bf16 v[132:135], a[56:59], a[252:255], v[132:135]
    buffer_load_dwordx4 v[196:199], v1, s[8:11], s67 offen sc1
    v_mov_b32 v27, v13
    v_mfma_f32_16x16x32_bf16 v[132:135], a[76:79], v[208:211], v[132:135]
    s_waitcnt lgkmcnt(0)
    ds_write_b128 v11, v[128:131] offset:23552
    v_mfma_f32_16x16x32_bf16 v[132:135], a[96:99], v[212:215], v[132:135]
    s_barrier
    v_mfma_f32_16x16x32_bf16 v[132:135], a[116:119], v[216:219], v[132:135]
    s_add_u32 s67, s41, 24576
    s_or_b32 s67, s67, s3
    v_mfma_f32_16x16x32_bf16 v[132:135], a[136:139], v[220:223], v[132:135]
    s_waitcnt vmcnt(10)
    buffer_load_dwordx4 v[200:203], v1, s[8:11], s67 offen sc1
    ds_read_b128 v[104:107], v7 offset:22528
    v_mfma_f32_16x16x32_bf16 v[96:99], a[0:3], v[136:139], v[96:99]
    s_waitcnt lgkmcnt(1)
    buffer_store_dwordx4 v[16:19], v14, s[8:11], s44 offen offset:0 sc1
    v_mfma_f32_16x16x32_bf16 v[96:99], a[20:23], v[140:143], v[96:99]
    s_barrier
    v_mfma_f32_16x16x32_bf16 v[96:99], a[40:43], v[144:147], v[96:99]
    ds_read_b128 v[108:111], v7 offset:23552
    ds_read_b64 v[38:39], v5 offset:0
    v_mfma_f32_16x16x32_bf16 v[96:99], a[60:63], v[148:151], v[96:99]
    ds_write_b128 v11, v[132:135] offset:24576
    v_mfma_f32_16x16x32_bf16 v[96:99], a[80:83], v[152:155], v[96:99]
    buffer_load_dwordx4 a[236:239], v15, s[8:11], s63 offen sc1
    ds_read_b64 v[42:43], v5 offset:32
    v_mfma_f32_16x16x32_bf16 v[96:99], a[100:103], v[156:159], v[96:99]
    ds_read_b64 v[46:47], v5 offset:64
    ds_read_b64 v[50:51], v5 offset:96
    v_mfma_f32_16x16x32_bf16 v[96:99], a[120:123], v[160:163], v[96:99]
    ds_read_b64 v[54:55], v5 offset:128
    v_mfma_f32_16x16x32_bf16 v[100:103], a[4:7], v[136:139], v[100:103]
    s_waitcnt vmcnt(11) lgkmcnt(4)
    v_cmp_ne_u32 vcc, s55, v9
    v_mfma_f32_16x16x32_bf16 v[100:103], a[24:27], v[140:143], v[100:103]
    s_barrier
    v_mfma_f32_16x16x32_bf16 v[100:103], a[44:47], v[144:147], v[100:103]
    s_waitcnt lgkmcnt(0)
    ds_read_b128 v[112:115], v7 offset:24576
    v_lshlrev_b32 v36, 16, v38
    v_mfma_f32_16x16x32_bf16 v[100:103], a[64:67], v[148:151], v[100:103]
    ds_write_b128 v11, v[96:99] offset:0
    v_mfma_f32_16x16x32_bf16 v[100:103], a[84:87], v[152:155], v[100:103]
    v_and_b32 v37, 0xffff0000, v38
    v_lshlrev_b32 v38, 16, v39
    v_mfma_f32_16x16x32_bf16 v[100:103], a[104:107], v[156:159], v[100:103]
    buffer_store_dwordx4 v[20:23], v14, s[8:11], s44 offen offset:1024 sc1
    v_mfma_f32_16x16x32_bf16 v[100:103], a[124:127], v[160:163], v[100:103]
    s_add_u32 s67, s40, 28672
    v_and_b32 v39, 0xffff0000, v39
    s_cbranch_vccnz L_spin_sy_yf
L_ret_sy_yf:
    v_mfma_f32_16x16x32_bf16 v[104:107], a[8:11], v[136:139], v[104:107]
    s_waitcnt lgkmcnt(0)
    buffer_load_dwordx4 v[204:207], v4, s[8:11], s67 offen sc1
    v_lshlrev_b32 v40, 16, v42
    v_mfma_f32_16x16x32_bf16 v[104:107], a[28:31], v[140:143], v[104:107]
    s_barrier
    v_and_b32 v41, 0xffff0000, v42
    v_mfma_f32_16x16x32_bf16 v[104:107], a[48:51], v[144:147], v[104:107]
    ds_read_b128 v[116:119], v7 offset:0
    v_lshlrev_b32 v42, 16, v43
    v_mfma_f32_16x16x32_bf16 v[104:107], a[68:71], v[148:151], v[104:107]
    s_add_u32 s67, s40, 32768
    ds_write_b128 v11, v[100:103] offset:1024
    v_mfma_f32_16x16x32_bf16 v[104:107], a[88:91], v[152:155], v[104:107]
    buffer_load_dwordx4 a[240:243], v4, s[8:11], s67 offen sc1
    v_and_b32 v43, 0xffff0000, v43
    v_mfma_f32_16x16x32_bf16 v[104:107], a[108:111], v[156:159], v[104:107]
    v_lshlrev_b32 v44, 16, v46
    v_and_b32 v45, 0xffff0000, v46
    v_mfma_f32_16x16x32_bf16 v[104:107], a[128:131], v[160:163], v[104:107]
    v_lshlrev_b32 v46, 16, v47
    v_and_b32 v47, 0xffff0000, v47
    v_mfma_f32_16x16x32_bf16 v[108:111], a[12:15], v[136:139], v[108:111]
    s_add_u32 s67, s40, 36864
    v_lshlrev_b32 v48, 16, v50
    v_and_b32 v49, 0xffff0000, v50
    v_mfma_f32_16x16x32_bf16 v[108:111], a[32:35], v[140:143], v[108:111]
    s_waitcnt lgkmcnt(0)
    buffer_load_dwordx4 a[244:247], v4, s[8:11], s67 offen sc1
    v_lshlrev_b32 v50, 16, v51
    v_mfma_f32_16x16x32_bf16 v[108:111], a[52:55], v[144:147], v[108:111]
    s_barrier
    v_and_b32 v51, 0xffff0000, v51
    v_mfma_f32_16x16x32_bf16 v[108:111], a[72:75], v[148:151], v[108:111]
    ds_read_b128 v[120:123], v7 offset:1024
    v_lshlrev_b32 v52, 16, v54
    v_mfma_f32_16x16x32_bf16 v[108:111], a[92:95], v[152:155], v[108:111]
    s_add_u32 s67, s40, 40960
    ds_write_b128 v11, v[104:107] offset:2048
    v_mfma_f32_16x16x32_bf16 v[108:111], a[112:115], v[156:159], v[108:111]
    buffer_load_dwordx4 a[248:251], v4, s[8:11], s67 offen sc1
    v_and_b32 v53, 0xffff0000, v54
    v_mfma_f32_16x16x32_bf16 v[108:111], a[132:135], v[160:163], v[108:111]
    buffer_store_dwordx4 v[24:27], v14, s[8:11], s44 offen offset:2048 sc1
    v_mfma_f32_16x16x32_bf16 v[112:115], a[16:19], v[136:139], v[112:115]
    v_lshlrev_b32 v54, 16, v55
    v_and_b32 v55, 0xffff0000, v55
    v_mfma_f32_16x16x32_bf16 v[112:115], a[36:39], v[140:143], v[112:115]
    s_add_u32 s67, s40, 45056
    v_mfma_f32_16x16x32_bf16 v[112:115], a[56:59], v[144:147], v[112:115]
    s_waitcnt lgkmcnt(0)
    buffer_load_dwordx4 a[252:255], v4, s[8:11], s67 offen sc1
    v_mfma_f32_16x16x32_bf16 v[112:115], a[76:79], v[148:151], v[112:115]
    s_barrier
    v_mfma_f32_16x16x32_bf16 v[112:115], a[96:99], v[152:155], v[112:115]
    ds_read_b128 v[124:127], v7 offset:2048
    v_mfma_f32_16x16x32_bf16 v[112:115], a[116:119], v[156:159], v[112:115]
    s_add_u32 s67, s40, 28672
    ds_write_b128 v11, v[108:111] offset:3072
    v_mfma_f32_16x16x32_bf16 v[112:115], a[136:139], v[160:163], v[112:115]
    s_waitcnt vmcnt(9)
    v_mfma_f32_16x16x32_bf16 v[116:119], a[0:3], v[176:179], v[116:119]
    buffer_load_dwordx4 v[208:211], v3, s[8:11], s67 offen sc1
    v_mfma_f32_16x16x32_bf16 v[116:119], a[20:23], v[180:183], v[116:119]
    v_mfma_f32_16x16x32_bf16 v[116:119], a[40:43], v[184:187], v[116:119]
    v_mfma_f32_16x16x32_bf16 v[116:119], a[60:63], v[188:191], v[116:119]
    s_add_u32 s67, s40, 32768
    s_nop 0
    ds_write_b128 v11, v[112:115] offset:4096
    v_mfma_f32_16x16x32_bf16 v[116:119], a[80:83], v[192:195], v[116:119]
    s_waitcnt lgkmcnt(1)
    buffer_load_dwordx4 v[212:215], v3, s[8:11], s67 offen sc1
    v_mfma_f32_16x16x32_bf16 v[116:119], a[100:103], v[196:199], v[116:119]
    s_barrier
    v_mfma_f32_16x16x32_bf16 v[116:119], a[120:123], v[200:203], v[116:119]
    ds_read_b128 v[128:131], v7 offset:3072
    v_mfma_f32_16x16x32_bf16 v[120:123], a[4:7], v[176:179], v[120:123]
    s_add_u32 s67, s40, 36864
    v_mfma_f32_16x16x32_bf16 v[120:123], a[24:27], v[180:183], v[120:123]
    s_waitcnt lgkmcnt(1)
    buffer_load_dwordx4 v[216:219], v3, s[8:11], s67 offen sc1
    v_mfma_f32_16x16x32_bf16 v[120:123], a[44:47], v[184:187], v[120:123]
    s_barrier
    v_mfma_f32_16x16x32_bf16 v[120:123], a[64:67], v[188:191], v[120:123]
    ds_read_b128 v[132:135], v7 offset:4096
    v_mfma_f32_16x16x32_bf16 v[120:123], a[84:87], v[192:195], v[120:123]
    s_add_u32 s67, s40, 40960
    v_mfma_f32_16x16x32_bf16 v[120:123], a[104:107], v[196:199], v[120:123]
    buffer_load_dwordx4 v[220:223], v3, s[8:11], s67 offen sc1
    v_mfma_f32_16x16x32_bf16 v[120:123], a[124:127], v[200:203], v[120:123]
    v_mfma_f32_16x16x32_bf16 v[124:127], a[8:11], v[176:179], v[124:127]
    v_mfma_f32_16x16x32_bf16 v[124:127], a[28:31], v[180:183], v[124:127]
    s_add_u32 s67, s40, 45056
    v_mfma_f32_16x16x32_bf16 v[124:127], a[48:51], v[184:187], v[124:127]
    buffer_load_dwordx4 a[0:3], v3, s[8:11], s67 offen sc1
    v_mfma_f32_16x16x32_bf16 v[124:127], a[68:71], v[188:191], v[124:127]
    s_waitcnt lgkmcnt(0)
    v_mfma_f32_16x16x32_bf16 v[124:127], a[88:91], v[192:195], v[124:127]
    s_buffer_load_dword s24, s[8:11], s45 offset:12 glc
    v_mfma_f32_16x16x32_bf16 v[124:127], a[108:111], v[196:199], v[124:127]
    v_mfma_f32_16x16x32_bf16 v[124:127], a[128:131], v[200:203], v[124:127]
    v_mfma_f32_16x16x32_bf16 v[128:131], a[12:15], v[176:179], v[128:131]
    v_mfma_f32_16x16x32_bf16 v[128:131], a[32:35], v[180:183], v[128:131]
    v_mfma_f32_16x16x32_bf16 v[128:131], a[52:55], v[184:187], v[128:131]
    v_mfma_f32_16x16x32_bf16 v[128:131], a[72:75], v[188:191], v[128:131]
    s_add_u32 s67, s40, 28672
    v_mfma_f32_16x16x32_bf16 v[128:131], a[92:95], v[192:195], v[128:131]
    buffer_load_dwordx4 a[20:23], v2, s[8:11], s67 offen sc1
    v_mfma_f32_16x16x32_bf16 v[128:131], a[112:115], v[196:199], v[128:131]
    v_mfma_f32_16x16x32_bf16 v[128:131], a[132:135], v[200:203], v[128:131]
    v_mfma_f32_16x16x32_bf16 v[132:135], a[16:19], v[176:179], v[132:135]
    s_add_u32 s67, s40, 32768
    v_mfma_f32_16x16x32_bf16 v[132:135], a[36:39], v[180:183], v[132:135]
    buffer_load_dwordx4 a[40:43], v2, s[8:11], s67 offen sc1
    v_mfma_f32_16x16x32_bf16 v[132:135], a[56:59], v[184:187], v[132:135]
    v_mfma_f32_16x16x32_bf16 v[132:135], a[76:79], v[188:191], v[132:135]
    v_mfma_f32_16x16x32_bf16 v[132:135], a[96:99], v[192:195], v[132:135]
    s_add_u32 s67, s40, 36864
    v_mfma_f32_16x16x32_bf16 v[132:135], a[116:119], v[196:199], v[132:135]
    buffer_load_dwordx4 a[60:63], v2, s[8:11], s67 offen sc1
    v_mfma_f32_16x16x32_bf16 v[132:135], a[136:139], v[200:203], v[132:135]
    s_waitcnt vmcnt(8)
    v_mfma_f32_16x16x32_bf16 v[136:139], a[140:143], v[204:207], 0
    v_mfma_f32_16x16x32_bf16 v[136:139], a[160:163], a[240:243], v[136:139]
    s_add_u32 s67, s40, 40960
    v_mfma_f32_16x16x32_bf16 v[136:139], a[180:183], a[244:247], v[136:139]
    buffer_load_dwordx4 a[80:83], v2, s[8:11], s67 offen sc1
    v_mfma_f32_16x16x32_bf16 v[136:139], a[200:203], a[248:251], v[136:139]
    v_mfma_f32_16x16x32_bf16 v[136:139], a[220:223], a[252:255], v[136:139]
    v_mfma_f32_16x16x32_bf16 v[140:143], a[144:147], v[204:207], 0
    s_add_u32 s67, s40, 45056
    v_mfma_f32_16x16x32_bf16 v[140:143], a[164:167], a[240:243], v[140:143]
    buffer_load_dwordx4 a[100:103], v2, s[8:11], s67 offen sc1
    v_mfma_f32_16x16x32_bf16 v[140:143], a[184:187], a[244:247], v[140:143]
    v_mfma_f32_16x16x32_bf16 v[140:143], a[204:207], a[248:251], v[140:143]
    s_nop 1
    ds_write_b128 v11, v[136:139] offset:20480
    v_mfma_f32_16x16x32_bf16 v[140:143], a[224:227], a[252:255], v[140:143]
    v_mfma_f32_16x16x32_bf16 v[144:147], a[148:151], v[204:207], 0
    v_mfma_f32_16x16x32_bf16 v[144:147], a[168:171], a[240:243], v[144:147]
    s_waitcnt lgkmcnt(0)
    s_xor_b32 s24, s24, s55
    s_and_b32 s24, s24, 0xffff
    s_cmp_eq_u32 s24, 0
    s_cbranch_scc0 L_spin_sy_gf
L_ret_sy_gf:
    v_mfma_f32_16x16x32_bf16 v[144:147], a[188:191], a[244:247], v[144:147]
    v_mfma_f32_16x16x32_bf16 v[144:147], a[208:211], a[248:251], v[144:147]
    s_barrier
    v_mfma_f32_16x16x32_bf16 v[144:147], a[228:231], a[252:255], v[144:147]
    s_add_u32 s67, s40, 28672
    ds_read_b128 v[156:159], v7 offset:20480
    v_mfma_f32_16x16x32_bf16 v[148:151], a[152:155], v[204:207], 0
    buffer_load_dwordx4 a[120:123], v1, s[8:11], s67 offen sc1
    v_mfma_f32_16x16x32_bf16 v[148:151], a[172:175], a[240:243], v[148:151]
    ds_write_b128 v11, v[140:143] offset:21504
    v_mfma_f32_16x16x32_bf16 v[148:151], a[192:195], a[244:247], v[148:151]
    buffer_load_dwordx4 v[76:79], v14, s[8:11], s45 offen offset:0 sc1
    v_mfma_f32_16x16x32_bf16 v[148:151], a[212:215], a[248:251], v[148:151]
    s_add_u32 s67, s40, 32768
    ds_write_b128 v11, v[144:147] offset:22528
    v_mfma_f32_16x16x32_bf16 v[148:151], a[232:235], a[252:255], v[148:151]
    buffer_load_dwordx4 a[4:7], v1, s[8:11], s67 offen sc1
    v_mfma_f32_16x16x32_bf16 v[152:155], a[156:159], v[204:207], 0
    s_waitcnt lgkmcnt(1)
    buffer_load_dwordx4 v[80:83], v14, s[8:11], s45 offen offset:1024 sc1
    v_mfma_f32_16x16x32_bf16 v[152:155], a[176:179], a[240:243], v[152:155]
    s_barrier
    v_mfma_f32_16x16x32_bf16 v[152:155], a[196:199], a[244:247], v[152:155]
    s_add_u32 s67, s40, 36864
    ds_read_b128 v[160:163], v7 offset:21504
    v_mfma_f32_16x16x32_bf16 v[152:155], a[216:219], a[248:251], v[152:155]
    buffer_load_dwordx4 a[24:27], v1, s[8:11], s67 offen sc1
    buffer_load_dwordx4 v[84:87], v14, s[8:11], s45 offen offset:2048 sc1
    v_mfma_f32_16x16x32_bf16 v[152:155], a[236:239], a[252:255], v[152:155]
    s_waitcnt vmcnt(11) lgkmcnt(1)
    ds_write_b128 v11, v[148:151] offset:23552
    v_mfma_f32_16x16x32_bf16 v[156:159], a[140:143], v[208:211], v[156:159]
    s_barrier
    v_mfma_f32_16x16x32_bf16 v[156:159], a[160:163], v[212:215], v[156:159]
    s_add_u32 s67, s40, 40960
    ds_read_b128 v[164:167], v7 offset:22528
    v_mfma_f32_16x16x32_bf16 v[156:159], a[180:183], v[216:219], v[156:159]
    buffer_load_dwordx4 a[44:47], v1, s[8:11], s67 offen sc1
    v_mfma_f32_16x16x32_bf16 v[156:159], a[200:203], v[220:223], v[156:159]
    ds_write_b128 v11, v[152:155] offset:24576
    v_mfma_f32_16x16x32_bf16 v[156:159], a[220:223], a[0:3], v[156:159]
    s_waitcnt lgkmcnt(3)
    v_mfma_f32_16x16x32_bf16 v[160:163], a[144:147], v[208:211], v[160:163]
    s_add_u32 s67, s40, 45056
    v_mfma_f32_16x16x32_bf16 v[160:163], a[164:167], v[212:215], v[160:163]
    s_waitcnt lgkmcnt(2)
    buffer_load_dwordx4 a[64:67], v1, s[8:11], s67 offen sc1
    v_mfma_f32_16x16x32_bf16 v[160:163], a[184:187], v[216:219], v[160:163]
    s_barrier
    v_mfma_f32_16x16x32_bf16 v[160:163], a[204:207], v[220:223], v[160:163]
    ds_read_b128 v[168:171], v7 offset:23552
    v_mfma_f32_16x16x32_bf16 v[160:163], a[224:227], a[0:3], v[160:163]
    s_waitcnt lgkmcnt(1)
    ds_write_b128 v11, v[156:159] offset:0
    v_mfma_f32_16x16x32_bf16 v[164:167], a[148:151], v[208:211], v[164:167]
    s_barrier
    v_mfma_f32_16x16x32_bf16 v[164:167], a[168:171], v[212:215], v[164:167]
    ds_read_b128 v[172:175], v7 offset:24576
    v_mfma_f32_16x16x32_bf16 v[164:167], a[188:191], v[216:219], v[164:167]
    v_mfma_f32_16x16x32_bf16 v[164:167], a[208:211], v[220:223], v[164:167]
    ds_write_b128 v11, v[160:163] offset:1024
    v_mfma_f32_16x16x32_bf16 v[164:167], a[228:231], a[0:3], v[164:167]
    s_waitcnt lgkmcnt(3)
    s_add_u32 s67, s41, 28672
    v_mfma_f32_16x16x32_bf16 v[168:171], a[152:155], v[208:211], v[168:171]
    s_waitcnt lgkmcnt(2)
    buffer_load_dwordx4 a[84:87], v4, s[8:11], s67 offen sc1
    v_mfma_f32_16x16x32_bf16 v[168:171], a[172:175], v[212:215], v[168:171]
    s_barrier
    v_mfma_f32_16x16x32_bf16 v[168:171], a[192:195], v[216:219], v[168:171]
    ds_read_b128 v[136:139], v7 offset:0
    v_mfma_f32_16x16x32_bf16 v[168:171], a[212:215], v[220:223], v[168:171]
    s_add_u32 s67, s41, 32768
    ds_write_b128 v11, v[164:167] offset:2048
    v_mfma_f32_16x16x32_bf16 v[168:171], a[232:235], a[0:3], v[168:171]
    s_waitcnt lgkmcnt(2)
    buffer_load_dwordx4 a[104:107], v4, s[8:11], s67 offen sc1
    v_mfma_f32_16x16x32_bf16 v[172:175], a[156:159], v[208:211], v[172:175]
    s_barrier
    v_mfma_f32_16x16x32_bf16 v[172:175], a[176:179], v[212:215], v[172:175]
    ds_read_b128 v[140:143], v7 offset:1024
    s_add_u32 s73, s44, 6144
    v_mfma_f32_16x16x32_bf16 v[172:175], a[196:199], v[216:219], v[172:175]
    s_add_u32 s67, s41, 36864
    s_mov_b64 exec, 1
    buffer_store_dword v13, v14, s[8:11], s73 offen sc1
    s_mov_b64 exec, -1
    v_mfma_f32_16x16x32_bf16 v[172:175], a[216:219], v[220:223], v[172:175]
    buffer_load_dwordx4 a[124:127], v4, s[8:11], s67 offen sc1
    v_mfma_f32_16x16x32_bf16 v[172:175], a[236:239], a[0:3], v[172:175]
    s_waitcnt vmcnt(12) lgkmcnt(1)
    ds_write_b128 v11, v[168:171] offset:3072
    v_mfma_f32_16x16x32_bf16 v[136:139], a[140:143], a[20:23], v[136:139]
    s_barrier
    v_mfma_f32_16x16x32_bf16 v[136:139], a[160:163], a[40:43], v[136:139]
    s_add_u32 s67, s41, 40960
    ds_read_b128 v[144:147], v7 offset:2048
    v_mfma_f32_16x16x32_bf16 v[136:139], a[180:183], a[60:63], v[136:139]
    buffer_load_dwordx4 a[8:11], v4, s[8:11], s67 offen sc1
    v_mfma_f32_16x16x32_bf16 v[136:139], a[200:203], a[80:83], v[136:139]
    ds_write_b128 v11, v[172:175] offset:4096
    v_mfma_f32_16x16x32_bf16 v[136:139], a[220:223], a[100:103], v[136:139]
    s_waitcnt vmcnt(11) lgkmcnt(3)
    v_xor_b32 v8, s55, v79
    s_waitcnt vmcnt(9)
    v_bitop3_b32 v8, v8, v83, s55 bitop3:0xf6
    v_mfma_f32_16x16x32_bf16 v[140:143], a[144:147], a[20:23], v[140:143]
    s_add_u32 s67, s41, 45056
    s_waitcnt vmcnt(7)
    v_bitop3_b32 v8, v8, v87, s55 bitop3:0xf6
    v_and_b32 v8, 0xffff, v8
    v_mfma_f32_16x16x32_bf16 v[140:143], a[164:167], a[40:43], v[140:143]
    s_waitcnt lgkmcnt(2)
    buffer_load_dwordx4 a[28:31], v4, s[8:11], s67 offen sc1
    v_mfma_f32_16x16x32_bf16 v[140:143], a[184:187], a[60:63], v[140:143]
    s_barrier
    v_mfma_f32_16x16x32_bf16 v[140:143], a[204:207], a[80:83], v[140:143]
    ds_read_b128 v[148:151], v7 offset:3072
    v_mfma_f32_16x16x32_bf16 v[140:143], a[224:227], a[100:103], v[140:143]
    s_waitcnt lgkmcnt(1)
    ds_write_b128 v11, v[136:139] offset:20480
    v_mfma_f32_16x16x32_bf16 v[144:147], a[148:151], a[20:23], v[144:147]
    s_barrier
    v_mfma_f32_16x16x32_bf16 v[144:147], a[168:171], a[40:43], v[144:147]
    ds_read_b128 v[152:155], v7 offset:4096
    v_mfma_f32_16x16x32_bf16 v[144:147], a[188:191], a[60:63], v[144:147]
    v_cmp_ne_u32 vcc, 0, v8
    s_nop 3
    s_cbranch_vccnz L_spin_sy_xf
L_ret_sy_xf:
    v_mfma_f32_16x16x32_bf16 v[144:147], a[208:211], a[80:83], v[144:147]
    ds_write_b128 v11, v[140:143] offset:21504
    v_mfma_f32_16x16x32_bf16 v[144:147], a[228:231], a[100:103], v[144:147]
    s_waitcnt lgkmcnt(3)
    s_add_u32 s67, s41, 28672
    v_lshlrev_b32 v56, 16, v76
    v_and_b32 v57, 0xffff0000, v76
    v_mfma_f32_16x16x32_bf16 v[148:151], a[152:155], a[20:23], v[148:151]
    s_waitcnt lgkmcnt(2)
    buffer_load_dwordx4 a[48:51], v3, s[8:11], s67 offen sc1
    v_lshlrev_b32 v58, 16, v77
    v_mfma_f32_16x16x32_bf16 v[148:151], a[172:175], a[40:43], v[148:151]
    s_barrier
    v_and_b32 v59, 0xffff0000, v77
    v_mfma_f32_16x16x32_bf16 v[148:151], a[192:195], a[60:63], v[148:151]
    ds_read_b128 v[156:159], v7 offset:20480
    v_lshlrev_b32 v60, 16, v78
    v_mfma_f32_16x16x32_bf16 v[148:151], a[212:215], a[80:83], v[148:151]
    s_add_u32 s67, s41, 32768
    ds_write_b128 v11, v[144:147] offset:22528
    v_mfma_f32_16x16x32_bf16 v[148:151], a[232:235], a[100:103], v[148:151]
    s_waitcnt lgkmcnt(2)
    buffer_load_dwordx4 a[68:71], v3, s[8:11], s67 offen sc1
    v_and_b32 v61, 0xffff0000, v78
    v_mfma_f32_16x16x32_bf16 v[152:155], a[156:159], a[20:23], v[152:155]
    s_barrier
    v_and_b32 v62, 0xffff0000, v79
    v_mfma_f32_16x16x32_bf16 v[152:155], a[176:179], a[40:43], v[152:155]
    ds_read_b128 v[160:163], v7 offset:21504
    v_lshlrev_b32 v63, 16, v80
    v_mfma_f32_16x16x32_bf16 v[152:155], a[196:199], a[60:63], v[152:155]
    s_add_u32 s67, s41, 36864
    v_and_b32 v64, 0xffff0000, v80
    v_lshlrev_b32 v65, 16, v81
    v_mfma_f32_16x16x32_bf16 v[152:155], a[216:219], a[80:83], v[152:155]
    buffer_load_dwordx4 a[88:91], v3, s[8:11], s67 offen sc1
    v_and_b32 v66, 0xffff0000, v81
    v_mfma_f32_16x16x32_bf16 v[152:155], a[236:239], a[100:103], v[152:155]
    s_waitcnt vmcnt(9) lgkmcnt(1)
    ds_write_b128 v11, v[148:151] offset:23552
    v_mfma_f32_16x16x32_bf16 v[156:159], a[140:143], a[120:123], v[156:159]
    s_barrier
    v_lshlrev_b32 v67, 16, v82
    v_mfma_f32_16x16x32_bf16 v[156:159], a[160:163], a[4:7], v[156:159]
    s_add_u32 s67, s41, 40960
    ds_read_b128 v[164:167], v7 offset:22528
    v_and_b32 v68, 0xffff0000, v82
    v_mfma_f32_16x16x32_bf16 v[156:159], a[180:183], a[24:27], v[156:159]
    buffer_load_dwordx4 a[108:111], v3, s[8:11], s67 offen sc1
    v_and_b32 v69, 0xffff0000, v83
    v_mfma_f32_16x16x32_bf16 v[156:159], a[200:203], a[44:47], v[156:159]
    ds_write_b128 v11, v[152:155] offset:24576
    v_mfma_f32_16x16x32_bf16 v[156:159], a[220:223], a[64:67], v[156:159]
    s_waitcnt lgkmcnt(3)
    v_lshlrev_b32 v70, 16, v84
    v_and_b32 v71, 0xffff0000, v84
    v_mfma_f32_16x16x32_bf16 v[160:163], a[144:147], a[120:123], v[160:163]
    s_add_u32 s67, s41, 45056
    v_lshlrev_b32 v72, 16, v85
    v_and_b32 v73, 0xffff0000, v85
    v_mfma_f32_16x16x32_bf16 v[160:163], a[164:167], a[4:7], v[160:163]
    s_waitcnt lgkmcnt(2)
    buffer_load_dwordx4 a[128:131], v3, s[8:11], s67 offen sc1
    v_lshlrev_b32 v74, 16, v86
    v_mfma_f32_16x16x32_bf16 v[160:163], a[184:187], a[24:27], v[160:163]
    s_barrier
    v_and_b32 v75, 0xffff0000, v86
    v_mfma_f32_16x16x32_bf16 v[160:163], a[204:207], a[44:47], v[160:163]
    ds_read_b128 v[168:171], v7 offset:23552
    v_add_f32 v116, v116, v56
    v_mfma_f32_16x16x32_bf16 v[160:163], a[224:227], a[64:67], v[160:163]
    s_waitcnt lgkmcnt(1)
    v_add_f32 v117, v117, v57
    v_add_f32 v118, v118, v58
    v_mfma_f32_16x16x32_bf16 v[164:167], a[148:151], a[120:123], v[164:167]
    s_barrier
    v_add_f32 v119, v119, v59
    v_mfma_f32_16x16x32_bf16 v[164:167], a[168:171], a[4:7], v[164:167]
    ds_read_b128 v[172:175], v7 offset:24576
    v_add_f32 v120, v120, v60
    v_mfma_f32_16x16x32_bf16 v[164:167], a[188:191], a[24:27], v[164:167]
    v_add_f32 v121, v121, v61
    v_add_f32 v122, v122, v62
    v_mfma_f32_16x16x32_bf16 v[164:167], a[208:211], a[44:47], v[164:167]
    v_cvt_pk_bf16_f32 v16, v156, v157
    v_cvt_pk_bf16_f32 v17, v158, v159
    v_mfma_f32_16x16x32_bf16 v[164:167], a[228:231], a[64:67], v[164:167]
    s_waitcnt lgkmcnt(1)
    s_add_u32 s67, s41, 28672
    v_cvt_pk_bf16_f32 v18, v160, v161
    v_cvt_pk_bf16_f32 v19, v162, v162
    v_mfma_f32_16x16x32_bf16 v[168:171], a[152:155], a[120:123], v[168:171]
    buffer_load_dwordx4 a[12:15], v2, s[8:11], s67 offen sc1
    v_perm_b32 v19, v19, v13, s72
    v_mfma_f32_16x16x32_bf16 v[168:171], a[172:175], a[4:7], v[168:171]
    buffer_store_dwordx4 v[16:19], v14, s[8:11], s74 offen offset:0 sc1
    v_mfma_f32_16x16x32_bf16 v[168:171], a[192:195], a[24:27], v[168:171]
    v_add_f32 v123, v123, v63
    v_add_f32 v124, v124, v64
    v_mfma_f32_16x16x32_bf16 v[168:171], a[212:215], a[44:47], v[168:171]
    s_waitcnt lgkmcnt(0)
    s_add_u32 s67, s41, 32768
    v_add_f32 v125, v125, v65
    v_add_f32 v126, v126, v66
    v_mfma_f32_16x16x32_bf16 v[168:171], a[232:235], a[64:67], v[168:171]
    buffer_load_dwordx4 a[32:35], v2, s[8:11], s67 offen sc1
    s_buffer_load_dword s24, s[8:11], s45 offset:6144 glc
    v_mfma_f32_16x16x32_bf16 v[172:175], a[156:159], a[120:123], v[172:175]
    v_add_f32 v127, v127, v67
    v_add_f32 v128, v128, v68
    v_mfma_f32_16x16x32_bf16 v[172:175], a[176:179], a[4:7], v[172:175]
    v_add_f32 v129, v129, v69
    v_add_f32 v130, v130, v70
    v_mfma_f32_16x16x32_bf16 v[172:175], a[196:199], a[24:27], v[172:175]
    s_add_u32 s67, s41, 36864
    v_add_f32 v131, v131, v71
    v_add_f32 v132, v132, v72
    v_mfma_f32_16x16x32_bf16 v[172:175], a[216:219], a[44:47], v[172:175]
    buffer_load_dwordx4 a[52:55], v2, s[8:11], s67 offen sc1
    v_cvt_pk_bf16_f32 v20, v163, v164
    v_mfma_f32_16x16x32_bf16 v[172:175], a[236:239], a[64:67], v[172:175]
    s_waitcnt vmcnt(9)
    v_cvt_pk_bf16_f32 v21, v165, v166
    v_cvt_pk_bf16_f32 v22, v167, v168
    v_mfma_f32_16x16x32_bf16 v[96:99], a[140:143], a[84:87], v[224:227]
    v_cvt_pk_bf16_f32 v23, v169, v169
    v_perm_b32 v23, v23, v13, s72
    v_mfma_f32_16x16x32_bf16 v[96:99], a[160:163], a[104:107], v[96:99]
    s_add_u32 s67, s41, 40960
    buffer_store_dwordx4 v[20:23], v14, s[8:11], s74 offen offset:1024 sc1
    v_mfma_f32_16x16x32_bf16 v[96:99], a[180:183], a[124:127], v[96:99]
    buffer_load_dwordx4 a[72:75], v2, s[8:11], s67 offen sc1
    v_add_f32 v133, v133, v73
    v_mfma_f32_16x16x32_bf16 v[96:99], a[200:203], a[8:11], v[96:99]
    v_cvt_pk_bf16_f32 v24, v170, v171
    v_cvt_pk_bf16_f32 v25, v172, v173
    v_mfma_f32_16x16x32_bf16 v[96:99], a[220:223], a[28:31], v[96:99]
    v_cvt_pk_bf16_f32 v26, v174, v175
    v_mov_b32 v27, v13
    v_mfma_f32_16x16x32_bf16 v[100:103], a[144:147], a[84:87], v[228:231]
    s_add_u32 s67, s41, 45056
    buffer_store_dwordx4 v[24:27], v14, s[8:11], s74 offen offset:2048 sc1
    v_mfma_f32_16x16x32_bf16 v[100:103], a[164:167], a[104:107], v[100:103]
    buffer_load_dwordx4 a[92:95], v2, s[8:11], s67 offen sc1
    v_add_f32 v134, v134, v74
    v_mfma_f32_16x16x32_bf16 v[100:103], a[184:187], a[124:127], v[100:103]
    v_add_f32 v135, v135, v75
    v_mul_f32 v56, s68, v116
    v_mfma_f32_16x16x32_bf16 v[100:103], a[204:207], a[8:11], v[100:103]
    ds_write_b128 v11, v[96:99] offset:0
    v_mfma_f32_16x16x32_bf16 v[100:103], a[224:227], a[28:31], v[100:103]
    v_mul_f32 v57, s68, v117
    v_mul_f32 v58, s68, v118
    v_mfma_f32_16x16x32_bf16 v[104:107], a[148:151], a[84:87], v[232:235]
    v_mul_f32 v59, s68, v119
    v_mfma_f32_16x16x32_bf16 v[104:107], a[168:171], a[104:107], v[104:107]
    s_waitcnt lgkmcnt(0)
    s_cmp_eq_u32 s24, s55
    s_cbranch_scc0 L_spin_sy_gy
L_ret_sy_gy:
    v_mfma_f32_16x16x32_bf16 v[104:107], a[188:191], a[124:127], v[104:107]
    v_exp_f32 v56, v56
    v_mfma_f32_16x16x32_bf16 v[104:107], a[208:211], a[8:11], v[104:107]
    s_barrier
    v_mfma_f32_16x16x32_bf16 v[104:107], a[228:231], a[28:31], v[104:107]
    s_add_u32 s67, s41, 28672
    ds_read_b128 v[136:139], v7 offset:0
    v_mfma_f32_16x16x32_bf16 v[108:111], a[152:155], a[84:87], v[236:239]
    buffer_load_dwordx4 a[112:115], v1, s[8:11], s67 offen sc1
    v_mfma_f32_16x16x32_bf16 v[108:111], a[172:175], a[104:107], v[108:111]
    ds_write_b128 v11, v[100:103] offset:1024
    v_mfma_f32_16x16x32_bf16 v[108:111], a[192:195], a[124:127], v[108:111]
    v_exp_f32 v57, v57
    v_mfma_f32_16x16x32_bf16 v[108:111], a[212:215], a[8:11], v[108:111]
    s_add_u32 s67, s41, 32768
    ds_write_b128 v11, v[104:107] offset:2048
    v_mfma_f32_16x16x32_bf16 v[108:111], a[232:235], a[28:31], v[108:111]
    buffer_load_dwordx4 a[132:135], v1, s[8:11], s67 offen sc1
    v_mfma_f32_16x16x32_bf16 v[112:115], a[156:159], a[84:87], v[240:243]
    s_waitcnt lgkmcnt(1)
    v_exp_f32 v58, v58
    v_mfma_f32_16x16x32_bf16 v[112:115], a[176:179], a[104:107], v[112:115]
    s_barrier
    v_mfma_f32_16x16x32_bf16 v[112:115], a[196:199], a[124:127], v[112:115]
    s_add_u32 s67, s41, 36864
    ds_read_b128 v[140:143], v7 offset:1024
    v_mfma_f32_16x16x32_bf16 v[112:115], a[216:219], a[8:11], v[112:115]
    buffer_load_dwordx4 a[16:19], v1, s[8:11], s67 offen sc1
    v_mfma_f32_16x16x32_bf16 v[112:115], a[236:239], a[28:31], v[112:115]
    s_waitcnt vmcnt(11) lgkmcnt(1)
    ds_write_b128 v11, v[108:111] offset:3072
    v_mfma_f32_16x16x32_bf16 v[136:139], a[140:143], a[48:51], v[136:139]
    s_barrier
    v_mfma_f32_16x16x32_bf16 v[136:139], a[160:163], a[68:71], v[136:139]
    s_add_u32 s67, s41, 40960
    ds_read_b128 v[144:147], v7 offset:2048
    v_mfma_f32_16x16x32_bf16 v[136:139], a[180:183], a[88:91], v[136:139]
    buffer_load_dwordx4 a[36:39], v1, s[8:11], s67 offen sc1
    v_mfma_f32_16x16x32_bf16 v[136:139], a[200:203], a[108:111], v[136:139]
    ds_write_b128 v11, v[112:115] offset:4096
    v_mfma_f32_16x16x32_bf16 v[136:139], a[220:223], a[128:131], v[136:139]
    s_waitcnt lgkmcnt(3)
    v_exp_f32 v59, v59
    v_mfma_f32_16x16x32_bf16 v[140:143], a[144:147], a[48:51], v[140:143]
    s_add_u32 s67, s41, 45056
    v_add_f32 v56, 1.0, v56
    v_add_f32 v57, 1.0, v57
    v_mfma_f32_16x16x32_bf16 v[140:143], a[164:167], a[68:71], v[140:143]
    s_waitcnt lgkmcnt(2)
    buffer_load_dwordx4 a[56:59], v1, s[8:11], s67 offen sc1
    v_add_f32 v58, 1.0, v58
    v_mfma_f32_16x16x32_bf16 v[140:143], a[184:187], a[88:91], v[140:143]
    s_barrier
    v_add_f32 v59, 1.0, v59
    v_mfma_f32_16x16x32_bf16 v[140:143], a[204:207], a[108:111], v[140:143]
    ds_read_b128 v[148:151], v7 offset:3072
    v_mfma_f32_16x16x32_bf16 v[140:143], a[224:227], a[128:131], v[140:143]
    s_waitcnt lgkmcnt(1)
    ds_write_b128 v11, v[136:139] offset:20480
    v_mfma_f32_16x16x32_bf16 v[144:147], a[148:151], a[48:51], v[144:147]
    s_barrier
    v_mfma_f32_16x16x32_bf16 v[144:147], a[168:171], a[68:71], v[144:147]
    ds_read_b128 v[152:155], v7 offset:4096
    v_mfma_f32_16x16x32_bf16 v[144:147], a[188:191], a[88:91], v[144:147]
    v_rcp_f32 v56, v56
    v_mfma_f32_16x16x32_bf16 v[144:147], a[208:211], a[108:111], v[144:147]
    ds_write_b128 v11, v[140:143] offset:21504
    v_mfma_f32_16x16x32_bf16 v[144:147], a[228:231], a[128:131], v[144:147]
    s_waitcnt lgkmcnt(2)
    v_rcp_f32 v57, v57
    v_mfma_f32_16x16x32_bf16 v[148:151], a[152:155], a[48:51], v[148:151]
    s_barrier
    v_mfma_f32_16x16x32_bf16 v[148:151], a[172:175], a[68:71], v[148:151]
    ds_read_b128 v[96:99], v7 offset:20480
    v_mfma_f32_16x16x32_bf16 v[148:151], a[192:195], a[88:91], v[148:151]
    s_waitcnt lgkmcnt(1)
    v_rcp_f32 v58, v58
    v_mfma_f32_16x16x32_bf16 v[148:151], a[212:215], a[108:111], v[148:151]
    s_barrier
    v_mfma_f32_16x16x32_bf16 v[148:151], a[232:235], a[128:131], v[148:151]
    ds_read_b128 v[100:103], v7 offset:21504
    v_mfma_f32_16x16x32_bf16 v[152:155], a[156:159], a[48:51], v[152:155]
    ds_write_b128 v11, v[144:147] offset:22528
    v_mfma_f32_16x16x32_bf16 v[152:155], a[176:179], a[68:71], v[152:155]
    v_rcp_f32 v59, v59
    v_mfma_f32_16x16x32_bf16 v[152:155], a[196:199], a[88:91], v[152:155]
    v_mul_f32 v56, v56, v116
    v_mul_f32 v57, v57, v117
    v_mfma_f32_16x16x32_bf16 v[152:155], a[216:219], a[108:111], v[152:155]
    ds_write_b128 v11, v[148:151] offset:23552
    v_mfma_f32_16x16x32_bf16 v[152:155], a[236:239], a[128:131], v[152:155]
    s_waitcnt vmcnt(5) lgkmcnt(1)
    v_mul_f32 v58, v58, v118
    v_mul_f32 v59, v59, v119
    v_mfma_f32_16x16x32_bf16 v[96:99], a[140:143], a[12:15], v[96:99]
    s_barrier
    v_mul_f32 v60, s68, v120
    v_mfma_f32_16x16x32_bf16 v[96:99], a[160:163], a[32:35], v[96:99]
    ds_read_b128 v[104:107], v7 offset:22528
    v_mul_f32 v61, s68, v121
    v_mfma_f32_16x16x32_bf16 v[96:99], a[180:183], a[52:55], v[96:99]
    s_waitcnt lgkmcnt(1)
    v_mul_f32 v62, s68, v122
    v_mul_f32 v63, s68, v123
    v_mfma_f32_16x16x32_bf16 v[96:99], a[200:203], a[72:75], v[96:99]
    s_barrier
    v_mfma_f32_16x16x32_bf16 v[96:99], a[220:223], a[92:95], v[96:99]
    ds_read_b128 v[108:111], v7 offset:23552
    v_mfma_f32_16x16x32_bf16 v[100:103], a[144:147], a[12:15], v[100:103]
    ds_write_b128 v11, v[152:155] offset:24576
    v_mfma_f32_16x16x32_bf16 v[100:103], a[164:167], a[32:35], v[100:103]
    v_exp_f32 v60, v60
    v_mfma_f32_16x16x32_bf16 v[100:103], a[184:187], a[52:55], v[100:103]
    v_exp_f32 v61, v61
    v_mfma_f32_16x16x32_bf16 v[100:103], a[204:207], a[72:75], v[100:103]
    ds_write_b128 v11, v[96:99] offset:0
    v_mfma_f32_16x16x32_bf16 v[100:103], a[224:227], a[92:95], v[100:103]
    s_waitcnt lgkmcnt(1)
    v_exp_f32 v62, v62
    v_mfma_f32_16x16x32_bf16 v[104:107], a[148:151], a[12:15], v[104:107]
    s_barrier
    v_mfma_f32_16x16x32_bf16 v[104:107], a[168:171], a[32:35], v[104:107]
    ds_read_b128 v[112:115], v7 offset:24576
    v_mfma_f32_16x16x32_bf16 v[104:107], a[188:191], a[52:55], v[104:107]
    s_waitcnt lgkmcnt(1)
    v_exp_f32 v63, v63
    v_mfma_f32_16x16x32_bf16 v[104:107], a[208:211], a[72:75], v[104:107]
    s_barrier
    v_add_f32 v60, 1.0, v60
    v_mfma_f32_16x16x32_bf16 v[104:107], a[228:231], a[92:95], v[104:107]
    ds_read_b128 v[136:139], v7 offset:0
    buffer_load_dwordx4 v[244:247], v14, s[8:11], s65 offen offset:0 sc1
    v_mfma_f32_16x16x32_bf16 v[108:111], a[152:155], a[12:15], v[108:111]
    ds_write_b128 v11, v[100:103] offset:1024
    v_mfma_f32_16x16x32_bf16 v[108:111], a[172:175], a[32:35], v[108:111]
    buffer_load_dwordx4 v[248:251], v14, s[8:11], s65 offen offset:1024 sc1
    v_add_f32 v61, 1.0, v61
    v_mfma_f32_16x16x32_bf16 v[108:111], a[192:195], a[52:55], v[108:111]
    v_add_f32 v62, 1.0, v62
    v_add_f32 v63, 1.0, v63
    v_mfma_f32_16x16x32_bf16 v[108:111], a[212:215], a[72:75], v[108:111]
    ds_write_b128 v11, v[104:107] offset:2048
    v_mfma_f32_16x16x32_bf16 v[108:111], a[232:235], a[92:95], v[108:111]
    s_waitcnt lgkmcnt(1)
    buffer_load_dwordx4 v[252:255], v14, s[8:11], s65 offen offset:2048 sc1
    v_mfma_f32_16x16x32_bf16 v[112:115], a[156:159], a[12:15], v[112:115]
    s_barrier
    v_mfma_f32_16x16x32_bf16 v[112:115], a[176:179], a[32:35], v[112:115]
    ds_read_b128 v[140:143], v7 offset:1024
    v_mfma_f32_16x16x32_bf16 v[112:115], a[196:199], a[52:55], v[112:115]
    s_waitcnt lgkmcnt(1)
    v_rcp_f32 v60, v60
    v_mfma_f32_16x16x32_bf16 v[112:115], a[216:219], a[72:75], v[112:115]
    s_barrier
    v_mfma_f32_16x16x32_bf16 v[112:115], a[236:239], a[92:95], v[112:115]
    s_waitcnt vmcnt(3)
    ds_read_b128 v[144:147], v7 offset:2048
    v_mfma_f32_16x16x32_bf16 v[136:139], a[140:143], a[112:115], v[136:139]
    ds_write_b128 v11, v[108:111] offset:3072
    v_mfma_f32_16x16x32_bf16 v[136:139], a[160:163], a[132:135], v[136:139]
    v_rcp_f32 v61, v61
    v_mfma_f32_16x16x32_bf16 v[136:139], a[180:183], a[16:19], v[136:139]
    v_rcp_f32 v62, v62
    v_mfma_f32_16x16x32_bf16 v[136:139], a[200:203], a[36:39], v[136:139]
    ds_write_b128 v11, v[112:115] offset:4096
    v_mfma_f32_16x16x32_bf16 v[136:139], a[220:223], a[56:59], v[136:139]
    s_waitcnt lgkmcnt(1)
    v_rcp_f32 v63, v63
    v_mfma_f32_16x16x32_bf16 v[140:143], a[144:147], a[112:115], v[140:143]
    s_barrier
    v_mul_f32 v60, v60, v120
    v_mfma_f32_16x16x32_bf16 v[140:143], a[164:167], a[132:135], v[140:143]
    ds_read_b128 v[148:151], v7 offset:3072
    v_mul_f32 v61, v61, v121
    v_mfma_f32_16x16x32_bf16 v[140:143], a[184:187], a[16:19], v[140:143]
    s_waitcnt lgkmcnt(1)
    v_mul_f32 v62, v62, v122
    v_mul_f32 v63, v63, v123
    v_mfma_f32_16x16x32_bf16 v[140:143], a[204:207], a[36:39], v[140:143]
    s_barrier
    v_mul_f32 v64, s68, v124
    v_mfma_f32_16x16x32_bf16 v[140:143], a[224:227], a[56:59], v[140:143]
    ds_read_b128 v[152:155], v7 offset:4096
    v_mul_f32 v65, s68, v125
    v_mfma_f32_16x16x32_bf16 v[144:147], a[148:151], a[112:115], v[144:147]
    v_mul_f32 v66, s68, v126
    v_mul_f32 v67, s68, v127
    v_mfma_f32_16x16x32_bf16 v[144:147], a[168:171], a[132:135], v[144:147]
    v_exp_f32 v64, v64
    v_mfma_f32_16x16x32_bf16 v[144:147], a[188:191], a[16:19], v[144:147]
    v_exp_f32 v65, v65
    v_mfma_f32_16x16x32_bf16 v[144:147], a[208:211], a[36:39], v[144:147]
    v_exp_f32 v66, v66
    v_mfma_f32_16x16x32_bf16 v[144:147], a[228:231], a[56:59], v[144:147]
    s_waitcnt lgkmcnt(1)
    v_exp_f32 v67, v67
    v_mfma_f32_16x16x32_bf16 v[148:151], a[152:155], a[112:115], v[148:151]
    v_add_f32 v64, 1.0, v64
    v_add_f32 v65, 1.0, v65
    v_mfma_f32_16x16x32_bf16 v[148:151], a[172:175], a[132:135], v[148:151]
    s_waitcnt lgkmcnt(0)
    v_add_f32 v66, 1.0, v66
    v_add_f32 v67, 1.0, v67
    v_mfma_f32_16x16x32_bf16 v[148:151], a[192:195], a[16:19], v[148:151]
    v_rcp_f32 v64, v64
    v_mfma_f32_16x16x32_bf16 v[148:151], a[212:215], a[36:39], v[148:151]
    v_rcp_f32 v65, v65
    v_mfma_f32_16x16x32_bf16 v[148:151], a[232:235], a[56:59], v[148:151]
    v_rcp_f32 v66, v66
    v_mfma_f32_16x16x32_bf16 v[152:155], a[156:159], a[112:115], v[152:155]
    v_rcp_f32 v67, v67
    v_mfma_f32_16x16x32_bf16 v[152:155], a[176:179], a[132:135], v[152:155]
    v_mul_f32 v64, v64, v124
    v_mul_f32 v65, v65, v125
    v_mfma_f32_16x16x32_bf16 v[152:155], a[196:199], a[16:19], v[152:155]
    v_mul_f32 v66, v66, v126
    v_mul_f32 v67, v67, v127
    v_mfma_f32_16x16x32_bf16 v[152:155], a[216:219], a[36:39], v[152:155]
    v_mfma_f32_16x16x32_bf16 v[152:155], a[236:239], a[56:59], v[152:155]
    s_waitcnt vmcnt(2)
    v_xor_b32 v8, s55, v247
    s_waitcnt vmcnt(1)
    v_bitop3_b32 v8, v8, v251, s55 bitop3:0xf6
    s_waitcnt vmcnt(0)
    v_bitop3_b32 v8, v8, v255, s55 bitop3:0xf6
    v_and_b32 v8, 0xffff, v8
    v_cmp_ne_u32 vcc, 0, v8
    s_nop 3
    s_cbranch_vccnz L_spin_sy_xy
L_ret_sy_xy:
    v_lshlrev_b32 v76, 16, v244
    v_and_b32 v77, 0xffff0000, v244
    v_lshlrev_b32 v78, 16, v245
    v_and_b32 v79, 0xffff0000, v245
    v_pk_add_f32 v[136:137], v[136:137], v[76:77]
    v_pk_add_f32 v[138:139], v[138:139], v[78:79]
    v_pk_fma_f32 v[56:57], v[56:57], v[136:137], v[36:37]
    v_pk_fma_f32 v[58:59], v[58:59], v[138:139], v[38:39]
    global_store_dwordx4 v10, v[56:59], s[12:13] offset:0 sc1
    v_lshlrev_b32 v80, 16, v246
    v_and_b32 v81, 0xffff0000, v246
    v_and_b32 v82, 0xffff0000, v247
    v_lshlrev_b32 v83, 16, v248
    v_pk_add_f32 v[140:141], v[140:141], v[80:81]
    v_pk_add_f32 v[142:143], v[142:143], v[82:83]
    v_pk_fma_f32 v[60:61], v[60:61], v[140:141], v[40:41]
    v_pk_fma_f32 v[62:63], v[62:63], v[142:143], v[42:43]
    global_store_dwordx4 v10, v[60:63], s[12:13] offset:64 sc1
    v_and_b32 v84, 0xffff0000, v248
    v_lshlrev_b32 v85, 16, v249
    v_and_b32 v86, 0xffff0000, v249
    v_lshlrev_b32 v87, 16, v250
    v_pk_add_f32 v[144:145], v[144:145], v[84:85]
    v_pk_add_f32 v[146:147], v[146:147], v[86:87]
    v_pk_fma_f32 v[64:65], v[64:65], v[144:145], v[44:45]
    v_pk_fma_f32 v[66:67], v[66:67], v[146:147], v[46:47]
    global_store_dwordx4 v10, v[64:67], s[12:13] offset:128 sc1
    v_pk_mul_f32 v[68:69], v[128:129], s[68:69]
    v_pk_mul_f32 v[70:71], v[130:131], s[68:69]
    v_exp_f32 v68, v68
    v_exp_f32 v69, v69
    v_exp_f32 v70, v70
    v_exp_f32 v71, v71
    v_pk_add_f32 v[68:69], v[68:69], 1.0 op_sel_hi:[1,0]
    v_pk_add_f32 v[70:71], v[70:71], 1.0 op_sel_hi:[1,0]
    v_rcp_f32 v68, v68
    v_rcp_f32 v69, v69
    v_rcp_f32 v70, v70
    v_rcp_f32 v71, v71
    v_pk_mul_f32 v[68:69], v[68:69], v[128:129]
    v_pk_mul_f32 v[70:71], v[70:71], v[130:131]
    v_and_b32 v88, 0xffff0000, v250
    v_and_b32 v89, 0xffff0000, v251
    v_lshlrev_b32_e64 v90, 16, v252
    v_and_b32 v91, 0xffff0000, v252
    v_pk_add_f32 v[148:149], v[148:149], v[88:89]
    v_pk_add_f32 v[150:151], v[150:151], v[90:91]
    v_pk_fma_f32 v[68:69], v[68:69], v[148:149], v[48:49]
    v_pk_fma_f32 v[70:71], v[70:71], v[150:151], v[50:51]
    global_store_dwordx4 v10, v[68:71], s[12:13] offset:192 sc1
    v_pk_mul_f32 v[72:73], v[132:133], s[68:69]
    v_pk_mul_f32 v[74:75], v[134:135], s[68:69]
    v_exp_f32 v72, v72
    v_exp_f32 v73, v73
    v_exp_f32 v74, v74
    v_exp_f32 v75, v75
    v_pk_add_f32 v[72:73], v[72:73], 1.0 op_sel_hi:[1,0]
    v_pk_add_f32 v[74:75], v[74:75], 1.0 op_sel_hi:[1,0]
    v_rcp_f32 v72, v72
    v_rcp_f32 v73, v73
    v_rcp_f32 v74, v74
    v_rcp_f32 v75, v75
    v_pk_mul_f32 v[72:73], v[72:73], v[132:133]
    v_pk_mul_f32 v[74:75], v[74:75], v[134:135]
    v_lshlrev_b32 v92, 16, v253
    v_and_b32 v93, 0xffff0000, v253
    v_lshlrev_b32 v94, 16, v254
    v_and_b32 v95, 0xffff0000, v254
    v_pk_add_f32 v[152:153], v[152:153], v[92:93]
    v_pk_add_f32 v[154:155], v[154:155], v[94:95]
    v_pk_fma_f32 v[72:73], v[72:73], v[152:153], v[52:53]
    v_pk_fma_f32 v[74:75], v[74:75], v[154:155], v[54:55]
    global_store_dwordx4 v10, v[72:75], s[12:13] offset:256 sc1
    s_lshl_b32 s70, s52, 8
    s_or_b32 s70, s70, s2
    s_cmp_eq_u32 s70, 191
    s_mov_b32 s70, 17268736
    s_cselect_b32 s70, s70, 1073741824
    s_mov_b64 exec, 1
    buffer_store_dword v13, v14, s[8:11], s70 offen sc1
    s_mov_b64 exec, -1
    s_endpgm
L_spins:
L_spin_pf_ff:
    s_mov_b32 s71, 0
L_spinl_pf_ff0:
    s_sleep 2
    s_buffer_load_dwordx8 s[28:35], s[8:11], s49 offset:0 glc
    s_waitcnt lgkmcnt(0)
    s_add_u32 s71, s71, 1
    s_cmp_gt_u32 s71, 40000
    s_cbranch_scc1 L_ret_pf_ff
    s_cmp_eq_u32 s28, s55
    s_cselect_b32 s28, s29, s28
    s_cmp_eq_u32 s28, s55
    s_cselect_b32 s28, s30, s28
    s_cmp_eq_u32 s28, s55
    s_cselect_b32 s28, s31, s28
    s_cmp_eq_u32 s28, s55
    s_cselect_b32 s28, s32, s28
    s_cmp_eq_u32 s28, s55
    s_cselect_b32 s28, s33, s28
    s_cmp_eq_u32 s28, s55
    s_cselect_b32 s28, s34, s28
    s_cmp_eq_u32 s28, s55
    s_cbranch_scc0 L_spinl_pf_ff0
L_spinl_pf_ff1:
    s_sleep 2
    s_buffer_load_dwordx8 s[28:35], s[8:11], s49 offset:256 glc
    s_waitcnt lgkmcnt(0)
    s_add_u32 s71, s71, 1
    s_cmp_gt_u32 s71, 40000
    s_cbranch_scc1 L_ret_pf_ff
    s_cmp_eq_u32 s28, s55
    s_cselect_b32 s28, s29, s28
    s_cmp_eq_u32 s28, s55
    s_cselect_b32 s28, s30, s28
    s_cmp_eq_u32 s28, s55
    s_cselect_b32 s28, s31, s28
    s_cmp_eq_u32 s28, s55
    s_cselect_b32 s28, s32, s28
    s_cmp_eq_u32 s28, s55
    s_cselect_b32 s28, s33, s28
    s_cmp_eq_u32 s28, s55
    s_cselect_b32 s28, s34, s28
    s_cmp_eq_u32 s28, s55
    s_cbranch_scc0 L_spinl_pf_ff1
    s_branch L_ret_pf_ff
L_spin_ext:
    s_mov_b32 s71, 0
L_spinl_ext:
    s_sleep 1
    buffer_load_dwordx2 v[168:169], v219, s[8:11], s74 offen offset:0 sc1
    buffer_load_dwordx2 v[170:171], v219, s[8:11], s74 offen offset:256 sc1
    buffer_load_dwordx4 v[172:175], v220, s[8:11], s75 offen offset:0 sc1
    buffer_load_dwordx4 v[176:179], v220, s[8:11], s75 offen offset:1024 sc1
    buffer_load_dwordx4 v[180:183], v220, s[8:11], s75 offen offset:2048 sc1
    s_waitcnt vmcnt(0)
    v_xor_b32 v12, s55, v169
    v_bitop3_b32 v12, v12, v171, s55 bitop3:0xf6
    v_bitop3_b32 v12, v12, v173, s55 bitop3:0xf6
    v_bitop3_b32 v12, v12, v175, s55 bitop3:0xf6
    v_bitop3_b32 v12, v12, v177, s55 bitop3:0xf6
    v_bitop3_b32 v12, v12, v179, s55 bitop3:0xf6
    v_bitop3_b32 v12, v12, v181, s55 bitop3:0xf6
    v_bitop3_b32 v12, v12, v183, s55 bitop3:0xf6
    s_add_u32 s71, s71, 1
    s_cmp_gt_u32 s71, 20000
    s_cbranch_scc1 L_ret_ext
    v_cmp_ne_u32 vcc, 0, v12
    s_nop 3
    s_cbranch_vccnz L_spinl_ext
    s_branch L_ret_ext
L_spin_sy_a01:
    s_mov_b32 s71, 0
L_spinl_sy_a01:
    s_buffer_load_dwordx8 s[24:31], s[8:11], s42 offset:0 glc
    s_waitcnt lgkmcnt(0)
    s_add_u32 s71, s71, 1
    s_cmp_gt_u32 s71, 40000
    s_cbranch_scc1 L_ret_sy_a01
    s_cmp_eq_u32 s24, s55
    s_cselect_b32 s24, s25, s24
    s_cmp_eq_u32 s24, s55
    s_cselect_b32 s24, s26, s24
    s_cmp_eq_u32 s24, s55
    s_cselect_b32 s24, s27, s24
    s_cmp_eq_u32 s24, s55
    s_cbranch_scc0 L_spinl_sy_a01
    s_branch L_ret_sy_a01
L_spin_pf_sf:
    s_mov_b32 s71, 0
L_spinl_pf_sf0:
    s_sleep 2
    s_buffer_load_dwordx8 s[32:39], s[8:11], s49 offset:0 glc
    s_waitcnt lgkmcnt(0)
    s_add_u32 s71, s71, 1
    s_cmp_gt_u32 s71, 40000
    s_cbranch_scc1 L_ret_pf_sf
    s_cmp_eq_u32 s32, s55
    s_cselect_b32 s32, s33, s32
    s_cmp_eq_u32 s32, s55
    s_cselect_b32 s32, s34, s32
    s_cmp_eq_u32 s32, s55
    s_cselect_b32 s32, s35, s32
    s_cmp_eq_u32 s32, s55
    s_cselect_b32 s32, s36, s32
    s_cmp_eq_u32 s32, s55
    s_cselect_b32 s32, s37, s32
    s_cmp_eq_u32 s32, s55
    s_cselect_b32 s32, s38, s32
    s_cmp_eq_u32 s32, s55
    s_cbranch_scc0 L_spinl_pf_sf0
L_spinl_pf_sf1:
    s_sleep 2
    s_buffer_load_dwordx8 s[32:39], s[8:11], s49 offset:256 glc
    s_waitcnt lgkmcnt(0)
    s_add_u32 s71, s71, 1
    s_cmp_gt_u32 s71, 40000
    s_cbranch_scc1 L_ret_pf_sf
    s_cmp_eq_u32 s32, s55
    s_cselect_b32 s32, s33, s32
    s_cmp_eq_u32 s32, s55
    s_cselect_b32 s32, s34, s32
    s_cmp_eq_u32 s32, s55
    s_cselect_b32 s32, s35, s32
    s_cmp_eq_u32 s32, s55
    s_cselect_b32 s32, s36, s32
    s_cmp_eq_u32 s32, s55
    s_cselect_b32 s32, s37, s32
    s_cmp_eq_u32 s32, s55
    s_cselect_b32 s32, s38, s32
    s_cmp_eq_u32 s32, s55
    s_cbranch_scc0 L_spinl_pf_sf1
    s_branch L_ret_pf_sf
L_spin_pf_sy:
    s_mov_b32 s71, 0
L_spinl_pf_sy0:
    s_sleep 2
    s_buffer_load_dwordx8 s[32:39], s[8:11], s50 offset:0 glc
    s_waitcnt lgkmcnt(0)
    s_add_u32 s71, s71, 1
    s_cmp_gt_u32 s71, 40000
    s_cbranch_scc1 L_ret_pf_sy
    s_cmp_eq_u32 s32, s55
    s_cselect_b32 s32, s33, s32
    s_cmp_eq_u32 s32, s55
    s_cselect_b32 s32, s34, s32
    s_cmp_eq_u32 s32, s55
    s_cselect_b32 s32, s35, s32
    s_cmp_eq_u32 s32, s55
    s_cselect_b32 s32, s36, s32
    s_cmp_eq_u32 s32, s55
    s_cbranch_scc0 L_spinl_pf_sy0
    s_branch L_ret_pf_sy
L_spin_ext5:
    s_mov_b32 s71, 0
L_spinl_ext5:
    s_sleep 1
    buffer_load_dwordx2 v[220:221], v223, s[8:11], s73 offen sc1
    buffer_load_dwordx4 v[208:211], v224, s[8:11], s74 offen offset:0 sc1
    buffer_load_dwordx4 v[212:215], v225, s[8:11], s74 offen offset:256 sc1
    buffer_load_dwordx4 v[216:219], v225, s[8:11], s74 offen offset:512 sc1
    s_waitcnt vmcnt(0)
    v_xor_b32_e64 v12, v13, v221
    v_bitop3_b32 v12, v12, v209, v13 bitop3:0xf6
    v_bitop3_b32 v12, v12, v211, v13 bitop3:0xf6
    v_bitop3_b32 v12, v12, v213, v222 bitop3:0xf6
    v_bitop3_b32 v12, v12, v215, v222 bitop3:0xf6
    v_bitop3_b32 v12, v12, v217, v222 bitop3:0xf6
    v_bitop3_b32 v12, v12, v219, v222 bitop3:0xf6
    s_add_u32 s71, s71, 1
    s_cmp_gt_u32 s71, 20000
    s_cbranch_scc1 L_ret_ext5
    v_cmp_ne_u32 vcc, 0, v12
    s_nop 3
    s_cbranch_vccnz L_spinl_ext5
    s_branch L_ret_ext5
L_spin_est:
    s_mov_b32 s71, 0
L_spinl_est:
    s_sleep 1
    s_mov_b32 exec_hi, 0xffff
    buffer_load_dwordx4 v[228:231], v14, s[8:11], s32 offen sc1
    buffer_load_dwordx4 v[232:235], v14, s[8:11], s33 offen sc1
    buffer_load_dwordx4 v[236:239], v14, s[8:11], s34 offen sc1
    buffer_load_dwordx4 v[240:243], v14, s[8:11], s35 offen sc1
    s_mov_b32 exec_hi, -1
    s_waitcnt vmcnt(0)
    v_xor_b32 v130, v13, v228
    v_bitop3_b32 v130, v130, v229, v224 bitop3:0xf6
    v_bitop3_b32 v130, v130, v230, v13 bitop3:0xf6
    v_bitop3_b32 v130, v130, v231, v224 bitop3:0xf6
    v_and_b32 v131, s36, v130
    v_xor_b32 v130, v13, v232
    v_bitop3_b32 v130, v130, v233, v224 bitop3:0xf6
    v_bitop3_b32 v130, v130, v234, v13 bitop3:0xf6
    v_bitop3_b32 v130, v130, v235, v224 bitop3:0xf6
    v_and_or_b32 v131, v130, s37, v131
    v_xor_b32 v130, v13, v236
    v_bitop3_b32 v130, v130, v237, v224 bitop3:0xf6
    v_bitop3_b32 v130, v130, v238, v13 bitop3:0xf6
    v_bitop3_b32 v130, v130, v239, v224 bitop3:0xf6
    v_and_or_b32 v131, v130, s38, v131
    v_xor_b32 v130, v13, v240
    v_bitop3_b32 v130, v130, v241, v224 bitop3:0xf6
    v_bitop3_b32 v130, v130, v242, v13 bitop3:0xf6
    v_bitop3_b32 v130, v130, v243, v224 bitop3:0xf6
    v_and_or_b32 v131, v130, s39, v131
    v_cmp_ne_u32 vcc, 0, v131
    s_add_u32 s71, s71, 1
    s_cmp_gt_u32 s71, 20000
    s_cbranch_scc1 L_ret_est
    s_and_b32 vcc_hi, vcc_hi, 0xffff
    s_cmp_eq_u64 vcc, 0
    s_cbranch_scc0 L_spinl_est
    s_branch L_ret_est
L_spin_pf_fy:
    s_mov_b32 s71, 0
L_spinl_pf_fy0:
    s_sleep 2
    s_buffer_load_dwordx8 s[28:35], s[8:11], s50 offset:0 glc
    s_waitcnt lgkmcnt(0)
    s_add_u32 s71, s71, 1
    s_cmp_gt_u32 s71, 40000
    s_cbranch_scc1 L_ret_pf_fy
    s_cmp_eq_u32 s28, s55
    s_cselect_b32 s28, s29, s28
    s_cmp_eq_u32 s28, s55
    s_cselect_b32 s28, s30, s28
    s_cmp_eq_u32 s28, s55
    s_cselect_b32 s28, s31, s28
    s_cmp_eq_u32 s28, s55
    s_cselect_b32 s28, s32, s28
    s_cmp_eq_u32 s28, s55
    s_cbranch_scc0 L_spinl_pf_fy0
    s_branch L_ret_pf_fy
L_spin_ff_a0:
    s_mov_b32 s71, 0
L_spinl_ff_a0:
    s_buffer_load_dwordx8 s[24:31], s[8:11], s42 offset:0 glc
    s_waitcnt lgkmcnt(0)
    s_add_u32 s71, s71, 1
    s_cmp_gt_u32 s71, 40000
    s_cbranch_scc1 L_ret_ff_a0
    s_cmp_eq_u32 s24, s55
    s_cselect_b32 s24, s25, s24
    s_cmp_eq_u32 s24, s55
    s_cbranch_scc0 L_spinl_ff_a0
    s_branch L_ret_ff_a0
L_spin_ff_a1:
    s_mov_b32 s71, 0
L_spinl_ff_a1:
    s_buffer_load_dwordx8 s[32:39], s[8:11], s42 offset:8 glc
    s_waitcnt lgkmcnt(0)
    s_add_u32 s71, s71, 1
    s_cmp_gt_u32 s71, 40000
    s_cbranch_scc1 L_ret_ff_a1
    s_cmp_eq_u32 s32, s55
    s_cselect_b32 s32, s33, s32
    s_cmp_eq_u32 s32, s55
    s_cbranch_scc0 L_spinl_ff_a1
    s_branch L_ret_ff_a1
L_spin_ff_a2:
    s_mov_b32 s71, 0
L_spinl_ff_a2:
    s_buffer_load_dwordx8 s[24:31], s[8:11], s42 offset:16 glc
    s_waitcnt lgkmcnt(0)
    s_add_u32 s71, s71, 1
    s_cmp_gt_u32 s71, 40000
    s_cbranch_scc1 L_ret_ff_a2
    s_cmp_lg_u32 s3, 0
    s_cselect_b32 s26, s55, s26
    s_cmp_eq_u32 s24, s55
    s_cselect_b32 s24, s25, s24
    s_cmp_eq_u32 s24, s55
    s_cselect_b32 s24, s26, s24
    s_cmp_eq_u32 s24, s55
    s_cbranch_scc0 L_spinl_ff_a2
    s_branch L_ret_ff_a2
L_spin_ff_a3:
    s_mov_b32 s71, 0
L_spinl_ff_a3:
    s_buffer_load_dwordx8 s[32:39], s[8:11], s43 offset:0 glc
    s_waitcnt lgkmcnt(0)
    s_add_u32 s71, s71, 1
    s_cmp_gt_u32 s71, 40000
    s_cbranch_scc1 L_ret_ff_a3
    s_cmp_lg_u32 s3, 0
    s_cselect_b32 s38, s55, s38
    s_cmp_eq_u32 s32, s55
    s_cselect_b32 s32, s33, s32
    s_cmp_eq_u32 s32, s55
    s_cselect_b32 s32, s34, s32
    s_cmp_eq_u32 s32, s55
    s_cselect_b32 s32, s35, s32
    s_cmp_eq_u32 s32, s55
    s_cselect_b32 s32, s36, s32
    s_cmp_eq_u32 s32, s55
    s_cselect_b32 s32, s37, s32
    s_cmp_eq_u32 s32, s55
    s_cselect_b32 s32, s38, s32
    s_cmp_eq_u32 s32, s55
    s_cbranch_scc0 L_spinl_ff_a3
    s_branch L_ret_ff_a3
L_spin_ff_yf:
    s_mov_b32 s71, 0
L_spinl_ff_yf:
    s_buffer_load_dwordx8 s[24:31], s[8:11], s42 offset:28 glc
    s_buffer_load_dwordx8 s[32:39], s[8:11], s43 offset:28 glc
    s_waitcnt lgkmcnt(0)
    s_add_u32 s71, s71, 1
    s_cmp_gt_u32 s71, 40000
    s_cbranch_scc1 L_ret_ff_yf
    s_cmp_eq_u32 s24, s55
    s_cselect_b32 s24, s25, s24
    s_cmp_eq_u32 s24, s55
    s_cselect_b32 s24, s26, s24
    s_cmp_eq_u32 s24, s55
    s_cselect_b32 s24, s27, s24
    s_cmp_eq_u32 s24, s55
    s_cselect_b32 s24, s28, s24
    s_cmp_eq_u32 s24, s55
    s_cselect_b32 s24, s32, s24
    s_cmp_eq_u32 s24, s55
    s_cselect_b32 s24, s33, s24
    s_cmp_eq_u32 s24, s55
    s_cselect_b32 s24, s34, s24
    s_cmp_eq_u32 s24, s55
    s_cselect_b32 s24, s35, s24
    s_cmp_eq_u32 s24, s55
    s_cselect_b32 s24, s36, s24
    s_cmp_eq_u32 s24, s55
    s_cbranch_scc0 L_spinl_ff_yf
    s_branch L_ret_ff_yf
L_spin_ff_st:
    s_mov_b32 s71, 0
L_spinl_ff_st:
    s_sleep 1
    buffer_load_dwordx2 v[254:255], v12, s[8:11], s48 offen sc1
    s_waitcnt vmcnt(0)
    s_add_u32 s71, s71, 1
    s_cmp_gt_u32 s71, 20000
    s_cbranch_scc1 L_ret_ff_st
    v_cmp_ne_u32 vcc, s55, v255
    s_nop 3
    s_cbranch_vccnz L_spinl_ff_st
    s_branch L_ret_ff_st
L_spin_ff_gf:
    s_mov_b32 s71, 0
L_spinl_ff_gf:
    s_buffer_load_dword s24, s[8:11], s45 offset:12 glc
    s_waitcnt lgkmcnt(0)
    s_add_u32 s71, s71, 1
    s_cmp_gt_u32 s71, 40000
    s_cbranch_scc1 L_ret_ff_gf
    s_xor_b32 s24, s24, s55
    s_and_b32 s24, s24, 0xffff
    s_cmp_eq_u32 s24, 0
    s_cbranch_scc0 L_spinl_ff_gf
    s_branch L_ret_ff_gf
L_spin_ff_gy:
    s_mov_b32 s71, 0
L_spinl_ff_gy:
    s_buffer_load_dword s24, s[8:11], s45 offset:6144 glc
    s_waitcnt lgkmcnt(0)
    s_add_u32 s71, s71, 1
    s_cmp_gt_u32 s71, 40000
    s_cbranch_scc1 L_ret_ff_gy
    s_cmp_eq_u32 s24, s55
    s_cbranch_scc0 L_spinl_ff_gy
    s_branch L_ret_ff_gy
L_spin_ff_xf:
    s_mov_b32 s71, 0
L_spinl_ff_xf:
    s_sleep 1
    buffer_load_dwordx4 v[76:79], v14, s[8:11], s45 offen offset:0 sc1
    buffer_load_dwordx4 v[80:83], v14, s[8:11], s45 offen offset:1024 sc1
    buffer_load_dwordx4 v[84:87], v14, s[8:11], s45 offen offset:2048 sc1
    s_waitcnt vmcnt(0)
    v_xor_b32 v8, s55, v79
    v_bitop3_b32 v8, v8, v83, s55 bitop3:0xf6
    v_bitop3_b32 v8, v8, v87, s55 bitop3:0xf6
    v_and_b32 v8, 0xffff, v8
    s_add_u32 s71, s71, 1
    s_cmp_gt_u32 s71, 20000
    s_cbranch_scc1 L_ret_ff_xf
    v_cmp_ne_u32 vcc, 0, v8
    s_nop 3
    s_cbranch_vccnz L_spinl_ff_xf
    s_branch L_ret_ff_xf
L_spin_ff_xy:
    s_mov_b32 s71, 0
L_spinl_ff_xy:
    s_sleep 1
    buffer_load_dwordx4 v[244:247], v14, s[8:11], s65 offen offset:0 sc1
    buffer_load_dwordx4 v[248:251], v14, s[8:11], s65 offen offset:1024 sc1
    buffer_load_dwordx4 v[252:255], v14, s[8:11], s65 offen offset:2048 sc1
    s_waitcnt vmcnt(0)
    v_xor_b32 v8, s55, v247
    v_bitop3_b32 v8, v8, v251, s55 bitop3:0xf6
    v_bitop3_b32 v8, v8, v255, s55 bitop3:0xf6
    v_and_b32 v8, 0xffff, v8
    s_add_u32 s71, s71, 1
    s_cmp_gt_u32 s71, 20000
    s_cbranch_scc1 L_ret_ff_xy
    v_cmp_ne_u32 vcc, 0, v8
    s_nop 3
    s_cbranch_vccnz L_spinl_ff_xy
    s_branch L_ret_ff_xy
L_spin_sy_a2:
    s_mov_b32 s71, 0
L_spinl_sy_a2:
    s_buffer_load_dwordx8 s[24:31], s[8:11], s42 offset:16 glc
    s_waitcnt lgkmcnt(0)
    s_add_u32 s71, s71, 1
    s_cmp_gt_u32 s71, 40000
    s_cbranch_scc1 L_ret_sy_a2
    s_cmp_lg_u32 s3, 0
    s_cselect_b32 s26, s55, s26
    s_cmp_eq_u32 s24, s55
    s_cselect_b32 s24, s25, s24
    s_cmp_eq_u32 s24, s55
    s_cselect_b32 s24, s26, s24
    s_cmp_eq_u32 s24, s55
    s_cbranch_scc0 L_spinl_sy_a2
    s_branch L_ret_sy_a2
L_spin_sy_a3:
    s_mov_b32 s71, 0
L_spinl_sy_a3:
    s_buffer_load_dwordx8 s[32:39], s[8:11], s43 offset:0 glc
    s_waitcnt lgkmcnt(0)
    s_add_u32 s71, s71, 1
    s_cmp_gt_u32 s71, 40000
    s_cbranch_scc1 L_ret_sy_a3
    s_cmp_lg_u32 s3, 0
    s_cselect_b32 s38, s55, s38
    s_cmp_eq_u32 s32, s55
    s_cselect_b32 s32, s33, s32
    s_cmp_eq_u32 s32, s55
    s_cselect_b32 s32, s34, s32
    s_cmp_eq_u32 s32, s55
    s_cselect_b32 s32, s35, s32
    s_cmp_eq_u32 s32, s55
    s_cselect_b32 s32, s36, s32
    s_cmp_eq_u32 s32, s55
    s_cselect_b32 s32, s37, s32
    s_cmp_eq_u32 s32, s55
    s_cselect_b32 s32, s38, s32
    s_cmp_eq_u32 s32, s55
    s_cbranch_scc0 L_spinl_sy_a3
    s_branch L_ret_sy_a3
L_spin_sy_yf:
    s_mov_b32 s71, 0
L_spinl_sy_yf:
    s_buffer_load_dwordx8 s[24:31], s[8:11], s42 offset:28 glc
    s_buffer_load_dwordx8 s[32:39], s[8:11], s43 offset:28 glc
    s_waitcnt lgkmcnt(0)
    s_add_u32 s71, s71, 1
    s_cmp_gt_u32 s71, 40000
    s_cbranch_scc1 L_ret_sy_yf
    s_cmp_eq_u32 s24, s55
    s_cselect_b32 s24, s25, s24
    s_cmp_eq_u32 s24, s55
    s_cselect_b32 s24, s26, s24
    s_cmp_eq_u32 s24, s55
    s_cselect_b32 s24, s27, s24
    s_cmp_eq_u32 s24, s55
    s_cselect_b32 s24, s28, s24
    s_cmp_eq_u32 s24, s55
    s_cselect_b32 s24, s32, s24
    s_cmp_eq_u32 s24, s55
    s_cselect_b32 s24, s33, s24
    s_cmp_eq_u32 s24, s55
    s_cselect_b32 s24, s34, s24
    s_cmp_eq_u32 s24, s55
    s_cselect_b32 s24, s35, s24
    s_cmp_eq_u32 s24, s55
    s_cselect_b32 s24, s36, s24
    s_cmp_eq_u32 s24, s55
    s_cbranch_scc0 L_spinl_sy_yf
    s_branch L_ret_sy_yf
L_spin_sy_st:
    s_mov_b32 s71, 0
L_spinl_sy_st:
    s_sleep 1
    buffer_load_dwordx2 v[254:255], v12, s[8:11], s48 offen sc1
    s_waitcnt vmcnt(0)
    s_add_u32 s71, s71, 1
    s_cmp_gt_u32 s71, 20000
    s_cbranch_scc1 L_ret_sy_st
    v_cmp_ne_u32 vcc, s55, v255
    s_nop 3
    s_cbranch_vccnz L_spinl_sy_st
    s_branch L_ret_sy_st
L_spin_sy_gf:
    s_mov_b32 s71, 0
L_spinl_sy_gf:
    s_buffer_load_dword s24, s[8:11], s45 offset:12 glc
    s_waitcnt lgkmcnt(0)
    s_add_u32 s71, s71, 1
    s_cmp_gt_u32 s71, 40000
    s_cbranch_scc1 L_ret_sy_gf
    s_xor_b32 s24, s24, s55
    s_and_b32 s24, s24, 0xffff
    s_cmp_eq_u32 s24, 0
    s_cbranch_scc0 L_spinl_sy_gf
    s_branch L_ret_sy_gf
L_spin_sy_gy:
    s_mov_b32 s71, 0
L_spinl_sy_gy:
    s_buffer_load_dword s24, s[8:11], s45 offset:6144 glc
    s_waitcnt lgkmcnt(0)
    s_add_u32 s71, s71, 1
    s_cmp_gt_u32 s71, 40000
    s_cbranch_scc1 L_ret_sy_gy
    s_cmp_eq_u32 s24, s55
    s_cbranch_scc0 L_spinl_sy_gy
    s_branch L_ret_sy_gy
L_spin_sy_xf:
    s_mov_b32 s71, 0
L_spinl_sy_xf:
    s_sleep 1
    buffer_load_dwordx4 v[76:79], v14, s[8:11], s45 offen offset:0 sc1
    buffer_load_dwordx4 v[80:83], v14, s[8:11], s45 offen offset:1024 sc1
    buffer_load_dwordx4 v[84:87], v14, s[8:11], s45 offen offset:2048 sc1
    s_waitcnt vmcnt(0)
    v_xor_b32 v8, s55, v79
    v_bitop3_b32 v8, v8, v83, s55 bitop3:0xf6
    v_bitop3_b32 v8, v8, v87, s55 bitop3:0xf6
    v_and_b32 v8, 0xffff, v8
    s_add_u32 s71, s71, 1
    s_cmp_gt_u32 s71, 20000
    s_cbranch_scc1 L_ret_sy_xf
    v_cmp_ne_u32 vcc, 0, v8
    s_nop 3
    s_cbranch_vccnz L_spinl_sy_xf
    s_branch L_ret_sy_xf
L_spin_sy_xy:
    s_mov_b32 s71, 0
L_spinl_sy_xy:
    s_sleep 1
    buffer_load_dwordx4 v[244:247], v14, s[8:11], s65 offen offset:0 sc1
    buffer_load_dwordx4 v[248:251], v14, s[8:11], s65 offen offset:1024 sc1
    buffer_load_dwordx4 v[252:255], v14, s[8:11], s65 offen offset:2048 sc1
    s_waitcnt vmcnt(0)
    v_xor_b32 v8, s55, v247
    v_bitop3_b32 v8, v8, v251, s55 bitop3:0xf6
    v_bitop3_b32 v8, v8, v255, s55 bitop3:0xf6
    v_and_b32 v8, 0xffff, v8
    s_add_u32 s71, s71, 1
    s_cmp_gt_u32 s71, 20000
    s_cbranch_scc1 L_ret_sy_xy
    v_cmp_ne_u32 vcc, 0, v8
    s_nop 3
    s_cbranch_vccnz L_spinl_sy_xy
    s_branch L_ret_sy_xy
L_end:
s_endpgm
.section .rodata,"a"
.p2align 6
.amdhsa_kernel recurrent_scan__ssm_conv_s5__dense_activation_gelu__prompt_kernel
  .amdhsa_next_free_vgpr 512
  .amdhsa_next_free_sgpr 102
  .amdhsa_accum_offset 256
  .amdhsa_group_segment_fixed_size 0
  .amdhsa_kernarg_size 136
  .amdhsa_user_sgpr_count 2
  .amdhsa_user_sgpr_kernarg_segment_ptr 1
  .amdhsa_system_sgpr_workgroup_id_x 1
.end_amdhsa_kernel
```
